```python
import torch

def _softmax(x, axis=-1):
    return torch.softmax(x, dim=axis)
def _gelu(x):
    return torch.nn.functional.gelu(x, approximate="tanh")
def _silu(x):
    return torch.nn.functional.silu(x)
def _sigmoid(x):
    return torch.sigmoid(x)
def _layernorm(x, axis=-1, eps=1e-5):
    m = x.mean(dim=axis, keepdim=True)
    v = x.var(dim=axis, keepdim=True, unbiased=False)
    return (x - m) / torch.sqrt(v + eps)
def _scatter_add(tgt, idx, src, axis=0):
    return tgt.clone().index_add_(axis, idx, src)
def _segment_sum(src, seg, n):
    out = torch.zeros((n,) + src.shape[1:], dtype=src.dtype)
    return out.index_add_(0, seg, src)
def _pad(x, pw):
    flat = tuple(v for pair in reversed(pw) for v in pair)
    return torch.nn.functional.pad(x, flat)

kernel_name = 'standalone__mha_softmax__near_ridge'

def setup_inputs():

    _w = (lambda a: (lambda t: t.to(torch.bfloat16) if t.is_floating_point() else t)(torch.as_tensor(a)))
    B, H, Sq, Sk, D = 8, 32, 608, 512, 128
    return {
        "q": _w((lambda *s: torch.randn(*s, dtype=torch.bfloat16) * 0.8)(B, H, Sq, D)),
        "k": _w((lambda *s: torch.randn(*s, dtype=torch.bfloat16) * 0.8)(B, H, Sk, D)),
        "v": _w((lambda *s: torch.randn(*s, dtype=torch.bfloat16) * 0.05)(B, H, Sk, D)),
    }

def reference(q, k, v):
    scale = q.shape[-1] ** -0.5
    scores = torch.einsum("bhqd,bhkd->bhqk", q, k) * scale
    p = _softmax(scores, axis=-1)
    return torch.einsum("bhqk,bhkd->bhqd", p, v)
```

```asm
; @launch grid=(256,1,1) block=(256,1,1) lds=163840
.amdgcn_target "amdgcn-amd-amdhsa--gfx950"
.text
.globl standalone__mha_softmax__near_ridge_kernel
.p2align 8
.type standalone__mha_softmax__near_ridge_kernel,@function
standalone__mha_softmax__near_ridge_kernel:
    s_cmp_ge_u32 s2, 256
    s_cbranch_scc1 L_exit
    s_load_dwordx8 s[4:11], s[0:1], 0
    v_lshrrev_b32 v10, 6, v0
    v_and_b32 v11, 63, v0
    v_readfirstlane_b32 s33, v10
    v_and_b32 v12, 15, v0
    v_lshrrev_b32 v13, 4, v11
    v_and_b32 v14, 3, v0
    v_bfe_u32 v15, v0, 2, 2
    s_lshl_b32 s32, s33, 12
    v_lshlrev_b32 v1, 8, v12
    v_lshl_add_u32 v1, v13, 4, v1
    v_lshl_add_u32 v1, v10, 12, v1
    v_lshlrev_b32 v16, 1, v10
    v_and_b32 v16, 2, v16
    v_xor_b32 v16, v16, v15
    v_lshlrev_b32 v17, 11, v10
    v_lshl_add_u32 v17, v13, 6, v17
    v_lshl_add_u32 v2, v14, 8, v17
    v_lshl_add_u32 v2, v16, 4, v2
    v_lshl_add_u32 v3, v15, 8, v17
    v_lshl_add_u32 v3, v14, 4, v3
    v_lshlrev_b32 v16, 12, v10
    v_lshl_add_u32 v16, v13, 6, v16
    v_lshl_add_u32 v16, v14, 8, v16
    v_lshl_add_u32 v59, v15, 4, v16
    v_xor_b32 v60, 32, v59
    s_mul_i32 s33, s2, 155648
    s_lshl_b32 s3, s2, 17
    s_mov_b32 s22, 131072
    s_mov_b32 s23, 0x20000
    s_mov_b32 s18, 155648
    s_mov_b32 s19, 0x20000
    s_mov_b32 s26, 133120
    s_mov_b32 s27, 0x20000
    s_mov_b32 s30, 155648
    s_mov_b32 s31, 0x20000
    s_mov_b32 s56, 0
    s_mov_b32 s57, 8192
    s_mov_b32 s58, 16384
    s_mov_b32 s59, 24576
    s_mov_b32 s60, 32768
    s_mov_b32 s61, 40960
    s_mov_b32 s62, 49152
    s_mov_b32 s63, 57344
    s_mov_b32 s64, 65536
    s_mov_b32 s65, 73728
    s_mov_b32 s66, 81920
    s_mov_b32 s67, 90112
    s_mov_b32 s68, 98304
    s_mov_b32 s69, 106496
    s_mov_b32 s70, 114688
    s_mov_b32 s71, 122880
    s_mov_b32 s44, 0
    s_mov_b32 s45, 16384
    s_mov_b32 s46, 32768
    s_mov_b32 s47, 49152
    s_mov_b32 s48, 65536
    s_mov_b32 s49, 81920
    s_mov_b32 s50, 98304
    s_mov_b32 s51, 114688
    s_mov_b32 s52, 131072
    s_mov_b32 s53, 147456
    s_getpc_b64 s[72:73]
L_pc:
    s_add_u32 s72, s72, L_main-L_pc
    s_addc_u32 s73, s73, 0
    s_lshr_b32 s74, s2, 3
    s_and_b32 s74, s74, 31
    s_lshl_b32 s74, s74, 11
    v_lshlrev_b32 v18, 9, v10
    v_lshl_add_u32 v18, v14, 7, v18
    v_add_u32 v18, s74, v18
    v_min_u32 v18, L_codeend-L_main-4, v18
    global_load_dword v63, v18, s[72:73]
    s_waitcnt lgkmcnt(0)
    s_add_u32 s20, s6, s3
    s_addc_u32 s21, s7, 0
    s_add_u32 s16, s4, s33
    s_addc_u32 s17, s5, 0
    s_add_u32 s24, s8, s3
    s_addc_u32 s25, s9, 0
    s_sub_u32 s24, s24, 2048
    s_subb_u32 s25, s25, 0
    s_add_u32 m0, s32, 0
    s_nop 0
    buffer_load_dwordx4 v2, s[20:23], s56 offen offset:0  lds
    buffer_load_dwordx4 v2, s[20:23], s56 offen offset:1024  lds
    s_add_u32 m0, s32, 65536
    s_nop 0
    buffer_load_dwordx4 v59, s[16:19], s44 offen offset:0 nt lds
    buffer_load_dwordx4 v59, s[16:19], s44 offen offset:1024 nt lds
    buffer_load_dwordx4 v60, s[16:19], s44 offen offset:2048 nt lds
    buffer_load_dwordx4 v60, s[16:19], s44 offen offset:3072 nt lds
    s_add_u32 m0, s32, 81920
    s_nop 0
    buffer_load_dwordx4 v59, s[16:19], s45 offen offset:0 nt lds
    buffer_load_dwordx4 v59, s[16:19], s45 offen offset:1024 nt lds
    buffer_load_dwordx4 v60, s[16:19], s45 offen offset:2048 nt lds
    buffer_load_dwordx4 v60, s[16:19], s45 offen offset:3072 nt lds
    s_add_u32 m0, s32, 98304
    s_nop 0
    buffer_load_dwordx4 v59, s[16:19], s46 offen offset:0 nt lds
    buffer_load_dwordx4 v59, s[16:19], s46 offen offset:1024 nt lds
    buffer_load_dwordx4 v60, s[16:19], s46 offen offset:2048 nt lds
    buffer_load_dwordx4 v60, s[16:19], s46 offen offset:3072 nt lds
    s_add_u32 s28, s10, s33
    s_addc_u32 s29, s11, 0
    v_lshrrev_b32 v16, 1, v15
    v_and_b32 v17, 1, v15
    v_lshlrev_b32 v18, 12, v16
    v_lshl_add_u32 v18, v17, 10, v18
    v_and_b32 v16, 2, v15
    v_xor_b32 v16, v16, v13
    v_lshl_add_u32 v18, v16, 6, v18
    v_lshl_add_u32 v4, v14, 4, v18
    v_add_u32 v5, 0x10000, v4
    v_add_u32 v6, 0x20000, v4
    v_lshlrev_b32 v17, 12, v10
    v_lshl_add_u32 v17, v15, 10, v17
    v_lshl_add_u32 v17, v16, 6, v17
    v_lshl_add_u32 v17, v14, 4, v17
    v_add_u32 v61, 0x10000, v17
    v_add_u32 v62, 0x20000, v17
    v_lshrrev_b32 v16, 1, v13
    v_and_b32 v17, 1, v13
    v_lshlrev_b32 v18, 12, v16
    v_lshl_add_u32 v18, v17, 10, v18
    v_lshl_add_u32 v18, v12, 4, v18
    v_add_u32 v7, 2048, v18
    v_add_u32 v8, 0x10000, v7
    v_add_u32 v9, 0x20000, v7
    s_and_b32 s42, s32, 8192
    s_sub_u32 s53, s53, s42
    s_lshr_b32 s43, s42, 6
    s_add_u32 s43, s43, s53
    s_lshl_b32 s42, s42, 1
    s_sub_u32 s3, 16384, s42
    v_add_u32 v43, s3, v4
    v_add_u32 v44, s3, v5
    v_add_u32 v45, s3, v6
    v_add_u32 v46, s3, v7
    v_add_u32 v47, s3, v8
    v_add_u32 v56, s3, v9
    v_mul_u32_u24 v16, 5120, v10
    v_lshl_add_u32 v16, v11, 4, v16
    v_add_u32 v57, 32768, v16
    v_xor_b32 v16, 2, v10
    v_mul_u32_u24 v16, 5120, v16
    v_lshl_add_u32 v16, v11, 4, v16
    v_add_u32 v58, 32768, v16
    v_cmp_eq_u32 vcc, 0, v14
    v_mov_b32 v17, 0x3f803f80
    s_nop 0
    v_cndmask_b32 v16, 0, v17, vcc
    v_accvgpr_write_b32 a248, v16
    v_accvgpr_write_b32 a249, v16
    v_accvgpr_write_b32 a250, v16
    v_accvgpr_write_b32 a251, v16
    s_mov_b32 s34, 0x3e0293ee
    s_mov_b32 s36, s34
    s_mov_b32 s37, s34
    s_mov_b32 s35, 0xffff0000
    s_mov_b32 s38, 0x2b800000
    s_mov_b32 s39, 0x32000000
    s_mov_b64 s[40:41], 0
    s_waitcnt vmcnt(14)
    s_mov_b64 exec, 0
    s_cmp_eq_u32 s32, 0
    s_cbranch_scc1 L_m0
    s_cmp_eq_u32 s32, 4096
    s_cbranch_scc1 L_m3
    s_cmp_eq_u32 s32, 8192
    s_cbranch_scc1 L_m6
    s_cmp_eq_u32 s32, 12288
    s_cbranch_scc1 L_m9
L_back:
    s_mov_b64 exec, -1
    s_branch L_main
.p2align 12
L_main:
    s_waitcnt vmcnt(8)
    ds_read_b128 v[240:243], v61 offset:0
    ds_read_b128 v[244:247], v61 offset:256
    ds_read_b128 v[248:251], v61 offset:512
    ds_read_b128 v[252:255], v61 offset:768
    s_waitcnt lgkmcnt(0)
    v_lshlrev_b32 v48, 16, v240
    v_and_b32 v49, s35, v240
    v_pk_mul_f32 v[48:49], v[48:49], s[36:37]
    v_cvt_pk_bf16_f32 v240, v48, v49
    v_accvgpr_write_b32 a0, v240
    v_lshlrev_b32 v50, 16, v241
    v_and_b32 v51, s35, v241
    v_pk_mul_f32 v[50:51], v[50:51], s[36:37]
    v_cvt_pk_bf16_f32 v241, v50, v51
    v_accvgpr_write_b32 a1, v241
    v_lshlrev_b32 v52, 16, v242
    v_and_b32 v53, s35, v242
    v_pk_mul_f32 v[52:53], v[52:53], s[36:37]
    v_cvt_pk_bf16_f32 v242, v52, v53
    v_accvgpr_write_b32 a2, v242
    v_lshlrev_b32 v54, 16, v243
    v_and_b32 v55, s35, v243
    v_pk_mul_f32 v[54:55], v[54:55], s[36:37]
    v_cvt_pk_bf16_f32 v243, v54, v55
    v_accvgpr_write_b32 a3, v243
    v_lshlrev_b32 v48, 16, v244
    v_and_b32 v49, s35, v244
    v_pk_mul_f32 v[48:49], v[48:49], s[36:37]
    v_cvt_pk_bf16_f32 v244, v48, v49
    v_accvgpr_write_b32 a4, v244
    v_lshlrev_b32 v50, 16, v245
    v_and_b32 v51, s35, v245
    v_pk_mul_f32 v[50:51], v[50:51], s[36:37]
    v_cvt_pk_bf16_f32 v245, v50, v51
    v_accvgpr_write_b32 a5, v245
    v_lshlrev_b32 v52, 16, v246
    v_and_b32 v53, s35, v246
    v_pk_mul_f32 v[52:53], v[52:53], s[36:37]
    v_cvt_pk_bf16_f32 v246, v52, v53
    v_accvgpr_write_b32 a6, v246
    v_lshlrev_b32 v54, 16, v247
    v_and_b32 v55, s35, v247
    v_pk_mul_f32 v[54:55], v[54:55], s[36:37]
    v_cvt_pk_bf16_f32 v247, v54, v55
    v_accvgpr_write_b32 a7, v247
    v_lshlrev_b32 v48, 16, v248
    v_and_b32 v49, s35, v248
    v_pk_mul_f32 v[48:49], v[48:49], s[36:37]
    v_cvt_pk_bf16_f32 v248, v48, v49
    v_accvgpr_write_b32 a8, v248
    v_lshlrev_b32 v50, 16, v249
    v_and_b32 v51, s35, v249
    v_pk_mul_f32 v[50:51], v[50:51], s[36:37]
    v_cvt_pk_bf16_f32 v249, v50, v51
    v_accvgpr_write_b32 a9, v249
    v_lshlrev_b32 v52, 16, v250
    v_and_b32 v53, s35, v250
    v_pk_mul_f32 v[52:53], v[52:53], s[36:37]
    v_cvt_pk_bf16_f32 v250, v52, v53
    v_accvgpr_write_b32 a10, v250
    v_lshlrev_b32 v54, 16, v251
    v_and_b32 v55, s35, v251
    v_pk_mul_f32 v[54:55], v[54:55], s[36:37]
    v_cvt_pk_bf16_f32 v251, v54, v55
    v_accvgpr_write_b32 a11, v251
    v_lshlrev_b32 v48, 16, v252
    v_and_b32 v49, s35, v252
    v_pk_mul_f32 v[48:49], v[48:49], s[36:37]
    v_cvt_pk_bf16_f32 v252, v48, v49
    v_accvgpr_write_b32 a12, v252
    v_lshlrev_b32 v50, 16, v253
    v_and_b32 v51, s35, v253
    v_pk_mul_f32 v[50:51], v[50:51], s[36:37]
    v_cvt_pk_bf16_f32 v253, v50, v51
    v_accvgpr_write_b32 a13, v253
    v_lshlrev_b32 v52, 16, v254
    v_and_b32 v53, s35, v254
    v_pk_mul_f32 v[52:53], v[52:53], s[36:37]
    v_cvt_pk_bf16_f32 v254, v52, v53
    v_accvgpr_write_b32 a14, v254
    v_lshlrev_b32 v54, 16, v255
    v_and_b32 v55, s35, v255
    v_pk_mul_f32 v[54:55], v[54:55], s[36:37]
    v_cvt_pk_bf16_f32 v255, v54, v55
    v_accvgpr_write_b32 a15, v255
    s_add_u32 m0, s32, 0
    s_nop 0
    buffer_load_dwordx4 v3, s[24:27], s56 offen offset:2048  lds
    buffer_load_dwordx4 v3, s[24:27], s56 offen offset:3072  lds
    s_add_u32 m0, s32, 114688
    s_nop 0
    buffer_load_dwordx4 v59, s[16:19], s47 offen offset:0 nt lds
    buffer_load_dwordx4 v59, s[16:19], s47 offen offset:1024 nt lds
    buffer_load_dwordx4 v60, s[16:19], s47 offen offset:2048 nt lds
    buffer_load_dwordx4 v60, s[16:19], s47 offen offset:3072 nt lds
    s_waitcnt vmcnt(18)
    s_barrier
    ds_read_b128 a[96:99], v4 offset:0
    ds_read_b128 a[100:103], v4 offset:256
    ds_read_b128 a[104:107], v4 offset:512
    ds_read_b128 a[108:111], v4 offset:768
    ds_read_b128 a[112:115], v4 offset:8192
    ds_read_b128 a[116:119], v4 offset:8448
    ds_read_b128 a[120:123], v4 offset:8704
    ds_read_b128 a[124:127], v4 offset:8960
    s_waitcnt lgkmcnt(0)
    v_mfma_f32_16x16x32_bf16 v[16:19], a[96:99], a[0:3], 0
    v_mfma_f32_16x16x32_bf16 v[16:19], a[100:103], a[4:7], v[16:19]
    v_mfma_f32_16x16x32_bf16 v[16:19], a[104:107], a[8:11], v[16:19]
    v_mfma_f32_16x16x32_bf16 v[16:19], a[108:111], a[12:15], v[16:19]
    v_mfma_f32_16x16x32_bf16 v[20:23], a[112:115], a[0:3], 0
    v_mfma_f32_16x16x32_bf16 v[20:23], a[116:119], a[4:7], v[20:23]
    v_mfma_f32_16x16x32_bf16 v[20:23], a[120:123], a[8:11], v[20:23]
    v_mfma_f32_16x16x32_bf16 v[20:23], a[124:127], a[12:15], v[20:23]
    s_waitcnt vmcnt(10)
    ds_read_b128 v[240:243], v61 offset:16384
    ds_read_b128 v[244:247], v61 offset:16640
    ds_read_b128 v[248:251], v61 offset:16896
    ds_read_b128 v[252:255], v61 offset:17152
    s_waitcnt lgkmcnt(0)
    v_lshlrev_b32 v48, 16, v240
    v_and_b32 v49, s35, v240
    v_pk_mul_f32 v[48:49], v[48:49], s[36:37]
    v_cvt_pk_bf16_f32 v240, v48, v49
    v_accvgpr_write_b32 a16, v240
    v_lshlrev_b32 v50, 16, v241
    v_and_b32 v51, s35, v241
    v_pk_mul_f32 v[50:51], v[50:51], s[36:37]
    v_cvt_pk_bf16_f32 v241, v50, v51
    v_accvgpr_write_b32 a17, v241
    v_lshlrev_b32 v52, 16, v242
    v_and_b32 v53, s35, v242
    v_pk_mul_f32 v[52:53], v[52:53], s[36:37]
    v_cvt_pk_bf16_f32 v242, v52, v53
    v_accvgpr_write_b32 a18, v242
    v_lshlrev_b32 v54, 16, v243
    v_and_b32 v55, s35, v243
    v_pk_mul_f32 v[54:55], v[54:55], s[36:37]
    v_cvt_pk_bf16_f32 v243, v54, v55
    v_accvgpr_write_b32 a19, v243
    v_lshlrev_b32 v48, 16, v244
    v_and_b32 v49, s35, v244
    v_pk_mul_f32 v[48:49], v[48:49], s[36:37]
    v_cvt_pk_bf16_f32 v244, v48, v49
    v_accvgpr_write_b32 a20, v244
    v_lshlrev_b32 v50, 16, v245
    v_and_b32 v51, s35, v245
    v_pk_mul_f32 v[50:51], v[50:51], s[36:37]
    v_cvt_pk_bf16_f32 v245, v50, v51
    v_accvgpr_write_b32 a21, v245
    v_lshlrev_b32 v52, 16, v246
    v_and_b32 v53, s35, v246
    v_pk_mul_f32 v[52:53], v[52:53], s[36:37]
    v_cvt_pk_bf16_f32 v246, v52, v53
    v_accvgpr_write_b32 a22, v246
    v_lshlrev_b32 v54, 16, v247
    v_and_b32 v55, s35, v247
    v_pk_mul_f32 v[54:55], v[54:55], s[36:37]
    v_cvt_pk_bf16_f32 v247, v54, v55
    v_accvgpr_write_b32 a23, v247
    v_lshlrev_b32 v48, 16, v248
    v_and_b32 v49, s35, v248
    v_pk_mul_f32 v[48:49], v[48:49], s[36:37]
    v_cvt_pk_bf16_f32 v248, v48, v49
    v_accvgpr_write_b32 a24, v248
    v_lshlrev_b32 v50, 16, v249
    v_and_b32 v51, s35, v249
    v_pk_mul_f32 v[50:51], v[50:51], s[36:37]
    v_cvt_pk_bf16_f32 v249, v50, v51
    v_accvgpr_write_b32 a25, v249
    v_lshlrev_b32 v52, 16, v250
    v_and_b32 v53, s35, v250
    v_pk_mul_f32 v[52:53], v[52:53], s[36:37]
    v_cvt_pk_bf16_f32 v250, v52, v53
    v_accvgpr_write_b32 a26, v250
    v_lshlrev_b32 v54, 16, v251
    v_and_b32 v55, s35, v251
    v_pk_mul_f32 v[54:55], v[54:55], s[36:37]
    v_cvt_pk_bf16_f32 v251, v54, v55
    v_accvgpr_write_b32 a27, v251
    v_lshlrev_b32 v48, 16, v252
    v_and_b32 v49, s35, v252
    v_pk_mul_f32 v[48:49], v[48:49], s[36:37]
    v_cvt_pk_bf16_f32 v252, v48, v49
    v_accvgpr_write_b32 a28, v252
    v_lshlrev_b32 v50, 16, v253
    v_and_b32 v51, s35, v253
    v_pk_mul_f32 v[50:51], v[50:51], s[36:37]
    v_cvt_pk_bf16_f32 v253, v50, v51
    v_accvgpr_write_b32 a29, v253
    v_lshlrev_b32 v52, 16, v254
    v_and_b32 v53, s35, v254
    v_pk_mul_f32 v[52:53], v[52:53], s[36:37]
    v_cvt_pk_bf16_f32 v254, v52, v53
    v_accvgpr_write_b32 a30, v254
    v_lshlrev_b32 v54, 16, v255
    v_and_b32 v55, s35, v255
    v_pk_mul_f32 v[54:55], v[54:55], s[36:37]
    v_cvt_pk_bf16_f32 v255, v54, v55
    v_accvgpr_write_b32 a31, v255
    s_add_u32 m0, s32, 131072
    s_nop 0
    buffer_load_dwordx4 v59, s[16:19], s48 offen offset:0 nt lds
    buffer_load_dwordx4 v59, s[16:19], s48 offen offset:1024 nt lds
    buffer_load_dwordx4 v60, s[16:19], s48 offen offset:2048 nt lds
    buffer_load_dwordx4 v60, s[16:19], s48 offen offset:3072 nt lds
    s_add_u32 m0, s32, 147456
    s_nop 0
    buffer_load_dwordx4 v59, s[16:19], s49 offen offset:0 nt lds
    buffer_load_dwordx4 v59, s[16:19], s49 offen offset:1024 nt lds
    buffer_load_dwordx4 v60, s[16:19], s49 offen offset:2048 nt lds
    buffer_load_dwordx4 v60, s[16:19], s49 offen offset:3072 nt lds
    s_nop 1
    v_mfma_f32_16x16x32_bf16 v[24:27], a[96:99], a[16:19], 0
    v_mfma_f32_16x16x32_bf16 v[24:27], a[100:103], a[20:23], v[24:27]
    v_mfma_f32_16x16x32_bf16 v[24:27], a[104:107], a[24:27], v[24:27]
    v_mfma_f32_16x16x32_bf16 v[24:27], a[108:111], a[28:31], v[24:27]
    v_mfma_f32_16x16x32_bf16 v[28:31], a[112:115], a[16:19], 0
    v_mfma_f32_16x16x32_bf16 v[28:31], a[116:119], a[20:23], v[28:31]
    v_mfma_f32_16x16x32_bf16 v[28:31], a[120:123], a[24:27], v[28:31]
    v_mfma_f32_16x16x32_bf16 v[28:31], a[124:127], a[28:31], v[28:31]
    v_exp_f32 v16, v16
    v_exp_f32 v17, v17
    v_exp_f32 v18, v18
    v_exp_f32 v19, v19
    v_exp_f32 v20, v20
    v_exp_f32 v21, v21
    v_exp_f32 v22, v22
    v_exp_f32 v23, v23
    s_nop 0
    v_cvt_pk_bf16_f32 v32, v16, v17
    v_cvt_pk_bf16_f32 v33, v18, v19
    v_cvt_pk_bf16_f32 v34, v20, v21
    v_cvt_pk_bf16_f32 v35, v22, v23
    s_waitcnt vmcnt(14)
    ds_read_b128 v[240:243], v61 offset:32768
    ds_read_b128 v[244:247], v61 offset:33024
    ds_read_b128 v[248:251], v61 offset:33280
    ds_read_b128 v[252:255], v61 offset:33536
    s_waitcnt lgkmcnt(0)
    v_lshlrev_b32 v48, 16, v240
    v_and_b32 v49, s35, v240
    v_pk_mul_f32 v[48:49], v[48:49], s[36:37]
    v_cvt_pk_bf16_f32 v240, v48, v49
    v_accvgpr_write_b32 a32, v240
    v_lshlrev_b32 v50, 16, v241
    v_and_b32 v51, s35, v241
    v_pk_mul_f32 v[50:51], v[50:51], s[36:37]
    v_cvt_pk_bf16_f32 v241, v50, v51
    v_accvgpr_write_b32 a33, v241
    v_lshlrev_b32 v52, 16, v242
    v_and_b32 v53, s35, v242
    v_pk_mul_f32 v[52:53], v[52:53], s[36:37]
    v_cvt_pk_bf16_f32 v242, v52, v53
    v_accvgpr_write_b32 a34, v242
    v_lshlrev_b32 v54, 16, v243
    v_and_b32 v55, s35, v243
    v_pk_mul_f32 v[54:55], v[54:55], s[36:37]
    v_cvt_pk_bf16_f32 v243, v54, v55
    v_accvgpr_write_b32 a35, v243
    v_lshlrev_b32 v48, 16, v244
    v_and_b32 v49, s35, v244
    v_pk_mul_f32 v[48:49], v[48:49], s[36:37]
    v_cvt_pk_bf16_f32 v244, v48, v49
    v_accvgpr_write_b32 a36, v244
    v_lshlrev_b32 v50, 16, v245
    v_and_b32 v51, s35, v245
    v_pk_mul_f32 v[50:51], v[50:51], s[36:37]
    v_cvt_pk_bf16_f32 v245, v50, v51
    v_accvgpr_write_b32 a37, v245
    v_lshlrev_b32 v52, 16, v246
    v_and_b32 v53, s35, v246
    v_pk_mul_f32 v[52:53], v[52:53], s[36:37]
    v_cvt_pk_bf16_f32 v246, v52, v53
    v_accvgpr_write_b32 a38, v246
    v_lshlrev_b32 v54, 16, v247
    v_and_b32 v55, s35, v247
    v_pk_mul_f32 v[54:55], v[54:55], s[36:37]
    v_cvt_pk_bf16_f32 v247, v54, v55
    v_accvgpr_write_b32 a39, v247
    v_lshlrev_b32 v48, 16, v248
    v_and_b32 v49, s35, v248
    v_pk_mul_f32 v[48:49], v[48:49], s[36:37]
    v_cvt_pk_bf16_f32 v248, v48, v49
    v_accvgpr_write_b32 a40, v248
    v_lshlrev_b32 v50, 16, v249
    v_and_b32 v51, s35, v249
    v_pk_mul_f32 v[50:51], v[50:51], s[36:37]
    v_cvt_pk_bf16_f32 v249, v50, v51
    v_accvgpr_write_b32 a41, v249
    v_lshlrev_b32 v52, 16, v250
    v_and_b32 v53, s35, v250
    v_pk_mul_f32 v[52:53], v[52:53], s[36:37]
    v_cvt_pk_bf16_f32 v250, v52, v53
    v_accvgpr_write_b32 a42, v250
    v_lshlrev_b32 v54, 16, v251
    v_and_b32 v55, s35, v251
    v_pk_mul_f32 v[54:55], v[54:55], s[36:37]
    v_cvt_pk_bf16_f32 v251, v54, v55
    v_accvgpr_write_b32 a43, v251
    v_lshlrev_b32 v48, 16, v252
    v_and_b32 v49, s35, v252
    v_pk_mul_f32 v[48:49], v[48:49], s[36:37]
    v_cvt_pk_bf16_f32 v252, v48, v49
    v_accvgpr_write_b32 a44, v252
    v_lshlrev_b32 v50, 16, v253
    v_and_b32 v51, s35, v253
    v_pk_mul_f32 v[50:51], v[50:51], s[36:37]
    v_cvt_pk_bf16_f32 v253, v50, v51
    v_accvgpr_write_b32 a45, v253
    v_lshlrev_b32 v52, 16, v254
    v_and_b32 v53, s35, v254
    v_pk_mul_f32 v[52:53], v[52:53], s[36:37]
    v_cvt_pk_bf16_f32 v254, v52, v53
    v_accvgpr_write_b32 a46, v254
    v_lshlrev_b32 v54, 16, v255
    v_and_b32 v55, s35, v255
    v_pk_mul_f32 v[54:55], v[54:55], s[36:37]
    v_cvt_pk_bf16_f32 v255, v54, v55
    v_accvgpr_write_b32 a47, v255
    s_add_u32 m0, s32, 16384
    s_nop 0
    buffer_load_dwordx4 v2, s[20:23], s57 offen offset:0  lds
    buffer_load_dwordx4 v2, s[20:23], s57 offen offset:1024  lds
    s_add_u32 m0, s32, 16384
    s_nop 0
    buffer_load_dwordx4 v3, s[24:27], s57 offen offset:2048  lds
    buffer_load_dwordx4 v3, s[24:27], s57 offen offset:3072  lds
    s_waitcnt vmcnt(16)
    s_barrier
    ds_read_b64_tr_b16 a[128:129], v7 offset:0
    ds_read_b64_tr_b16 a[130:131], v7 offset:8192
    ds_read_b64_tr_b16 a[132:133], v7 offset:8
    ds_read_b64_tr_b16 a[134:135], v7 offset:8200
    ds_read_b64_tr_b16 a[136:137], v7 offset:256
    ds_read_b64_tr_b16 a[138:139], v7 offset:8448
    ds_read_b64_tr_b16 a[140:141], v7 offset:264
    ds_read_b64_tr_b16 a[142:143], v7 offset:8456
    ds_read_b64_tr_b16 a[144:145], v7 offset:512
    ds_read_b64_tr_b16 a[146:147], v7 offset:8704
    ds_read_b64_tr_b16 a[148:149], v7 offset:520
    ds_read_b64_tr_b16 a[150:151], v7 offset:8712
    ds_read_b64_tr_b16 a[152:153], v7 offset:768
    ds_read_b64_tr_b16 a[154:155], v7 offset:8960
    ds_read_b64_tr_b16 a[156:157], v7 offset:776
    ds_read_b64_tr_b16 a[158:159], v7 offset:8968
    s_waitcnt lgkmcnt(0)
    v_mfma_f32_16x16x32_bf16 v[16:19], a[96:99], a[32:35], 0
    v_exp_f32 v24, v24
    v_mfma_f32_16x16x32_bf16 v[16:19], a[100:103], a[36:39], v[16:19]
    v_mfma_f32_16x16x32_bf16 v[16:19], a[104:107], a[40:43], v[16:19]
    v_exp_f32 v25, v25
    v_mfma_f32_16x16x32_bf16 v[16:19], a[108:111], a[44:47], v[16:19]
    v_cvt_pk_bf16_f32 v36, v24, v25
    v_mfma_f32_16x16x32_bf16 v[20:23], a[112:115], a[32:35], 0
    v_exp_f32 v26, v26
    v_mfma_f32_16x16x32_bf16 v[20:23], a[116:119], a[36:39], v[20:23]
    v_mfma_f32_16x16x32_bf16 v[20:23], a[120:123], a[40:43], v[20:23]
    v_exp_f32 v27, v27
    v_mfma_f32_16x16x32_bf16 v[20:23], a[124:127], a[44:47], v[20:23]
    v_cvt_pk_bf16_f32 v37, v26, v27
    v_mfma_f32_16x16x32_bf16 v[64:67], a[128:131], v[32:35], 0
    v_exp_f32 v28, v28
    v_mfma_f32_16x16x32_bf16 v[68:71], a[132:135], v[32:35], 0
    v_mfma_f32_16x16x32_bf16 v[72:75], a[136:139], v[32:35], 0
    v_exp_f32 v29, v29
    v_mfma_f32_16x16x32_bf16 v[76:79], a[140:143], v[32:35], 0
    v_cvt_pk_bf16_f32 v38, v28, v29
    v_mfma_f32_16x16x32_bf16 v[80:83], a[144:147], v[32:35], 0
    v_exp_f32 v30, v30
    v_mfma_f32_16x16x32_bf16 v[84:87], a[148:151], v[32:35], 0
    v_mfma_f32_16x16x32_bf16 v[88:91], a[152:155], v[32:35], 0
    v_exp_f32 v31, v31
    v_mfma_f32_16x16x32_bf16 v[92:95], a[156:159], v[32:35], 0
    v_cvt_pk_bf16_f32 v39, v30, v31
    v_mfma_f32_16x16x32_bf16 a[224:227], a[248:251], v[32:35], 0
    s_waitcnt vmcnt(12)
    ds_read_b128 v[240:243], v61 offset:49152
    ds_read_b128 v[244:247], v61 offset:49408
    ds_read_b128 v[248:251], v61 offset:49664
    ds_read_b128 v[252:255], v61 offset:49920
    s_waitcnt lgkmcnt(0)
    v_lshlrev_b32 v48, 16, v240
    v_and_b32 v49, s35, v240
    v_pk_mul_f32 v[48:49], v[48:49], s[36:37]
    v_cvt_pk_bf16_f32 v240, v48, v49
    v_accvgpr_write_b32 a48, v240
    v_lshlrev_b32 v50, 16, v241
    v_and_b32 v51, s35, v241
    v_pk_mul_f32 v[50:51], v[50:51], s[36:37]
    v_cvt_pk_bf16_f32 v241, v50, v51
    v_accvgpr_write_b32 a49, v241
    v_lshlrev_b32 v52, 16, v242
    v_and_b32 v53, s35, v242
    v_pk_mul_f32 v[52:53], v[52:53], s[36:37]
    v_cvt_pk_bf16_f32 v242, v52, v53
    v_accvgpr_write_b32 a50, v242
    v_lshlrev_b32 v54, 16, v243
    v_and_b32 v55, s35, v243
    v_pk_mul_f32 v[54:55], v[54:55], s[36:37]
    v_cvt_pk_bf16_f32 v243, v54, v55
    v_accvgpr_write_b32 a51, v243
    v_lshlrev_b32 v48, 16, v244
    v_and_b32 v49, s35, v244
    v_pk_mul_f32 v[48:49], v[48:49], s[36:37]
    v_cvt_pk_bf16_f32 v244, v48, v49
    v_accvgpr_write_b32 a52, v244
    v_lshlrev_b32 v50, 16, v245
    v_and_b32 v51, s35, v245
    v_pk_mul_f32 v[50:51], v[50:51], s[36:37]
    v_cvt_pk_bf16_f32 v245, v50, v51
    v_accvgpr_write_b32 a53, v245
    v_lshlrev_b32 v52, 16, v246
    v_and_b32 v53, s35, v246
    v_pk_mul_f32 v[52:53], v[52:53], s[36:37]
    v_cvt_pk_bf16_f32 v246, v52, v53
    v_accvgpr_write_b32 a54, v246
    v_lshlrev_b32 v54, 16, v247
    v_and_b32 v55, s35, v247
    v_pk_mul_f32 v[54:55], v[54:55], s[36:37]
    v_cvt_pk_bf16_f32 v247, v54, v55
    v_accvgpr_write_b32 a55, v247
    v_lshlrev_b32 v48, 16, v248
    v_and_b32 v49, s35, v248
    v_pk_mul_f32 v[48:49], v[48:49], s[36:37]
    v_cvt_pk_bf16_f32 v248, v48, v49
    v_accvgpr_write_b32 a56, v248
    v_lshlrev_b32 v50, 16, v249
    v_and_b32 v51, s35, v249
    v_pk_mul_f32 v[50:51], v[50:51], s[36:37]
    v_cvt_pk_bf16_f32 v249, v50, v51
    v_accvgpr_write_b32 a57, v249
    v_lshlrev_b32 v52, 16, v250
    v_and_b32 v53, s35, v250
    v_pk_mul_f32 v[52:53], v[52:53], s[36:37]
    v_cvt_pk_bf16_f32 v250, v52, v53
    v_accvgpr_write_b32 a58, v250
    v_lshlrev_b32 v54, 16, v251
    v_and_b32 v55, s35, v251
    v_pk_mul_f32 v[54:55], v[54:55], s[36:37]
    v_cvt_pk_bf16_f32 v251, v54, v55
    v_accvgpr_write_b32 a59, v251
    v_lshlrev_b32 v48, 16, v252
    v_and_b32 v49, s35, v252
    v_pk_mul_f32 v[48:49], v[48:49], s[36:37]
    v_cvt_pk_bf16_f32 v252, v48, v49
    v_accvgpr_write_b32 a60, v252
    v_lshlrev_b32 v50, 16, v253
    v_and_b32 v51, s35, v253
    v_pk_mul_f32 v[50:51], v[50:51], s[36:37]
    v_cvt_pk_bf16_f32 v253, v50, v51
    v_accvgpr_write_b32 a61, v253
    v_lshlrev_b32 v52, 16, v254
    v_and_b32 v53, s35, v254
    v_pk_mul_f32 v[52:53], v[52:53], s[36:37]
    v_cvt_pk_bf16_f32 v254, v52, v53
    v_accvgpr_write_b32 a62, v254
    v_lshlrev_b32 v54, 16, v255
    v_and_b32 v55, s35, v255
    v_pk_mul_f32 v[54:55], v[54:55], s[36:37]
    v_cvt_pk_bf16_f32 v255, v54, v55
    v_accvgpr_write_b32 a63, v255
    s_nop 1
    v_mfma_f32_16x16x32_bf16 v[24:27], a[96:99], a[48:51], 0
    v_exp_f32 v16, v16
    v_mfma_f32_16x16x32_bf16 v[24:27], a[100:103], a[52:55], v[24:27]
    v_mfma_f32_16x16x32_bf16 v[24:27], a[104:107], a[56:59], v[24:27]
    v_exp_f32 v17, v17
    v_mfma_f32_16x16x32_bf16 v[24:27], a[108:111], a[60:63], v[24:27]
    v_cvt_pk_bf16_f32 v32, v16, v17
    v_mfma_f32_16x16x32_bf16 v[28:31], a[112:115], a[48:51], 0
    v_exp_f32 v18, v18
    v_mfma_f32_16x16x32_bf16 v[28:31], a[116:119], a[52:55], v[28:31]
    v_mfma_f32_16x16x32_bf16 v[28:31], a[120:123], a[56:59], v[28:31]
    v_exp_f32 v19, v19
    v_mfma_f32_16x16x32_bf16 v[28:31], a[124:127], a[60:63], v[28:31]
    v_cvt_pk_bf16_f32 v33, v18, v19
    v_mfma_f32_16x16x32_bf16 v[96:99], a[128:131], v[36:39], 0
    v_exp_f32 v20, v20
    v_mfma_f32_16x16x32_bf16 v[100:103], a[132:135], v[36:39], 0
    v_mfma_f32_16x16x32_bf16 v[104:107], a[136:139], v[36:39], 0
    v_exp_f32 v21, v21
    v_mfma_f32_16x16x32_bf16 v[108:111], a[140:143], v[36:39], 0
    v_cvt_pk_bf16_f32 v34, v20, v21
    v_mfma_f32_16x16x32_bf16 v[112:115], a[144:147], v[36:39], 0
    v_exp_f32 v22, v22
    v_mfma_f32_16x16x32_bf16 v[116:119], a[148:151], v[36:39], 0
    v_mfma_f32_16x16x32_bf16 v[120:123], a[152:155], v[36:39], 0
    v_exp_f32 v23, v23
    v_mfma_f32_16x16x32_bf16 v[124:127], a[156:159], v[36:39], 0
    v_cvt_pk_bf16_f32 v35, v22, v23
    v_mfma_f32_16x16x32_bf16 a[228:231], a[248:251], v[36:39], 0
    s_waitcnt vmcnt(8)
    ds_read_b128 v[240:243], v62 offset:0
    ds_read_b128 v[244:247], v62 offset:256
    ds_read_b128 v[248:251], v62 offset:512
    ds_read_b128 v[252:255], v62 offset:768
    s_waitcnt lgkmcnt(0)
    v_lshlrev_b32 v48, 16, v240
    v_and_b32 v49, s35, v240
    v_pk_mul_f32 v[48:49], v[48:49], s[36:37]
    v_cvt_pk_bf16_f32 v240, v48, v49
    v_accvgpr_write_b32 a64, v240
    v_lshlrev_b32 v50, 16, v241
    v_and_b32 v51, s35, v241
    v_pk_mul_f32 v[50:51], v[50:51], s[36:37]
    v_cvt_pk_bf16_f32 v241, v50, v51
    v_accvgpr_write_b32 a65, v241
    v_lshlrev_b32 v52, 16, v242
    v_and_b32 v53, s35, v242
    v_pk_mul_f32 v[52:53], v[52:53], s[36:37]
    v_cvt_pk_bf16_f32 v242, v52, v53
    v_accvgpr_write_b32 a66, v242
    v_lshlrev_b32 v54, 16, v243
    v_and_b32 v55, s35, v243
    v_pk_mul_f32 v[54:55], v[54:55], s[36:37]
    v_cvt_pk_bf16_f32 v243, v54, v55
    v_accvgpr_write_b32 a67, v243
    v_lshlrev_b32 v48, 16, v244
    v_and_b32 v49, s35, v244
    v_pk_mul_f32 v[48:49], v[48:49], s[36:37]
    v_cvt_pk_bf16_f32 v244, v48, v49
    v_accvgpr_write_b32 a68, v244
    v_lshlrev_b32 v50, 16, v245
    v_and_b32 v51, s35, v245
    v_pk_mul_f32 v[50:51], v[50:51], s[36:37]
    v_cvt_pk_bf16_f32 v245, v50, v51
    v_accvgpr_write_b32 a69, v245
    v_lshlrev_b32 v52, 16, v246
    v_and_b32 v53, s35, v246
    v_pk_mul_f32 v[52:53], v[52:53], s[36:37]
    v_cvt_pk_bf16_f32 v246, v52, v53
    v_accvgpr_write_b32 a70, v246
    v_lshlrev_b32 v54, 16, v247
    v_and_b32 v55, s35, v247
    v_pk_mul_f32 v[54:55], v[54:55], s[36:37]
    v_cvt_pk_bf16_f32 v247, v54, v55
    v_accvgpr_write_b32 a71, v247
    v_lshlrev_b32 v48, 16, v248
    v_and_b32 v49, s35, v248
    v_pk_mul_f32 v[48:49], v[48:49], s[36:37]
    v_cvt_pk_bf16_f32 v248, v48, v49
    v_accvgpr_write_b32 a72, v248
    v_lshlrev_b32 v50, 16, v249
    v_and_b32 v51, s35, v249
    v_pk_mul_f32 v[50:51], v[50:51], s[36:37]
    v_cvt_pk_bf16_f32 v249, v50, v51
    v_accvgpr_write_b32 a73, v249
    v_lshlrev_b32 v52, 16, v250
    v_and_b32 v53, s35, v250
    v_pk_mul_f32 v[52:53], v[52:53], s[36:37]
    v_cvt_pk_bf16_f32 v250, v52, v53
    v_accvgpr_write_b32 a74, v250
    v_lshlrev_b32 v54, 16, v251
    v_and_b32 v55, s35, v251
    v_pk_mul_f32 v[54:55], v[54:55], s[36:37]
    v_cvt_pk_bf16_f32 v251, v54, v55
    v_accvgpr_write_b32 a75, v251
    v_lshlrev_b32 v48, 16, v252
    v_and_b32 v49, s35, v252
    v_pk_mul_f32 v[48:49], v[48:49], s[36:37]
    v_cvt_pk_bf16_f32 v252, v48, v49
    v_accvgpr_write_b32 a76, v252
    v_lshlrev_b32 v50, 16, v253
    v_and_b32 v51, s35, v253
    v_pk_mul_f32 v[50:51], v[50:51], s[36:37]
    v_cvt_pk_bf16_f32 v253, v50, v51
    v_accvgpr_write_b32 a77, v253
    v_lshlrev_b32 v52, 16, v254
    v_and_b32 v53, s35, v254
    v_pk_mul_f32 v[52:53], v[52:53], s[36:37]
    v_cvt_pk_bf16_f32 v254, v52, v53
    v_accvgpr_write_b32 a78, v254
    v_lshlrev_b32 v54, 16, v255
    v_and_b32 v55, s35, v255
    v_pk_mul_f32 v[54:55], v[54:55], s[36:37]
    v_cvt_pk_bf16_f32 v255, v54, v55
    v_accvgpr_write_b32 a79, v255
    s_add_u32 m0, s32, 32768
    s_nop 0
    buffer_load_dwordx4 v2, s[20:23], s58 offen offset:0  lds
    buffer_load_dwordx4 v2, s[20:23], s58 offen offset:1024  lds
    buffer_load_dwordx4 v3, s[24:27], s58 offen offset:2048  lds
    buffer_load_dwordx4 v3, s[24:27], s58 offen offset:3072  lds
    s_nop 1
    v_mfma_f32_16x16x32_bf16 v[16:19], a[96:99], a[64:67], 0
    v_exp_f32 v24, v24
    v_mfma_f32_16x16x32_bf16 v[16:19], a[100:103], a[68:71], v[16:19]
    v_mfma_f32_16x16x32_bf16 v[16:19], a[104:107], a[72:75], v[16:19]
    v_exp_f32 v25, v25
    v_mfma_f32_16x16x32_bf16 v[16:19], a[108:111], a[76:79], v[16:19]
    v_cvt_pk_bf16_f32 v36, v24, v25
    v_mfma_f32_16x16x32_bf16 v[20:23], a[112:115], a[64:67], 0
    v_exp_f32 v26, v26
    v_mfma_f32_16x16x32_bf16 v[20:23], a[116:119], a[68:71], v[20:23]
    v_mfma_f32_16x16x32_bf16 v[20:23], a[120:123], a[72:75], v[20:23]
    v_exp_f32 v27, v27
    v_mfma_f32_16x16x32_bf16 v[20:23], a[124:127], a[76:79], v[20:23]
    v_cvt_pk_bf16_f32 v37, v26, v27
    v_mfma_f32_16x16x32_bf16 v[128:131], a[128:131], v[32:35], 0
    v_exp_f32 v28, v28
    v_mfma_f32_16x16x32_bf16 v[132:135], a[132:135], v[32:35], 0
    v_mfma_f32_16x16x32_bf16 v[136:139], a[136:139], v[32:35], 0
    v_exp_f32 v29, v29
    v_mfma_f32_16x16x32_bf16 v[140:143], a[140:143], v[32:35], 0
    v_cvt_pk_bf16_f32 v38, v28, v29
    v_mfma_f32_16x16x32_bf16 v[144:147], a[144:147], v[32:35], 0
    v_exp_f32 v30, v30
    v_mfma_f32_16x16x32_bf16 v[148:151], a[148:151], v[32:35], 0
    v_mfma_f32_16x16x32_bf16 v[152:155], a[152:155], v[32:35], 0
    v_exp_f32 v31, v31
    v_mfma_f32_16x16x32_bf16 v[156:159], a[156:159], v[32:35], 0
    v_cvt_pk_bf16_f32 v39, v30, v31
    v_mfma_f32_16x16x32_bf16 a[232:235], a[248:251], v[32:35], 0
    s_waitcnt vmcnt(8)
    ds_read_b128 v[240:243], v62 offset:16384
    ds_read_b128 v[244:247], v62 offset:16640
    ds_read_b128 v[248:251], v62 offset:16896
    ds_read_b128 v[252:255], v62 offset:17152
    s_waitcnt lgkmcnt(0)
    v_lshlrev_b32 v48, 16, v240
    v_and_b32 v49, s35, v240
    v_pk_mul_f32 v[48:49], v[48:49], s[36:37]
L_m0:
    s_cbranch_execz L_m1
    v_cvt_pk_bf16_f32 v240, v48, v49
    v_accvgpr_write_b32 a80, v240
    v_lshlrev_b32 v50, 16, v241
    v_and_b32 v51, s35, v241
    v_pk_mul_f32 v[50:51], v[50:51], s[36:37]
    v_cvt_pk_bf16_f32 v241, v50, v51
    v_accvgpr_write_b32 a81, v241
    v_lshlrev_b32 v52, 16, v242
    v_and_b32 v53, s35, v242
    v_pk_mul_f32 v[52:53], v[52:53], s[36:37]
    v_cvt_pk_bf16_f32 v242, v52, v53
    v_accvgpr_write_b32 a82, v242
    v_lshlrev_b32 v54, 16, v243
    v_and_b32 v55, s35, v243
    v_pk_mul_f32 v[54:55], v[54:55], s[36:37]
    v_cvt_pk_bf16_f32 v243, v54, v55
    v_accvgpr_write_b32 a83, v243
    v_lshlrev_b32 v48, 16, v244
    v_and_b32 v49, s35, v244
    v_pk_mul_f32 v[48:49], v[48:49], s[36:37]
    v_cvt_pk_bf16_f32 v244, v48, v49
    v_accvgpr_write_b32 a84, v244
    v_lshlrev_b32 v50, 16, v245
    v_and_b32 v51, s35, v245
    v_pk_mul_f32 v[50:51], v[50:51], s[36:37]
    v_cvt_pk_bf16_f32 v245, v50, v51
    v_accvgpr_write_b32 a85, v245
    v_lshlrev_b32 v52, 16, v246
    v_and_b32 v53, s35, v246
    v_pk_mul_f32 v[52:53], v[52:53], s[36:37]
    v_cvt_pk_bf16_f32 v246, v52, v53
    v_accvgpr_write_b32 a86, v246
    v_lshlrev_b32 v54, 16, v247
    v_and_b32 v55, s35, v247
    v_pk_mul_f32 v[54:55], v[54:55], s[36:37]
    v_cvt_pk_bf16_f32 v247, v54, v55
    v_accvgpr_write_b32 a87, v247
    v_lshlrev_b32 v48, 16, v248
    v_and_b32 v49, s35, v248
    v_pk_mul_f32 v[48:49], v[48:49], s[36:37]
    v_cvt_pk_bf16_f32 v248, v48, v49
    v_accvgpr_write_b32 a88, v248
    v_lshlrev_b32 v50, 16, v249
    v_and_b32 v51, s35, v249
    v_pk_mul_f32 v[50:51], v[50:51], s[36:37]
    v_cvt_pk_bf16_f32 v249, v50, v51
    v_accvgpr_write_b32 a89, v249
    v_lshlrev_b32 v52, 16, v250
    v_and_b32 v53, s35, v250
    v_pk_mul_f32 v[52:53], v[52:53], s[36:37]
    v_cvt_pk_bf16_f32 v250, v52, v53
    v_accvgpr_write_b32 a90, v250
    v_lshlrev_b32 v54, 16, v251
    v_and_b32 v55, s35, v251
    v_pk_mul_f32 v[54:55], v[54:55], s[36:37]
    v_cvt_pk_bf16_f32 v251, v54, v55
    v_accvgpr_write_b32 a91, v251
    v_lshlrev_b32 v48, 16, v252
    v_and_b32 v49, s35, v252
    v_pk_mul_f32 v[48:49], v[48:49], s[36:37]
    v_cvt_pk_bf16_f32 v252, v48, v49
    v_accvgpr_write_b32 a92, v252
    v_lshlrev_b32 v50, 16, v253
    v_and_b32 v51, s35, v253
    v_pk_mul_f32 v[50:51], v[50:51], s[36:37]
    v_cvt_pk_bf16_f32 v253, v50, v51
    v_accvgpr_write_b32 a93, v253
    v_lshlrev_b32 v52, 16, v254
    v_and_b32 v53, s35, v254
    v_pk_mul_f32 v[52:53], v[52:53], s[36:37]
    v_cvt_pk_bf16_f32 v254, v52, v53
    v_accvgpr_write_b32 a94, v254
    v_lshlrev_b32 v54, 16, v255
    v_and_b32 v55, s35, v255
    v_pk_mul_f32 v[54:55], v[54:55], s[36:37]
    v_cvt_pk_bf16_f32 v255, v54, v55
    v_accvgpr_write_b32 a95, v255
    s_nop 1
    s_waitcnt vmcnt(6)
    s_barrier
    v_mfma_f32_16x16x32_bf16 v[24:27], a[96:99], a[80:83], 0
    v_exp_f32 v16, v16
    v_mfma_f32_16x16x32_bf16 v[24:27], a[100:103], a[84:87], v[24:27]
    ds_read_b128 a[96:99], v4 offset:16384
    ds_read_b128 a[100:103], v4 offset:16640
    v_mfma_f32_16x16x32_bf16 v[24:27], a[104:107], a[88:91], v[24:27]
    v_exp_f32 v17, v17
    v_mfma_f32_16x16x32_bf16 v[24:27], a[108:111], a[92:95], v[24:27]
    ds_read_b128 a[104:107], v4 offset:16896
    v_cvt_pk_bf16_f32 v32, v16, v17
    v_mfma_f32_16x16x32_bf16 v[28:31], a[112:115], a[80:83], 0
    v_exp_f32 v18, v18
    v_mfma_f32_16x16x32_bf16 v[28:31], a[116:119], a[84:87], v[28:31]
    ds_read_b128 a[108:111], v4 offset:17152
    ds_read_b128 a[112:115], v4 offset:24576
    v_mfma_f32_16x16x32_bf16 v[28:31], a[120:123], a[88:91], v[28:31]
    v_exp_f32 v19, v19
    v_mfma_f32_16x16x32_bf16 v[28:31], a[124:127], a[92:95], v[28:31]
    ds_read_b128 a[116:119], v4 offset:24832
    v_cvt_pk_bf16_f32 v33, v18, v19
    v_mfma_f32_16x16x32_bf16 v[160:163], a[128:131], v[36:39], 0
    v_exp_f32 v20, v20
    v_mfma_f32_16x16x32_bf16 v[164:167], a[132:135], v[36:39], 0
    ds_read_b128 a[120:123], v4 offset:25088
    ds_read_b128 a[124:127], v4 offset:25344
    v_mfma_f32_16x16x32_bf16 v[168:171], a[136:139], v[36:39], 0
    v_exp_f32 v21, v21
    v_mfma_f32_16x16x32_bf16 v[172:175], a[140:143], v[36:39], 0
    v_cvt_pk_bf16_f32 v34, v20, v21
    v_mfma_f32_16x16x32_bf16 v[176:179], a[144:147], v[36:39], 0
    v_exp_f32 v22, v22
    v_mfma_f32_16x16x32_bf16 v[180:183], a[148:151], v[36:39], 0
    v_mfma_f32_16x16x32_bf16 v[184:187], a[152:155], v[36:39], 0
    v_exp_f32 v23, v23
    v_mfma_f32_16x16x32_bf16 v[188:191], a[156:159], v[36:39], 0
    v_cvt_pk_bf16_f32 v35, v22, v23
    v_mfma_f32_16x16x32_bf16 a[236:239], a[248:251], v[36:39], 0
    s_waitcnt lgkmcnt(7)
    v_mfma_f32_16x16x32_bf16 v[16:19], a[96:99], a[0:3], 0
    s_waitcnt lgkmcnt(6)
    v_exp_f32 v24, v24
    v_mfma_f32_16x16x32_bf16 v[16:19], a[100:103], a[4:7], v[16:19]
    s_waitcnt lgkmcnt(5)
    v_mfma_f32_16x16x32_bf16 v[16:19], a[104:107], a[8:11], v[16:19]
    s_waitcnt lgkmcnt(4)
    v_exp_f32 v25, v25
    v_mfma_f32_16x16x32_bf16 v[16:19], a[108:111], a[12:15], v[16:19]
    s_waitcnt lgkmcnt(3)
    v_cvt_pk_bf16_f32 v36, v24, v25
    v_mfma_f32_16x16x32_bf16 v[20:23], a[112:115], a[0:3], 0
    s_waitcnt lgkmcnt(2)
    v_exp_f32 v26, v26
    v_mfma_f32_16x16x32_bf16 v[20:23], a[116:119], a[4:7], v[20:23]
    s_waitcnt lgkmcnt(1)
    v_mfma_f32_16x16x32_bf16 v[20:23], a[120:123], a[8:11], v[20:23]
    s_waitcnt lgkmcnt(0)
    v_exp_f32 v27, v27
    v_mfma_f32_16x16x32_bf16 v[20:23], a[124:127], a[12:15], v[20:23]
    v_cvt_pk_bf16_f32 v37, v26, v27
    v_mfma_f32_16x16x32_bf16 v[192:195], a[128:131], v[32:35], 0
    v_exp_f32 v28, v28
    v_mfma_f32_16x16x32_bf16 v[196:199], a[132:135], v[32:35], 0
    v_mfma_f32_16x16x32_bf16 v[200:203], a[136:139], v[32:35], 0
    v_exp_f32 v29, v29
    v_mfma_f32_16x16x32_bf16 v[204:207], a[140:143], v[32:35], 0
    v_cvt_pk_bf16_f32 v38, v28, v29
    v_mfma_f32_16x16x32_bf16 v[208:211], a[144:147], v[32:35], 0
    v_exp_f32 v30, v30
    v_mfma_f32_16x16x32_bf16 v[212:215], a[148:151], v[32:35], 0
    v_mfma_f32_16x16x32_bf16 v[216:219], a[152:155], v[32:35], 0
    v_exp_f32 v31, v31
    v_mfma_f32_16x16x32_bf16 v[220:223], a[156:159], v[32:35], 0
    s_waitcnt vmcnt(4)
    v_cvt_pk_bf16_f32 v39, v30, v31
    v_mfma_f32_16x16x32_bf16 a[240:243], a[248:251], v[32:35], 0
    s_barrier
    v_mfma_f32_16x16x32_bf16 v[24:27], a[96:99], a[16:19], 0
    v_exp_f32 v16, v16
    v_mfma_f32_16x16x32_bf16 v[24:27], a[100:103], a[20:23], v[24:27]
    v_mfma_f32_16x16x32_bf16 v[24:27], a[104:107], a[24:27], v[24:27]
    v_exp_f32 v17, v17
    v_mfma_f32_16x16x32_bf16 v[24:27], a[108:111], a[28:31], v[24:27]
    v_cvt_pk_bf16_f32 v32, v16, v17
    v_mfma_f32_16x16x32_bf16 v[28:31], a[112:115], a[16:19], 0
    v_exp_f32 v18, v18
    v_mfma_f32_16x16x32_bf16 v[28:31], a[116:119], a[20:23], v[28:31]
    v_mfma_f32_16x16x32_bf16 v[28:31], a[120:123], a[24:27], v[28:31]
    v_exp_f32 v19, v19
    v_mfma_f32_16x16x32_bf16 v[28:31], a[124:127], a[28:31], v[28:31]
    v_cvt_pk_bf16_f32 v33, v18, v19
    v_mfma_f32_16x16x32_bf16 v[224:227], a[128:131], v[36:39], 0
    v_exp_f32 v20, v20
    v_mfma_f32_16x16x32_bf16 v[228:231], a[132:135], v[36:39], 0
    ds_read_b64_tr_b16 a[128:129], v7 offset:16384
    ds_read_b64_tr_b16 a[130:131], v7 offset:24576
    v_mfma_f32_16x16x32_bf16 v[232:235], a[136:139], v[36:39], 0
    v_exp_f32 v21, v21
    v_mfma_f32_16x16x32_bf16 v[236:239], a[140:143], v[36:39], 0
    ds_read_b64_tr_b16 a[132:133], v7 offset:16392
    v_cvt_pk_bf16_f32 v34, v20, v21
    v_mfma_f32_16x16x32_bf16 v[240:243], a[144:147], v[36:39], 0
    v_exp_f32 v22, v22
    v_mfma_f32_16x16x32_bf16 v[244:247], a[148:151], v[36:39], 0
    ds_read_b64_tr_b16 a[134:135], v7 offset:24584
    ds_read_b64_tr_b16 a[136:137], v7 offset:16640
    v_mfma_f32_16x16x32_bf16 v[248:251], a[152:155], v[36:39], 0
    v_exp_f32 v23, v23
    v_mfma_f32_16x16x32_bf16 v[252:255], a[156:159], v[36:39], 0
    ds_read_b64_tr_b16 a[138:139], v7 offset:24832
    v_cvt_pk_bf16_f32 v35, v22, v23
    v_mfma_f32_16x16x32_bf16 a[244:247], a[248:251], v[36:39], 0
    ds_read_b64_tr_b16 a[140:141], v7 offset:16648
    ds_read_b64_tr_b16 a[142:143], v7 offset:24840
    v_mfma_f32_16x16x32_bf16 v[16:19], a[96:99], a[32:35], 0
    v_exp_f32 v24, v24
    v_mfma_f32_16x16x32_bf16 v[16:19], a[100:103], a[36:39], v[16:19]
    ds_read_b64_tr_b16 a[144:145], v7 offset:16896
    ds_read_b64_tr_b16 a[146:147], v7 offset:25088
    v_mfma_f32_16x16x32_bf16 v[16:19], a[104:107], a[40:43], v[16:19]
    v_exp_f32 v25, v25
    v_mfma_f32_16x16x32_bf16 v[16:19], a[108:111], a[44:47], v[16:19]
    ds_read_b64_tr_b16 a[148:149], v7 offset:16904
    v_cvt_pk_bf16_f32 v36, v24, v25
    v_mfma_f32_16x16x32_bf16 v[20:23], a[112:115], a[32:35], 0
    v_exp_f32 v26, v26
    v_mfma_f32_16x16x32_bf16 v[20:23], a[116:119], a[36:39], v[20:23]
    ds_read_b64_tr_b16 a[150:151], v7 offset:25096
    ds_read_b64_tr_b16 a[152:153], v7 offset:17152
    v_mfma_f32_16x16x32_bf16 v[20:23], a[120:123], a[40:43], v[20:23]
    v_exp_f32 v27, v27
    v_mfma_f32_16x16x32_bf16 v[20:23], a[124:127], a[44:47], v[20:23]
    s_waitcnt lgkmcnt(11)
    ds_read_b64_tr_b16 a[154:155], v7 offset:25344
    v_cvt_pk_bf16_f32 v37, v26, v27
    v_mfma_f32_16x16x32_bf16 v[64:67], a[128:131], v[32:35], v[64:67]
    s_waitcnt lgkmcnt(10)
    v_exp_f32 v28, v28
    v_mfma_f32_16x16x32_bf16 v[68:71], a[132:135], v[32:35], v[68:71]
    s_waitcnt lgkmcnt(8)
    ds_read_b64_tr_b16 a[156:157], v7 offset:17160
    ds_read_b64_tr_b16 a[158:159], v7 offset:25352
    v_mfma_f32_16x16x32_bf16 v[72:75], a[136:139], v[32:35], v[72:75]
    s_waitcnt lgkmcnt(8)
    v_exp_f32 v29, v29
    v_mfma_f32_16x16x32_bf16 v[76:79], a[140:143], v[32:35], v[76:79]
    s_waitcnt lgkmcnt(6)
    v_cvt_pk_bf16_f32 v38, v28, v29
    v_mfma_f32_16x16x32_bf16 v[80:83], a[144:147], v[32:35], v[80:83]
    s_waitcnt lgkmcnt(4)
    v_exp_f32 v30, v30
    v_mfma_f32_16x16x32_bf16 v[84:87], a[148:151], v[32:35], v[84:87]
    s_waitcnt lgkmcnt(2)
    v_mfma_f32_16x16x32_bf16 v[88:91], a[152:155], v[32:35], v[88:91]
    s_waitcnt lgkmcnt(0)
    v_exp_f32 v31, v31
    v_mfma_f32_16x16x32_bf16 v[92:95], a[156:159], v[32:35], v[92:95]
    v_cvt_pk_bf16_f32 v39, v30, v31
    v_mfma_f32_16x16x32_bf16 a[224:227], a[248:251], v[32:35], a[224:227]
    v_mfma_f32_16x16x32_bf16 v[24:27], a[96:99], a[48:51], 0
    v_exp_f32 v16, v16
    v_mfma_f32_16x16x32_bf16 v[24:27], a[100:103], a[52:55], v[24:27]
    v_mfma_f32_16x16x32_bf16 v[24:27], a[104:107], a[56:59], v[24:27]
    v_exp_f32 v17, v17
    v_mfma_f32_16x16x32_bf16 v[24:27], a[108:111], a[60:63], v[24:27]
    v_cvt_pk_bf16_f32 v32, v16, v17
    v_mfma_f32_16x16x32_bf16 v[28:31], a[112:115], a[48:51], 0
    v_exp_f32 v18, v18
    v_mfma_f32_16x16x32_bf16 v[28:31], a[116:119], a[52:55], v[28:31]
    v_mfma_f32_16x16x32_bf16 v[28:31], a[120:123], a[56:59], v[28:31]
    v_exp_f32 v19, v19
    v_mfma_f32_16x16x32_bf16 v[28:31], a[124:127], a[60:63], v[28:31]
    v_cvt_pk_bf16_f32 v33, v18, v19
    v_mfma_f32_16x16x32_bf16 v[96:99], a[128:131], v[36:39], v[96:99]
    v_exp_f32 v20, v20
    v_mfma_f32_16x16x32_bf16 v[100:103], a[132:135], v[36:39], v[100:103]
    v_mfma_f32_16x16x32_bf16 v[104:107], a[136:139], v[36:39], v[104:107]
    v_exp_f32 v21, v21
    v_mfma_f32_16x16x32_bf16 v[108:111], a[140:143], v[36:39], v[108:111]
    v_cvt_pk_bf16_f32 v34, v20, v21
    v_mfma_f32_16x16x32_bf16 v[112:115], a[144:147], v[36:39], v[112:115]
    v_exp_f32 v22, v22
    v_mfma_f32_16x16x32_bf16 v[116:119], a[148:151], v[36:39], v[116:119]
    v_mfma_f32_16x16x32_bf16 v[120:123], a[152:155], v[36:39], v[120:123]
    v_exp_f32 v23, v23
    v_mfma_f32_16x16x32_bf16 v[124:127], a[156:159], v[36:39], v[124:127]
    v_cvt_pk_bf16_f32 v35, v22, v23
    v_mfma_f32_16x16x32_bf16 a[228:231], a[248:251], v[36:39], a[228:231]
    v_mfma_f32_16x16x32_bf16 v[16:19], a[96:99], a[64:67], 0
    s_add_u32 m0, s32, 49152
    v_exp_f32 v24, v24
    v_mfma_f32_16x16x32_bf16 v[16:19], a[100:103], a[68:71], v[16:19]
    buffer_load_dwordx4 v2, s[20:23], s59 offen offset:0  lds
    v_mfma_f32_16x16x32_bf16 v[16:19], a[104:107], a[72:75], v[16:19]
    v_exp_f32 v25, v25
    v_mfma_f32_16x16x32_bf16 v[16:19], a[108:111], a[76:79], v[16:19]
    v_cvt_pk_bf16_f32 v36, v24, v25
    v_mfma_f32_16x16x32_bf16 v[20:23], a[112:115], a[64:67], 0
    v_exp_f32 v26, v26
    v_mfma_f32_16x16x32_bf16 v[20:23], a[116:119], a[68:71], v[20:23]
    buffer_load_dwordx4 v2, s[20:23], s59 offen offset:1024  lds
    v_mfma_f32_16x16x32_bf16 v[20:23], a[120:123], a[72:75], v[20:23]
    v_exp_f32 v27, v27
    v_mfma_f32_16x16x32_bf16 v[20:23], a[124:127], a[76:79], v[20:23]
    v_cvt_pk_bf16_f32 v37, v26, v27
    v_mfma_f32_16x16x32_bf16 v[128:131], a[128:131], v[32:35], v[128:131]
    v_exp_f32 v28, v28
    v_mfma_f32_16x16x32_bf16 v[132:135], a[132:135], v[32:35], v[132:135]
    buffer_load_dwordx4 v3, s[24:27], s59 offen offset:2048  lds
    v_mfma_f32_16x16x32_bf16 v[136:139], a[136:139], v[32:35], v[136:139]
    v_exp_f32 v29, v29
    v_mfma_f32_16x16x32_bf16 v[140:143], a[140:143], v[32:35], v[140:143]
    v_cvt_pk_bf16_f32 v38, v28, v29
    v_mfma_f32_16x16x32_bf16 v[144:147], a[144:147], v[32:35], v[144:147]
    v_exp_f32 v30, v30
    v_mfma_f32_16x16x32_bf16 v[148:151], a[148:151], v[32:35], v[148:151]
    buffer_load_dwordx4 v3, s[24:27], s59 offen offset:3072  lds
    v_mfma_f32_16x16x32_bf16 v[152:155], a[152:155], v[32:35], v[152:155]
    v_exp_f32 v31, v31
    v_mfma_f32_16x16x32_bf16 v[156:159], a[156:159], v[32:35], v[156:159]
    s_waitcnt vmcnt(4)
    v_cvt_pk_bf16_f32 v39, v30, v31
    v_mfma_f32_16x16x32_bf16 a[232:235], a[248:251], v[32:35], a[232:235]
    s_barrier
    v_mfma_f32_16x16x32_bf16 v[24:27], a[96:99], a[80:83], 0
    v_exp_f32 v16, v16
    v_mfma_f32_16x16x32_bf16 v[24:27], a[100:103], a[84:87], v[24:27]
    ds_read_b128 a[96:99], v4 offset:32768
    ds_read_b128 a[100:103], v4 offset:33024
    v_mfma_f32_16x16x32_bf16 v[24:27], a[104:107], a[88:91], v[24:27]
    v_exp_f32 v17, v17
    v_mfma_f32_16x16x32_bf16 v[24:27], a[108:111], a[92:95], v[24:27]
    ds_read_b128 a[104:107], v4 offset:33280
    v_cvt_pk_bf16_f32 v32, v16, v17
    v_mfma_f32_16x16x32_bf16 v[28:31], a[112:115], a[80:83], 0
    v_exp_f32 v18, v18
    v_mfma_f32_16x16x32_bf16 v[28:31], a[116:119], a[84:87], v[28:31]
    ds_read_b128 a[108:111], v4 offset:33536
    ds_read_b128 a[112:115], v4 offset:40960
    v_mfma_f32_16x16x32_bf16 v[28:31], a[120:123], a[88:91], v[28:31]
    v_exp_f32 v19, v19
    v_mfma_f32_16x16x32_bf16 v[28:31], a[124:127], a[92:95], v[28:31]
    ds_read_b128 a[116:119], v4 offset:41216
    v_cvt_pk_bf16_f32 v33, v18, v19
    v_mfma_f32_16x16x32_bf16 v[160:163], a[128:131], v[36:39], v[160:163]
    v_exp_f32 v20, v20
    v_mfma_f32_16x16x32_bf16 v[164:167], a[132:135], v[36:39], v[164:167]
    ds_read_b128 a[120:123], v4 offset:41472
    ds_read_b128 a[124:127], v4 offset:41728
    v_mfma_f32_16x16x32_bf16 v[168:171], a[136:139], v[36:39], v[168:171]
    v_exp_f32 v21, v21
    v_mfma_f32_16x16x32_bf16 v[172:175], a[140:143], v[36:39], v[172:175]
    v_cvt_pk_bf16_f32 v34, v20, v21
    v_mfma_f32_16x16x32_bf16 v[176:179], a[144:147], v[36:39], v[176:179]
    v_exp_f32 v22, v22
    v_mfma_f32_16x16x32_bf16 v[180:183], a[148:151], v[36:39], v[180:183]
    v_mfma_f32_16x16x32_bf16 v[184:187], a[152:155], v[36:39], v[184:187]
    v_exp_f32 v23, v23
    v_mfma_f32_16x16x32_bf16 v[188:191], a[156:159], v[36:39], v[188:191]
    v_cvt_pk_bf16_f32 v35, v22, v23
    v_mfma_f32_16x16x32_bf16 a[236:239], a[248:251], v[36:39], a[236:239]
    s_waitcnt lgkmcnt(7)
    v_mfma_f32_16x16x32_bf16 v[16:19], a[96:99], a[0:3], 0
    s_waitcnt lgkmcnt(6)
    v_exp_f32 v24, v24
    v_mfma_f32_16x16x32_bf16 v[16:19], a[100:103], a[4:7], v[16:19]
    s_waitcnt lgkmcnt(5)
    v_mfma_f32_16x16x32_bf16 v[16:19], a[104:107], a[8:11], v[16:19]
    s_waitcnt lgkmcnt(4)
    v_exp_f32 v25, v25
    v_mfma_f32_16x16x32_bf16 v[16:19], a[108:111], a[12:15], v[16:19]
    s_waitcnt lgkmcnt(3)
    v_cvt_pk_bf16_f32 v36, v24, v25
    v_mfma_f32_16x16x32_bf16 v[20:23], a[112:115], a[0:3], 0
    s_waitcnt lgkmcnt(2)
    v_exp_f32 v26, v26
    v_mfma_f32_16x16x32_bf16 v[20:23], a[116:119], a[4:7], v[20:23]
    s_waitcnt lgkmcnt(1)
    v_mfma_f32_16x16x32_bf16 v[20:23], a[120:123], a[8:11], v[20:23]
    s_waitcnt lgkmcnt(0)
    v_exp_f32 v27, v27
    v_mfma_f32_16x16x32_bf16 v[20:23], a[124:127], a[12:15], v[20:23]
    v_cvt_pk_bf16_f32 v37, v26, v27
    v_mfma_f32_16x16x32_bf16 v[192:195], a[128:131], v[32:35], v[192:195]
    v_exp_f32 v28, v28
    v_mfma_f32_16x16x32_bf16 v[196:199], a[132:135], v[32:35], v[196:199]
    v_mfma_f32_16x16x32_bf16 v[200:203], a[136:139], v[32:35], v[200:203]
    v_exp_f32 v29, v29
    v_mfma_f32_16x16x32_bf16 v[204:207], a[140:143], v[32:35], v[204:207]
    v_cvt_pk_bf16_f32 v38, v28, v29
    v_mfma_f32_16x16x32_bf16 v[208:211], a[144:147], v[32:35], v[208:211]
    v_exp_f32 v30, v30
    v_mfma_f32_16x16x32_bf16 v[212:215], a[148:151], v[32:35], v[212:215]
    v_mfma_f32_16x16x32_bf16 v[216:219], a[152:155], v[32:35], v[216:219]
    v_exp_f32 v31, v31
    v_mfma_f32_16x16x32_bf16 v[220:223], a[156:159], v[32:35], v[220:223]
    v_cvt_pk_bf16_f32 v39, v30, v31
    v_mfma_f32_16x16x32_bf16 a[240:243], a[248:251], v[32:35], a[240:243]
    v_mfma_f32_16x16x32_bf16 v[24:27], a[96:99], a[16:19], 0
    v_exp_f32 v16, v16
    v_mfma_f32_16x16x32_bf16 v[24:27], a[100:103], a[20:23], v[24:27]
    v_mfma_f32_16x16x32_bf16 v[24:27], a[104:107], a[24:27], v[24:27]
    v_exp_f32 v17, v17
    v_mfma_f32_16x16x32_bf16 v[24:27], a[108:111], a[28:31], v[24:27]
    v_cvt_pk_bf16_f32 v32, v16, v17
    v_mfma_f32_16x16x32_bf16 v[28:31], a[112:115], a[16:19], 0
    v_exp_f32 v18, v18
    v_mfma_f32_16x16x32_bf16 v[28:31], a[116:119], a[20:23], v[28:31]
    v_mfma_f32_16x16x32_bf16 v[28:31], a[120:123], a[24:27], v[28:31]
    v_exp_f32 v19, v19
    v_mfma_f32_16x16x32_bf16 v[28:31], a[124:127], a[28:31], v[28:31]
    v_cvt_pk_bf16_f32 v33, v18, v19
    v_mfma_f32_16x16x32_bf16 v[224:227], a[128:131], v[36:39], v[224:227]
    v_exp_f32 v20, v20
    v_mfma_f32_16x16x32_bf16 v[228:231], a[132:135], v[36:39], v[228:231]
    ds_read_b64_tr_b16 a[128:129], v7 offset:32768
    ds_read_b64_tr_b16 a[130:131], v7 offset:40960
    v_mfma_f32_16x16x32_bf16 v[232:235], a[136:139], v[36:39], v[232:235]
    v_exp_f32 v21, v21
    v_mfma_f32_16x16x32_bf16 v[236:239], a[140:143], v[36:39], v[236:239]
    ds_read_b64_tr_b16 a[132:133], v7 offset:32776
    v_cvt_pk_bf16_f32 v34, v20, v21
    v_mfma_f32_16x16x32_bf16 v[240:243], a[144:147], v[36:39], v[240:243]
    v_exp_f32 v22, v22
    v_mfma_f32_16x16x32_bf16 v[244:247], a[148:151], v[36:39], v[244:247]
    ds_read_b64_tr_b16 a[134:135], v7 offset:40968
    ds_read_b64_tr_b16 a[136:137], v7 offset:33024
    v_mfma_f32_16x16x32_bf16 v[248:251], a[152:155], v[36:39], v[248:251]
    v_exp_f32 v23, v23
    v_mfma_f32_16x16x32_bf16 v[252:255], a[156:159], v[36:39], v[252:255]
    ds_read_b64_tr_b16 a[138:139], v7 offset:41216
    v_cvt_pk_bf16_f32 v35, v22, v23
    v_mfma_f32_16x16x32_bf16 a[244:247], a[248:251], v[36:39], a[244:247]
    ds_read_b64_tr_b16 a[140:141], v7 offset:33032
    ds_read_b64_tr_b16 a[142:143], v7 offset:41224
    v_mfma_f32_16x16x32_bf16 v[16:19], a[96:99], a[32:35], 0
    v_exp_f32 v24, v24
    v_mfma_f32_16x16x32_bf16 v[16:19], a[100:103], a[36:39], v[16:19]
    ds_read_b64_tr_b16 a[144:145], v7 offset:33280
    ds_read_b64_tr_b16 a[146:147], v7 offset:41472
    v_mfma_f32_16x16x32_bf16 v[16:19], a[104:107], a[40:43], v[16:19]
    v_exp_f32 v25, v25
    v_mfma_f32_16x16x32_bf16 v[16:19], a[108:111], a[44:47], v[16:19]
    ds_read_b64_tr_b16 a[148:149], v7 offset:33288
    v_cvt_pk_bf16_f32 v36, v24, v25
    v_mfma_f32_16x16x32_bf16 v[20:23], a[112:115], a[32:35], 0
    v_exp_f32 v26, v26
    v_mfma_f32_16x16x32_bf16 v[20:23], a[116:119], a[36:39], v[20:23]
    ds_read_b64_tr_b16 a[150:151], v7 offset:41480
    ds_read_b64_tr_b16 a[152:153], v7 offset:33536
    v_mfma_f32_16x16x32_bf16 v[20:23], a[120:123], a[40:43], v[20:23]
    v_exp_f32 v27, v27
    v_mfma_f32_16x16x32_bf16 v[20:23], a[124:127], a[44:47], v[20:23]
    s_waitcnt lgkmcnt(11)
    ds_read_b64_tr_b16 a[154:155], v7 offset:41728
    v_cvt_pk_bf16_f32 v37, v26, v27
    v_mfma_f32_16x16x32_bf16 v[64:67], a[128:131], v[32:35], v[64:67]
    s_waitcnt lgkmcnt(10)
    v_exp_f32 v28, v28
    v_mfma_f32_16x16x32_bf16 v[68:71], a[132:135], v[32:35], v[68:71]
    s_waitcnt lgkmcnt(8)
    ds_read_b64_tr_b16 a[156:157], v7 offset:33544
    ds_read_b64_tr_b16 a[158:159], v7 offset:41736
    v_mfma_f32_16x16x32_bf16 v[72:75], a[136:139], v[32:35], v[72:75]
    s_waitcnt lgkmcnt(8)
    v_exp_f32 v29, v29
    v_mfma_f32_16x16x32_bf16 v[76:79], a[140:143], v[32:35], v[76:79]
    s_waitcnt lgkmcnt(6)
    v_cvt_pk_bf16_f32 v38, v28, v29
    v_mfma_f32_16x16x32_bf16 v[80:83], a[144:147], v[32:35], v[80:83]
    s_waitcnt lgkmcnt(4)
    v_exp_f32 v30, v30
    v_mfma_f32_16x16x32_bf16 v[84:87], a[148:151], v[32:35], v[84:87]
    s_waitcnt lgkmcnt(2)
    v_mfma_f32_16x16x32_bf16 v[88:91], a[152:155], v[32:35], v[88:91]
    s_waitcnt lgkmcnt(0)
    v_exp_f32 v31, v31
    v_mfma_f32_16x16x32_bf16 v[92:95], a[156:159], v[32:35], v[92:95]
    v_cvt_pk_bf16_f32 v39, v30, v31
    v_mfma_f32_16x16x32_bf16 a[224:227], a[248:251], v[32:35], a[224:227]
    v_mfma_f32_16x16x32_bf16 v[24:27], a[96:99], a[48:51], 0
    v_exp_f32 v16, v16
    v_mfma_f32_16x16x32_bf16 v[24:27], a[100:103], a[52:55], v[24:27]
    v_mfma_f32_16x16x32_bf16 v[24:27], a[104:107], a[56:59], v[24:27]
    v_exp_f32 v17, v17
    v_mfma_f32_16x16x32_bf16 v[24:27], a[108:111], a[60:63], v[24:27]
    v_cvt_pk_bf16_f32 v32, v16, v17
    v_mfma_f32_16x16x32_bf16 v[28:31], a[112:115], a[48:51], 0
    v_exp_f32 v18, v18
    v_mfma_f32_16x16x32_bf16 v[28:31], a[116:119], a[52:55], v[28:31]
    v_mfma_f32_16x16x32_bf16 v[28:31], a[120:123], a[56:59], v[28:31]
    v_exp_f32 v19, v19
    v_mfma_f32_16x16x32_bf16 v[28:31], a[124:127], a[60:63], v[28:31]
    v_cvt_pk_bf16_f32 v33, v18, v19
    v_mfma_f32_16x16x32_bf16 v[96:99], a[128:131], v[36:39], v[96:99]
    v_exp_f32 v20, v20
    v_mfma_f32_16x16x32_bf16 v[100:103], a[132:135], v[36:39], v[100:103]
    v_mfma_f32_16x16x32_bf16 v[104:107], a[136:139], v[36:39], v[104:107]
    v_exp_f32 v21, v21
    v_mfma_f32_16x16x32_bf16 v[108:111], a[140:143], v[36:39], v[108:111]
    v_cvt_pk_bf16_f32 v34, v20, v21
    v_mfma_f32_16x16x32_bf16 v[112:115], a[144:147], v[36:39], v[112:115]
    v_exp_f32 v22, v22
    v_mfma_f32_16x16x32_bf16 v[116:119], a[148:151], v[36:39], v[116:119]
    v_mfma_f32_16x16x32_bf16 v[120:123], a[152:155], v[36:39], v[120:123]
    v_exp_f32 v23, v23
    v_mfma_f32_16x16x32_bf16 v[124:127], a[156:159], v[36:39], v[124:127]
    v_cvt_pk_bf16_f32 v35, v22, v23
    v_mfma_f32_16x16x32_bf16 a[228:231], a[248:251], v[36:39], a[228:231]
    v_mfma_f32_16x16x32_bf16 v[16:19], a[96:99], a[64:67], 0
    s_add_u32 m0, s32, 65536
    v_exp_f32 v24, v24
    v_mfma_f32_16x16x32_bf16 v[16:19], a[100:103], a[68:71], v[16:19]
    buffer_load_dwordx4 v2, s[20:23], s60 offen offset:0  lds
    v_mfma_f32_16x16x32_bf16 v[16:19], a[104:107], a[72:75], v[16:19]
    v_exp_f32 v25, v25
    v_mfma_f32_16x16x32_bf16 v[16:19], a[108:111], a[76:79], v[16:19]
    v_cvt_pk_bf16_f32 v36, v24, v25
    v_mfma_f32_16x16x32_bf16 v[20:23], a[112:115], a[64:67], 0
    v_exp_f32 v26, v26
    v_mfma_f32_16x16x32_bf16 v[20:23], a[116:119], a[68:71], v[20:23]
    buffer_load_dwordx4 v2, s[20:23], s60 offen offset:1024  lds
    v_mfma_f32_16x16x32_bf16 v[20:23], a[120:123], a[72:75], v[20:23]
    v_exp_f32 v27, v27
    v_mfma_f32_16x16x32_bf16 v[20:23], a[124:127], a[76:79], v[20:23]
    v_cvt_pk_bf16_f32 v37, v26, v27
    v_mfma_f32_16x16x32_bf16 v[128:131], a[128:131], v[32:35], v[128:131]
    v_exp_f32 v28, v28
    v_mfma_f32_16x16x32_bf16 v[132:135], a[132:135], v[32:35], v[132:135]
    buffer_load_dwordx4 v3, s[24:27], s60 offen offset:2048  lds
    v_mfma_f32_16x16x32_bf16 v[136:139], a[136:139], v[32:35], v[136:139]
    v_exp_f32 v29, v29
    v_mfma_f32_16x16x32_bf16 v[140:143], a[140:143], v[32:35], v[140:143]
    v_cvt_pk_bf16_f32 v38, v28, v29
    v_mfma_f32_16x16x32_bf16 v[144:147], a[144:147], v[32:35], v[144:147]
    v_exp_f32 v30, v30
    v_mfma_f32_16x16x32_bf16 v[148:151], a[148:151], v[32:35], v[148:151]
    buffer_load_dwordx4 v3, s[24:27], s60 offen offset:3072  lds
    v_mfma_f32_16x16x32_bf16 v[152:155], a[152:155], v[32:35], v[152:155]
    v_exp_f32 v31, v31
    v_mfma_f32_16x16x32_bf16 v[156:159], a[156:159], v[32:35], v[156:159]
    s_waitcnt vmcnt(4)
    v_cvt_pk_bf16_f32 v39, v30, v31
    v_mfma_f32_16x16x32_bf16 a[232:235], a[248:251], v[32:35], a[232:235]
    s_barrier
    v_mfma_f32_16x16x32_bf16 v[24:27], a[96:99], a[80:83], 0
    v_exp_f32 v16, v16
    v_mfma_f32_16x16x32_bf16 v[24:27], a[100:103], a[84:87], v[24:27]
    ds_read_b128 a[96:99], v4 offset:49152
    ds_read_b128 a[100:103], v4 offset:49408
    v_mfma_f32_16x16x32_bf16 v[24:27], a[104:107], a[88:91], v[24:27]
    v_exp_f32 v17, v17
    v_mfma_f32_16x16x32_bf16 v[24:27], a[108:111], a[92:95], v[24:27]
    ds_read_b128 a[104:107], v4 offset:49664
    v_cvt_pk_bf16_f32 v32, v16, v17
    v_mfma_f32_16x16x32_bf16 v[28:31], a[112:115], a[80:83], 0
    v_exp_f32 v18, v18
    v_mfma_f32_16x16x32_bf16 v[28:31], a[116:119], a[84:87], v[28:31]
    ds_read_b128 a[108:111], v4 offset:49920
    ds_read_b128 a[112:115], v4 offset:57344
    v_mfma_f32_16x16x32_bf16 v[28:31], a[120:123], a[88:91], v[28:31]
    v_exp_f32 v19, v19
    v_mfma_f32_16x16x32_bf16 v[28:31], a[124:127], a[92:95], v[28:31]
    ds_read_b128 a[116:119], v4 offset:57600
    v_cvt_pk_bf16_f32 v33, v18, v19
    v_mfma_f32_16x16x32_bf16 v[160:163], a[128:131], v[36:39], v[160:163]
    v_exp_f32 v20, v20
    v_mfma_f32_16x16x32_bf16 v[164:167], a[132:135], v[36:39], v[164:167]
    ds_read_b128 a[120:123], v4 offset:57856
    ds_read_b128 a[124:127], v4 offset:58112
    v_mfma_f32_16x16x32_bf16 v[168:171], a[136:139], v[36:39], v[168:171]
    v_exp_f32 v21, v21
    v_mfma_f32_16x16x32_bf16 v[172:175], a[140:143], v[36:39], v[172:175]
    v_cvt_pk_bf16_f32 v34, v20, v21
    v_mfma_f32_16x16x32_bf16 v[176:179], a[144:147], v[36:39], v[176:179]
    v_exp_f32 v22, v22
    v_mfma_f32_16x16x32_bf16 v[180:183], a[148:151], v[36:39], v[180:183]
    v_mfma_f32_16x16x32_bf16 v[184:187], a[152:155], v[36:39], v[184:187]
    v_exp_f32 v23, v23
    v_mfma_f32_16x16x32_bf16 v[188:191], a[156:159], v[36:39], v[188:191]
    v_cvt_pk_bf16_f32 v35, v22, v23
    v_mfma_f32_16x16x32_bf16 a[236:239], a[248:251], v[36:39], a[236:239]
    s_waitcnt lgkmcnt(7)
    v_mfma_f32_16x16x32_bf16 v[16:19], a[96:99], a[0:3], 0
    s_waitcnt lgkmcnt(6)
    v_exp_f32 v24, v24
    v_mfma_f32_16x16x32_bf16 v[16:19], a[100:103], a[4:7], v[16:19]
    s_waitcnt lgkmcnt(5)
    v_mfma_f32_16x16x32_bf16 v[16:19], a[104:107], a[8:11], v[16:19]
    s_waitcnt lgkmcnt(4)
    v_exp_f32 v25, v25
    v_mfma_f32_16x16x32_bf16 v[16:19], a[108:111], a[12:15], v[16:19]
    s_waitcnt lgkmcnt(3)
    v_cvt_pk_bf16_f32 v36, v24, v25
    v_mfma_f32_16x16x32_bf16 v[20:23], a[112:115], a[0:3], 0
    s_waitcnt lgkmcnt(2)
    v_exp_f32 v26, v26
    v_mfma_f32_16x16x32_bf16 v[20:23], a[116:119], a[4:7], v[20:23]
    s_waitcnt lgkmcnt(1)
    v_mfma_f32_16x16x32_bf16 v[20:23], a[120:123], a[8:11], v[20:23]
    s_waitcnt lgkmcnt(0)
    v_exp_f32 v27, v27
    v_mfma_f32_16x16x32_bf16 v[20:23], a[124:127], a[12:15], v[20:23]
    v_cvt_pk_bf16_f32 v37, v26, v27
    v_mfma_f32_16x16x32_bf16 v[192:195], a[128:131], v[32:35], v[192:195]
    v_exp_f32 v28, v28
    v_mfma_f32_16x16x32_bf16 v[196:199], a[132:135], v[32:35], v[196:199]
    v_mfma_f32_16x16x32_bf16 v[200:203], a[136:139], v[32:35], v[200:203]
    v_exp_f32 v29, v29
    v_mfma_f32_16x16x32_bf16 v[204:207], a[140:143], v[32:35], v[204:207]
    v_cvt_pk_bf16_f32 v38, v28, v29
    v_mfma_f32_16x16x32_bf16 v[208:211], a[144:147], v[32:35], v[208:211]
    v_exp_f32 v30, v30
    v_mfma_f32_16x16x32_bf16 v[212:215], a[148:151], v[32:35], v[212:215]
    v_mfma_f32_16x16x32_bf16 v[216:219], a[152:155], v[32:35], v[216:219]
    v_exp_f32 v31, v31
    v_mfma_f32_16x16x32_bf16 v[220:223], a[156:159], v[32:35], v[220:223]
    v_cvt_pk_bf16_f32 v39, v30, v31
    v_mfma_f32_16x16x32_bf16 a[240:243], a[248:251], v[32:35], a[240:243]
    v_mfma_f32_16x16x32_bf16 v[24:27], a[96:99], a[16:19], 0
    v_exp_f32 v16, v16
    v_mfma_f32_16x16x32_bf16 v[24:27], a[100:103], a[20:23], v[24:27]
    v_mfma_f32_16x16x32_bf16 v[24:27], a[104:107], a[24:27], v[24:27]
    v_exp_f32 v17, v17
    v_mfma_f32_16x16x32_bf16 v[24:27], a[108:111], a[28:31], v[24:27]
    v_cvt_pk_bf16_f32 v32, v16, v17
    v_mfma_f32_16x16x32_bf16 v[28:31], a[112:115], a[16:19], 0
    v_exp_f32 v18, v18
    v_mfma_f32_16x16x32_bf16 v[28:31], a[116:119], a[20:23], v[28:31]
    v_mfma_f32_16x16x32_bf16 v[28:31], a[120:123], a[24:27], v[28:31]
L_m1:
    s_cbranch_execz L_m2
    v_exp_f32 v19, v19
    v_mfma_f32_16x16x32_bf16 v[28:31], a[124:127], a[28:31], v[28:31]
    v_cvt_pk_bf16_f32 v33, v18, v19
    v_mfma_f32_16x16x32_bf16 v[224:227], a[128:131], v[36:39], v[224:227]
    v_exp_f32 v20, v20
    v_mfma_f32_16x16x32_bf16 v[228:231], a[132:135], v[36:39], v[228:231]
    ds_read_b64_tr_b16 a[128:129], v7 offset:49152
    ds_read_b64_tr_b16 a[130:131], v7 offset:57344
    v_mfma_f32_16x16x32_bf16 v[232:235], a[136:139], v[36:39], v[232:235]
    v_exp_f32 v21, v21
    v_mfma_f32_16x16x32_bf16 v[236:239], a[140:143], v[36:39], v[236:239]
    ds_read_b64_tr_b16 a[132:133], v7 offset:49160
    v_cvt_pk_bf16_f32 v34, v20, v21
    v_mfma_f32_16x16x32_bf16 v[240:243], a[144:147], v[36:39], v[240:243]
    v_exp_f32 v22, v22
    v_mfma_f32_16x16x32_bf16 v[244:247], a[148:151], v[36:39], v[244:247]
    ds_read_b64_tr_b16 a[134:135], v7 offset:57352
    ds_read_b64_tr_b16 a[136:137], v7 offset:49408
    v_mfma_f32_16x16x32_bf16 v[248:251], a[152:155], v[36:39], v[248:251]
    v_exp_f32 v23, v23
    v_mfma_f32_16x16x32_bf16 v[252:255], a[156:159], v[36:39], v[252:255]
    ds_read_b64_tr_b16 a[138:139], v7 offset:57600
    v_cvt_pk_bf16_f32 v35, v22, v23
    v_mfma_f32_16x16x32_bf16 a[244:247], a[248:251], v[36:39], a[244:247]
    ds_read_b64_tr_b16 a[140:141], v7 offset:49416
    ds_read_b64_tr_b16 a[142:143], v7 offset:57608
    v_mfma_f32_16x16x32_bf16 v[16:19], a[96:99], a[32:35], 0
    v_exp_f32 v24, v24
    v_mfma_f32_16x16x32_bf16 v[16:19], a[100:103], a[36:39], v[16:19]
    ds_read_b64_tr_b16 a[144:145], v7 offset:49664
    ds_read_b64_tr_b16 a[146:147], v7 offset:57856
    v_mfma_f32_16x16x32_bf16 v[16:19], a[104:107], a[40:43], v[16:19]
    v_exp_f32 v25, v25
    v_mfma_f32_16x16x32_bf16 v[16:19], a[108:111], a[44:47], v[16:19]
    ds_read_b64_tr_b16 a[148:149], v7 offset:49672
    v_cvt_pk_bf16_f32 v36, v24, v25
    v_mfma_f32_16x16x32_bf16 v[20:23], a[112:115], a[32:35], 0
    v_exp_f32 v26, v26
    v_mfma_f32_16x16x32_bf16 v[20:23], a[116:119], a[36:39], v[20:23]
    ds_read_b64_tr_b16 a[150:151], v7 offset:57864
    ds_read_b64_tr_b16 a[152:153], v7 offset:49920
    v_mfma_f32_16x16x32_bf16 v[20:23], a[120:123], a[40:43], v[20:23]
    v_exp_f32 v27, v27
    v_mfma_f32_16x16x32_bf16 v[20:23], a[124:127], a[44:47], v[20:23]
    s_waitcnt lgkmcnt(11)
    ds_read_b64_tr_b16 a[154:155], v7 offset:58112
    v_cvt_pk_bf16_f32 v37, v26, v27
    v_mfma_f32_16x16x32_bf16 v[64:67], a[128:131], v[32:35], v[64:67]
    s_waitcnt lgkmcnt(10)
    v_exp_f32 v28, v28
    v_mfma_f32_16x16x32_bf16 v[68:71], a[132:135], v[32:35], v[68:71]
    s_waitcnt lgkmcnt(8)
    ds_read_b64_tr_b16 a[156:157], v7 offset:49928
    ds_read_b64_tr_b16 a[158:159], v7 offset:58120
    v_mfma_f32_16x16x32_bf16 v[72:75], a[136:139], v[32:35], v[72:75]
    s_waitcnt lgkmcnt(8)
    v_exp_f32 v29, v29
    v_mfma_f32_16x16x32_bf16 v[76:79], a[140:143], v[32:35], v[76:79]
    s_waitcnt lgkmcnt(6)
    v_cvt_pk_bf16_f32 v38, v28, v29
    v_mfma_f32_16x16x32_bf16 v[80:83], a[144:147], v[32:35], v[80:83]
    s_waitcnt lgkmcnt(4)
    v_exp_f32 v30, v30
    v_mfma_f32_16x16x32_bf16 v[84:87], a[148:151], v[32:35], v[84:87]
    s_waitcnt lgkmcnt(2)
    v_mfma_f32_16x16x32_bf16 v[88:91], a[152:155], v[32:35], v[88:91]
    s_waitcnt lgkmcnt(0)
    v_exp_f32 v31, v31
    v_mfma_f32_16x16x32_bf16 v[92:95], a[156:159], v[32:35], v[92:95]
    v_cvt_pk_bf16_f32 v39, v30, v31
    v_mfma_f32_16x16x32_bf16 a[224:227], a[248:251], v[32:35], a[224:227]
    v_mfma_f32_16x16x32_bf16 v[24:27], a[96:99], a[48:51], 0
    v_exp_f32 v16, v16
    v_mfma_f32_16x16x32_bf16 v[24:27], a[100:103], a[52:55], v[24:27]
    v_mfma_f32_16x16x32_bf16 v[24:27], a[104:107], a[56:59], v[24:27]
    v_exp_f32 v17, v17
    v_mfma_f32_16x16x32_bf16 v[24:27], a[108:111], a[60:63], v[24:27]
    v_cvt_pk_bf16_f32 v32, v16, v17
    v_mfma_f32_16x16x32_bf16 v[28:31], a[112:115], a[48:51], 0
    v_exp_f32 v18, v18
    v_mfma_f32_16x16x32_bf16 v[28:31], a[116:119], a[52:55], v[28:31]
    v_mfma_f32_16x16x32_bf16 v[28:31], a[120:123], a[56:59], v[28:31]
    v_exp_f32 v19, v19
    v_mfma_f32_16x16x32_bf16 v[28:31], a[124:127], a[60:63], v[28:31]
    v_cvt_pk_bf16_f32 v33, v18, v19
    v_mfma_f32_16x16x32_bf16 v[96:99], a[128:131], v[36:39], v[96:99]
    v_exp_f32 v20, v20
    v_mfma_f32_16x16x32_bf16 v[100:103], a[132:135], v[36:39], v[100:103]
    v_mfma_f32_16x16x32_bf16 v[104:107], a[136:139], v[36:39], v[104:107]
    v_exp_f32 v21, v21
    v_mfma_f32_16x16x32_bf16 v[108:111], a[140:143], v[36:39], v[108:111]
    v_cvt_pk_bf16_f32 v34, v20, v21
    v_mfma_f32_16x16x32_bf16 v[112:115], a[144:147], v[36:39], v[112:115]
    v_exp_f32 v22, v22
    v_mfma_f32_16x16x32_bf16 v[116:119], a[148:151], v[36:39], v[116:119]
    v_mfma_f32_16x16x32_bf16 v[120:123], a[152:155], v[36:39], v[120:123]
    v_exp_f32 v23, v23
    v_mfma_f32_16x16x32_bf16 v[124:127], a[156:159], v[36:39], v[124:127]
    v_cvt_pk_bf16_f32 v35, v22, v23
    v_mfma_f32_16x16x32_bf16 a[228:231], a[248:251], v[36:39], a[228:231]
    v_mfma_f32_16x16x32_bf16 v[16:19], a[96:99], a[64:67], 0
    s_add_u32 m0, s32, 81920
    v_exp_f32 v24, v24
    v_mfma_f32_16x16x32_bf16 v[16:19], a[100:103], a[68:71], v[16:19]
    buffer_load_dwordx4 v2, s[20:23], s61 offen offset:0  lds
    v_mfma_f32_16x16x32_bf16 v[16:19], a[104:107], a[72:75], v[16:19]
    v_exp_f32 v25, v25
    v_mfma_f32_16x16x32_bf16 v[16:19], a[108:111], a[76:79], v[16:19]
    v_cvt_pk_bf16_f32 v36, v24, v25
    v_mfma_f32_16x16x32_bf16 v[20:23], a[112:115], a[64:67], 0
    v_exp_f32 v26, v26
    v_mfma_f32_16x16x32_bf16 v[20:23], a[116:119], a[68:71], v[20:23]
    buffer_load_dwordx4 v2, s[20:23], s61 offen offset:1024  lds
    v_mfma_f32_16x16x32_bf16 v[20:23], a[120:123], a[72:75], v[20:23]
    v_exp_f32 v27, v27
    v_mfma_f32_16x16x32_bf16 v[20:23], a[124:127], a[76:79], v[20:23]
    v_cvt_pk_bf16_f32 v37, v26, v27
    v_mfma_f32_16x16x32_bf16 v[128:131], a[128:131], v[32:35], v[128:131]
    v_exp_f32 v28, v28
    v_mfma_f32_16x16x32_bf16 v[132:135], a[132:135], v[32:35], v[132:135]
    buffer_load_dwordx4 v3, s[24:27], s61 offen offset:2048  lds
    v_mfma_f32_16x16x32_bf16 v[136:139], a[136:139], v[32:35], v[136:139]
    v_exp_f32 v29, v29
    v_mfma_f32_16x16x32_bf16 v[140:143], a[140:143], v[32:35], v[140:143]
    v_cvt_pk_bf16_f32 v38, v28, v29
    v_mfma_f32_16x16x32_bf16 v[144:147], a[144:147], v[32:35], v[144:147]
    v_exp_f32 v30, v30
    v_mfma_f32_16x16x32_bf16 v[148:151], a[148:151], v[32:35], v[148:151]
    buffer_load_dwordx4 v3, s[24:27], s61 offen offset:3072  lds
    v_mfma_f32_16x16x32_bf16 v[152:155], a[152:155], v[32:35], v[152:155]
    v_exp_f32 v31, v31
    v_mfma_f32_16x16x32_bf16 v[156:159], a[156:159], v[32:35], v[156:159]
    s_waitcnt vmcnt(4)
    v_cvt_pk_bf16_f32 v39, v30, v31
    v_mfma_f32_16x16x32_bf16 a[232:235], a[248:251], v[32:35], a[232:235]
    s_barrier
    v_mfma_f32_16x16x32_bf16 v[24:27], a[96:99], a[80:83], 0
    v_exp_f32 v16, v16
    v_mfma_f32_16x16x32_bf16 v[24:27], a[100:103], a[84:87], v[24:27]
    ds_read_b128 a[96:99], v5 offset:0
    ds_read_b128 a[100:103], v5 offset:256
    v_mfma_f32_16x16x32_bf16 v[24:27], a[104:107], a[88:91], v[24:27]
    v_exp_f32 v17, v17
    v_mfma_f32_16x16x32_bf16 v[24:27], a[108:111], a[92:95], v[24:27]
    ds_read_b128 a[104:107], v5 offset:512
    v_cvt_pk_bf16_f32 v32, v16, v17
    v_mfma_f32_16x16x32_bf16 v[28:31], a[112:115], a[80:83], 0
    v_exp_f32 v18, v18
    v_mfma_f32_16x16x32_bf16 v[28:31], a[116:119], a[84:87], v[28:31]
    ds_read_b128 a[108:111], v5 offset:768
    ds_read_b128 a[112:115], v5 offset:8192
    v_mfma_f32_16x16x32_bf16 v[28:31], a[120:123], a[88:91], v[28:31]
    v_exp_f32 v19, v19
    v_mfma_f32_16x16x32_bf16 v[28:31], a[124:127], a[92:95], v[28:31]
    ds_read_b128 a[116:119], v5 offset:8448
    v_cvt_pk_bf16_f32 v33, v18, v19
    v_mfma_f32_16x16x32_bf16 v[160:163], a[128:131], v[36:39], v[160:163]
    v_exp_f32 v20, v20
    v_mfma_f32_16x16x32_bf16 v[164:167], a[132:135], v[36:39], v[164:167]
    ds_read_b128 a[120:123], v5 offset:8704
    ds_read_b128 a[124:127], v5 offset:8960
    v_mfma_f32_16x16x32_bf16 v[168:171], a[136:139], v[36:39], v[168:171]
    v_exp_f32 v21, v21
    v_mfma_f32_16x16x32_bf16 v[172:175], a[140:143], v[36:39], v[172:175]
    v_cvt_pk_bf16_f32 v34, v20, v21
    v_mfma_f32_16x16x32_bf16 v[176:179], a[144:147], v[36:39], v[176:179]
    v_exp_f32 v22, v22
    v_mfma_f32_16x16x32_bf16 v[180:183], a[148:151], v[36:39], v[180:183]
    v_mfma_f32_16x16x32_bf16 v[184:187], a[152:155], v[36:39], v[184:187]
    v_exp_f32 v23, v23
    v_mfma_f32_16x16x32_bf16 v[188:191], a[156:159], v[36:39], v[188:191]
    v_cvt_pk_bf16_f32 v35, v22, v23
    v_mfma_f32_16x16x32_bf16 a[236:239], a[248:251], v[36:39], a[236:239]
    s_waitcnt lgkmcnt(7)
    v_mfma_f32_16x16x32_bf16 v[16:19], a[96:99], a[0:3], 0
    s_waitcnt lgkmcnt(6)
    v_exp_f32 v24, v24
    v_mfma_f32_16x16x32_bf16 v[16:19], a[100:103], a[4:7], v[16:19]
    s_waitcnt lgkmcnt(5)
    v_mfma_f32_16x16x32_bf16 v[16:19], a[104:107], a[8:11], v[16:19]
    s_waitcnt lgkmcnt(4)
    v_exp_f32 v25, v25
    v_mfma_f32_16x16x32_bf16 v[16:19], a[108:111], a[12:15], v[16:19]
    s_waitcnt lgkmcnt(3)
    v_cvt_pk_bf16_f32 v36, v24, v25
    v_mfma_f32_16x16x32_bf16 v[20:23], a[112:115], a[0:3], 0
    s_waitcnt lgkmcnt(2)
    v_exp_f32 v26, v26
    v_mfma_f32_16x16x32_bf16 v[20:23], a[116:119], a[4:7], v[20:23]
    s_waitcnt lgkmcnt(1)
    v_mfma_f32_16x16x32_bf16 v[20:23], a[120:123], a[8:11], v[20:23]
    s_waitcnt lgkmcnt(0)
    v_exp_f32 v27, v27
    v_mfma_f32_16x16x32_bf16 v[20:23], a[124:127], a[12:15], v[20:23]
    v_cvt_pk_bf16_f32 v37, v26, v27
    v_mfma_f32_16x16x32_bf16 v[192:195], a[128:131], v[32:35], v[192:195]
    v_exp_f32 v28, v28
    v_mfma_f32_16x16x32_bf16 v[196:199], a[132:135], v[32:35], v[196:199]
    v_mfma_f32_16x16x32_bf16 v[200:203], a[136:139], v[32:35], v[200:203]
    v_exp_f32 v29, v29
    v_mfma_f32_16x16x32_bf16 v[204:207], a[140:143], v[32:35], v[204:207]
    v_cvt_pk_bf16_f32 v38, v28, v29
    v_mfma_f32_16x16x32_bf16 v[208:211], a[144:147], v[32:35], v[208:211]
    v_exp_f32 v30, v30
    v_mfma_f32_16x16x32_bf16 v[212:215], a[148:151], v[32:35], v[212:215]
    v_mfma_f32_16x16x32_bf16 v[216:219], a[152:155], v[32:35], v[216:219]
    v_exp_f32 v31, v31
    v_mfma_f32_16x16x32_bf16 v[220:223], a[156:159], v[32:35], v[220:223]
    v_cvt_pk_bf16_f32 v39, v30, v31
    v_mfma_f32_16x16x32_bf16 a[240:243], a[248:251], v[32:35], a[240:243]
    v_mfma_f32_16x16x32_bf16 v[24:27], a[96:99], a[16:19], 0
    v_exp_f32 v16, v16
    v_mfma_f32_16x16x32_bf16 v[24:27], a[100:103], a[20:23], v[24:27]
    v_mfma_f32_16x16x32_bf16 v[24:27], a[104:107], a[24:27], v[24:27]
    v_exp_f32 v17, v17
    v_mfma_f32_16x16x32_bf16 v[24:27], a[108:111], a[28:31], v[24:27]
    v_cvt_pk_bf16_f32 v32, v16, v17
    v_mfma_f32_16x16x32_bf16 v[28:31], a[112:115], a[16:19], 0
    v_exp_f32 v18, v18
    v_mfma_f32_16x16x32_bf16 v[28:31], a[116:119], a[20:23], v[28:31]
    v_mfma_f32_16x16x32_bf16 v[28:31], a[120:123], a[24:27], v[28:31]
    v_exp_f32 v19, v19
    v_mfma_f32_16x16x32_bf16 v[28:31], a[124:127], a[28:31], v[28:31]
    v_cvt_pk_bf16_f32 v33, v18, v19
    v_mfma_f32_16x16x32_bf16 v[224:227], a[128:131], v[36:39], v[224:227]
    v_exp_f32 v20, v20
    v_mfma_f32_16x16x32_bf16 v[228:231], a[132:135], v[36:39], v[228:231]
    ds_read_b64_tr_b16 a[128:129], v8 offset:0
    ds_read_b64_tr_b16 a[130:131], v8 offset:8192
    v_mfma_f32_16x16x32_bf16 v[232:235], a[136:139], v[36:39], v[232:235]
    v_exp_f32 v21, v21
    v_mfma_f32_16x16x32_bf16 v[236:239], a[140:143], v[36:39], v[236:239]
    ds_read_b64_tr_b16 a[132:133], v8 offset:8
    v_cvt_pk_bf16_f32 v34, v20, v21
    v_mfma_f32_16x16x32_bf16 v[240:243], a[144:147], v[36:39], v[240:243]
    v_exp_f32 v22, v22
    v_mfma_f32_16x16x32_bf16 v[244:247], a[148:151], v[36:39], v[244:247]
    ds_read_b64_tr_b16 a[134:135], v8 offset:8200
    ds_read_b64_tr_b16 a[136:137], v8 offset:256
    v_mfma_f32_16x16x32_bf16 v[248:251], a[152:155], v[36:39], v[248:251]
    v_exp_f32 v23, v23
    v_mfma_f32_16x16x32_bf16 v[252:255], a[156:159], v[36:39], v[252:255]
    ds_read_b64_tr_b16 a[138:139], v8 offset:8448
    v_cvt_pk_bf16_f32 v35, v22, v23
    v_mfma_f32_16x16x32_bf16 a[244:247], a[248:251], v[36:39], a[244:247]
    ds_read_b64_tr_b16 a[140:141], v8 offset:264
    ds_read_b64_tr_b16 a[142:143], v8 offset:8456
    v_mfma_f32_16x16x32_bf16 v[16:19], a[96:99], a[32:35], 0
    v_exp_f32 v24, v24
    v_mfma_f32_16x16x32_bf16 v[16:19], a[100:103], a[36:39], v[16:19]
    ds_read_b64_tr_b16 a[144:145], v8 offset:512
    ds_read_b64_tr_b16 a[146:147], v8 offset:8704
    v_mfma_f32_16x16x32_bf16 v[16:19], a[104:107], a[40:43], v[16:19]
    v_exp_f32 v25, v25
    v_mfma_f32_16x16x32_bf16 v[16:19], a[108:111], a[44:47], v[16:19]
    ds_read_b64_tr_b16 a[148:149], v8 offset:520
    v_cvt_pk_bf16_f32 v36, v24, v25
    v_mfma_f32_16x16x32_bf16 v[20:23], a[112:115], a[32:35], 0
    v_exp_f32 v26, v26
    v_mfma_f32_16x16x32_bf16 v[20:23], a[116:119], a[36:39], v[20:23]
    ds_read_b64_tr_b16 a[150:151], v8 offset:8712
    ds_read_b64_tr_b16 a[152:153], v8 offset:768
    v_mfma_f32_16x16x32_bf16 v[20:23], a[120:123], a[40:43], v[20:23]
    v_exp_f32 v27, v27
    v_mfma_f32_16x16x32_bf16 v[20:23], a[124:127], a[44:47], v[20:23]
    s_waitcnt lgkmcnt(11)
    ds_read_b64_tr_b16 a[154:155], v8 offset:8960
    v_cvt_pk_bf16_f32 v37, v26, v27
    v_mfma_f32_16x16x32_bf16 v[64:67], a[128:131], v[32:35], v[64:67]
    s_waitcnt lgkmcnt(10)
    v_exp_f32 v28, v28
    v_mfma_f32_16x16x32_bf16 v[68:71], a[132:135], v[32:35], v[68:71]
    s_waitcnt lgkmcnt(8)
    ds_read_b64_tr_b16 a[156:157], v8 offset:776
    ds_read_b64_tr_b16 a[158:159], v8 offset:8968
    v_mfma_f32_16x16x32_bf16 v[72:75], a[136:139], v[32:35], v[72:75]
    s_waitcnt lgkmcnt(8)
    v_exp_f32 v29, v29
    v_mfma_f32_16x16x32_bf16 v[76:79], a[140:143], v[32:35], v[76:79]
    s_waitcnt lgkmcnt(6)
    v_cvt_pk_bf16_f32 v38, v28, v29
    v_mfma_f32_16x16x32_bf16 v[80:83], a[144:147], v[32:35], v[80:83]
    s_waitcnt lgkmcnt(4)
    v_exp_f32 v30, v30
    v_mfma_f32_16x16x32_bf16 v[84:87], a[148:151], v[32:35], v[84:87]
    s_waitcnt lgkmcnt(2)
    v_mfma_f32_16x16x32_bf16 v[88:91], a[152:155], v[32:35], v[88:91]
    s_waitcnt lgkmcnt(0)
    v_exp_f32 v31, v31
    v_mfma_f32_16x16x32_bf16 v[92:95], a[156:159], v[32:35], v[92:95]
    v_cvt_pk_bf16_f32 v39, v30, v31
    v_mfma_f32_16x16x32_bf16 a[224:227], a[248:251], v[32:35], a[224:227]
    v_mfma_f32_16x16x32_bf16 v[24:27], a[96:99], a[48:51], 0
    s_add_u32 m0, s32, 98304
    v_exp_f32 v16, v16
    v_mfma_f32_16x16x32_bf16 v[24:27], a[100:103], a[52:55], v[24:27]
    buffer_load_dwordx4 v2, s[20:23], s62 offen offset:0 nt lds
    v_mfma_f32_16x16x32_bf16 v[24:27], a[104:107], a[56:59], v[24:27]
    v_exp_f32 v17, v17
    v_mfma_f32_16x16x32_bf16 v[24:27], a[108:111], a[60:63], v[24:27]
    v_cvt_pk_bf16_f32 v32, v16, v17
    v_mfma_f32_16x16x32_bf16 v[28:31], a[112:115], a[48:51], 0
    v_exp_f32 v18, v18
    v_mfma_f32_16x16x32_bf16 v[28:31], a[116:119], a[52:55], v[28:31]
    v_mfma_f32_16x16x32_bf16 v[28:31], a[120:123], a[56:59], v[28:31]
    v_exp_f32 v19, v19
    v_mfma_f32_16x16x32_bf16 v[28:31], a[124:127], a[60:63], v[28:31]
    v_cvt_pk_bf16_f32 v33, v18, v19
    v_mfma_f32_16x16x32_bf16 v[96:99], a[128:131], v[36:39], v[96:99]
    v_exp_f32 v20, v20
    v_mfma_f32_16x16x32_bf16 v[100:103], a[132:135], v[36:39], v[100:103]
    buffer_load_dwordx4 v2, s[20:23], s62 offen offset:1024 nt lds
    v_mfma_f32_16x16x32_bf16 v[104:107], a[136:139], v[36:39], v[104:107]
    v_exp_f32 v21, v21
    v_mfma_f32_16x16x32_bf16 v[108:111], a[140:143], v[36:39], v[108:111]
    v_cvt_pk_bf16_f32 v34, v20, v21
    v_mfma_f32_16x16x32_bf16 v[112:115], a[144:147], v[36:39], v[112:115]
    v_exp_f32 v22, v22
    v_mfma_f32_16x16x32_bf16 v[116:119], a[148:151], v[36:39], v[116:119]
    v_mfma_f32_16x16x32_bf16 v[120:123], a[152:155], v[36:39], v[120:123]
    v_exp_f32 v23, v23
    v_mfma_f32_16x16x32_bf16 v[124:127], a[156:159], v[36:39], v[124:127]
    v_cvt_pk_bf16_f32 v35, v22, v23
    v_mfma_f32_16x16x32_bf16 a[228:231], a[248:251], v[36:39], a[228:231]
    v_mfma_f32_16x16x32_bf16 v[16:19], a[96:99], a[64:67], 0
    v_exp_f32 v24, v24
    v_mfma_f32_16x16x32_bf16 v[16:19], a[100:103], a[68:71], v[16:19]
    buffer_load_dwordx4 v3, s[24:27], s62 offen offset:2048 nt lds
    v_mfma_f32_16x16x32_bf16 v[16:19], a[104:107], a[72:75], v[16:19]
    v_exp_f32 v25, v25
    v_mfma_f32_16x16x32_bf16 v[16:19], a[108:111], a[76:79], v[16:19]
    v_cvt_pk_bf16_f32 v36, v24, v25
    v_mfma_f32_16x16x32_bf16 v[20:23], a[112:115], a[64:67], 0
    v_exp_f32 v26, v26
    v_mfma_f32_16x16x32_bf16 v[20:23], a[116:119], a[68:71], v[20:23]
    v_mfma_f32_16x16x32_bf16 v[20:23], a[120:123], a[72:75], v[20:23]
    v_exp_f32 v27, v27
    v_mfma_f32_16x16x32_bf16 v[20:23], a[124:127], a[76:79], v[20:23]
    v_cvt_pk_bf16_f32 v37, v26, v27
    v_mfma_f32_16x16x32_bf16 v[128:131], a[128:131], v[32:35], v[128:131]
    v_exp_f32 v28, v28
    v_mfma_f32_16x16x32_bf16 v[132:135], a[132:135], v[32:35], v[132:135]
    buffer_load_dwordx4 v3, s[24:27], s62 offen offset:3072 nt lds
    v_mfma_f32_16x16x32_bf16 v[136:139], a[136:139], v[32:35], v[136:139]
    v_exp_f32 v29, v29
    v_mfma_f32_16x16x32_bf16 v[140:143], a[140:143], v[32:35], v[140:143]
    v_cvt_pk_bf16_f32 v38, v28, v29
    v_mfma_f32_16x16x32_bf16 v[144:147], a[144:147], v[32:35], v[144:147]
    v_exp_f32 v30, v30
    v_mfma_f32_16x16x32_bf16 v[148:151], a[148:151], v[32:35], v[148:151]
    v_mfma_f32_16x16x32_bf16 v[152:155], a[152:155], v[32:35], v[152:155]
    v_exp_f32 v31, v31
    v_mfma_f32_16x16x32_bf16 v[156:159], a[156:159], v[32:35], v[156:159]
    s_waitcnt vmcnt(4)
    v_cvt_pk_bf16_f32 v39, v30, v31
    v_mfma_f32_16x16x32_bf16 a[232:235], a[248:251], v[32:35], a[232:235]
    s_barrier
    v_mfma_f32_16x16x32_bf16 v[24:27], a[96:99], a[80:83], 0
    v_exp_f32 v16, v16
    v_mfma_f32_16x16x32_bf16 v[24:27], a[100:103], a[84:87], v[24:27]
    ds_read_b128 a[96:99], v5 offset:16384
    ds_read_b128 a[100:103], v5 offset:16640
    v_mfma_f32_16x16x32_bf16 v[24:27], a[104:107], a[88:91], v[24:27]
    v_exp_f32 v17, v17
    v_mfma_f32_16x16x32_bf16 v[24:27], a[108:111], a[92:95], v[24:27]
    ds_read_b128 a[104:107], v5 offset:16896
    v_cvt_pk_bf16_f32 v32, v16, v17
    v_mfma_f32_16x16x32_bf16 v[28:31], a[112:115], a[80:83], 0
    v_exp_f32 v18, v18
    v_mfma_f32_16x16x32_bf16 v[28:31], a[116:119], a[84:87], v[28:31]
    ds_read_b128 a[108:111], v5 offset:17152
    ds_read_b128 a[112:115], v5 offset:24576
    v_mfma_f32_16x16x32_bf16 v[28:31], a[120:123], a[88:91], v[28:31]
    v_exp_f32 v19, v19
    v_mfma_f32_16x16x32_bf16 v[28:31], a[124:127], a[92:95], v[28:31]
    ds_read_b128 a[116:119], v5 offset:24832
    v_cvt_pk_bf16_f32 v33, v18, v19
    v_mfma_f32_16x16x32_bf16 v[160:163], a[128:131], v[36:39], v[160:163]
    v_exp_f32 v20, v20
    v_mfma_f32_16x16x32_bf16 v[164:167], a[132:135], v[36:39], v[164:167]
    ds_read_b128 a[120:123], v5 offset:25088
    ds_read_b128 a[124:127], v5 offset:25344
    v_mfma_f32_16x16x32_bf16 v[168:171], a[136:139], v[36:39], v[168:171]
    v_exp_f32 v21, v21
    v_mfma_f32_16x16x32_bf16 v[172:175], a[140:143], v[36:39], v[172:175]
    v_cvt_pk_bf16_f32 v34, v20, v21
    v_mfma_f32_16x16x32_bf16 v[176:179], a[144:147], v[36:39], v[176:179]
    v_exp_f32 v22, v22
    v_mfma_f32_16x16x32_bf16 v[180:183], a[148:151], v[36:39], v[180:183]
    v_mfma_f32_16x16x32_bf16 v[184:187], a[152:155], v[36:39], v[184:187]
    v_exp_f32 v23, v23
    v_mfma_f32_16x16x32_bf16 v[188:191], a[156:159], v[36:39], v[188:191]
    v_cvt_pk_bf16_f32 v35, v22, v23
    v_mfma_f32_16x16x32_bf16 a[236:239], a[248:251], v[36:39], a[236:239]
    s_waitcnt lgkmcnt(7)
    v_mfma_f32_16x16x32_bf16 v[16:19], a[96:99], a[0:3], 0
    s_waitcnt lgkmcnt(6)
    v_exp_f32 v24, v24
    v_mfma_f32_16x16x32_bf16 v[16:19], a[100:103], a[4:7], v[16:19]
    s_waitcnt lgkmcnt(5)
    s_add_u32 m0, s32, 114688
    v_mfma_f32_16x16x32_bf16 v[16:19], a[104:107], a[8:11], v[16:19]
    s_waitcnt lgkmcnt(4)
    v_exp_f32 v25, v25
    v_mfma_f32_16x16x32_bf16 v[16:19], a[108:111], a[12:15], v[16:19]
    s_waitcnt lgkmcnt(3)
    v_cvt_pk_bf16_f32 v36, v24, v25
    v_mfma_f32_16x16x32_bf16 v[20:23], a[112:115], a[0:3], 0
    s_waitcnt lgkmcnt(2)
    v_exp_f32 v26, v26
    v_mfma_f32_16x16x32_bf16 v[20:23], a[116:119], a[4:7], v[20:23]
    s_waitcnt lgkmcnt(1)
    buffer_load_dwordx4 v2, s[20:23], s63 offen offset:0 nt lds
    v_mfma_f32_16x16x32_bf16 v[20:23], a[120:123], a[8:11], v[20:23]
    s_waitcnt lgkmcnt(0)
    v_exp_f32 v27, v27
    v_mfma_f32_16x16x32_bf16 v[20:23], a[124:127], a[12:15], v[20:23]
    v_cvt_pk_bf16_f32 v37, v26, v27
    v_mfma_f32_16x16x32_bf16 v[192:195], a[128:131], v[32:35], v[192:195]
    v_exp_f32 v28, v28
    v_mfma_f32_16x16x32_bf16 v[196:199], a[132:135], v[32:35], v[196:199]
    v_mfma_f32_16x16x32_bf16 v[200:203], a[136:139], v[32:35], v[200:203]
    v_exp_f32 v29, v29
    v_mfma_f32_16x16x32_bf16 v[204:207], a[140:143], v[32:35], v[204:207]
    v_cvt_pk_bf16_f32 v38, v28, v29
    v_mfma_f32_16x16x32_bf16 v[208:211], a[144:147], v[32:35], v[208:211]
    v_exp_f32 v30, v30
    v_mfma_f32_16x16x32_bf16 v[212:215], a[148:151], v[32:35], v[212:215]
    buffer_load_dwordx4 v2, s[20:23], s63 offen offset:1024 nt lds
    v_mfma_f32_16x16x32_bf16 v[216:219], a[152:155], v[32:35], v[216:219]
    v_exp_f32 v31, v31
    v_mfma_f32_16x16x32_bf16 v[220:223], a[156:159], v[32:35], v[220:223]
    v_cvt_pk_bf16_f32 v39, v30, v31
    v_mfma_f32_16x16x32_bf16 a[240:243], a[248:251], v[32:35], a[240:243]
    v_mfma_f32_16x16x32_bf16 v[24:27], a[96:99], a[16:19], 0
    v_exp_f32 v16, v16
    v_mfma_f32_16x16x32_bf16 v[24:27], a[100:103], a[20:23], v[24:27]
    v_mfma_f32_16x16x32_bf16 v[24:27], a[104:107], a[24:27], v[24:27]
    v_exp_f32 v17, v17
    v_mfma_f32_16x16x32_bf16 v[24:27], a[108:111], a[28:31], v[24:27]
    v_cvt_pk_bf16_f32 v32, v16, v17
    v_mfma_f32_16x16x32_bf16 v[28:31], a[112:115], a[16:19], 0
    v_exp_f32 v18, v18
    v_mfma_f32_16x16x32_bf16 v[28:31], a[116:119], a[20:23], v[28:31]
    buffer_load_dwordx4 v3, s[24:27], s63 offen offset:2048 nt lds
    v_mfma_f32_16x16x32_bf16 v[28:31], a[120:123], a[24:27], v[28:31]
    v_exp_f32 v19, v19
    v_mfma_f32_16x16x32_bf16 v[28:31], a[124:127], a[28:31], v[28:31]
    v_cvt_pk_bf16_f32 v33, v18, v19
    v_mfma_f32_16x16x32_bf16 v[224:227], a[128:131], v[36:39], v[224:227]
    v_exp_f32 v20, v20
    v_mfma_f32_16x16x32_bf16 v[228:231], a[132:135], v[36:39], v[228:231]
    ds_read_b64_tr_b16 a[128:129], v8 offset:16384
    ds_read_b64_tr_b16 a[130:131], v8 offset:24576
    v_mfma_f32_16x16x32_bf16 v[232:235], a[136:139], v[36:39], v[232:235]
    v_exp_f32 v21, v21
    v_mfma_f32_16x16x32_bf16 v[236:239], a[140:143], v[36:39], v[236:239]
    ds_read_b64_tr_b16 a[132:133], v8 offset:16392
    v_cvt_pk_bf16_f32 v34, v20, v21
    v_mfma_f32_16x16x32_bf16 v[240:243], a[144:147], v[36:39], v[240:243]
    v_exp_f32 v22, v22
    v_mfma_f32_16x16x32_bf16 v[244:247], a[148:151], v[36:39], v[244:247]
    ds_read_b64_tr_b16 a[134:135], v8 offset:24584
    ds_read_b64_tr_b16 a[136:137], v8 offset:16640
    v_mfma_f32_16x16x32_bf16 v[248:251], a[152:155], v[36:39], v[248:251]
    v_exp_f32 v23, v23
    v_mfma_f32_16x16x32_bf16 v[252:255], a[156:159], v[36:39], v[252:255]
    ds_read_b64_tr_b16 a[138:139], v8 offset:24832
    v_cvt_pk_bf16_f32 v35, v22, v23
    v_mfma_f32_16x16x32_bf16 a[244:247], a[248:251], v[36:39], a[244:247]
    ds_read_b64_tr_b16 a[140:141], v8 offset:16648
    ds_read_b64_tr_b16 a[142:143], v8 offset:24840
    v_mfma_f32_16x16x32_bf16 v[16:19], a[96:99], a[32:35], 0
    v_exp_f32 v24, v24
    v_mfma_f32_16x16x32_bf16 v[16:19], a[100:103], a[36:39], v[16:19]
    ds_read_b64_tr_b16 a[144:145], v8 offset:16896
    ds_read_b64_tr_b16 a[146:147], v8 offset:25088
    v_mfma_f32_16x16x32_bf16 v[16:19], a[104:107], a[40:43], v[16:19]
    v_exp_f32 v25, v25
    v_mfma_f32_16x16x32_bf16 v[16:19], a[108:111], a[44:47], v[16:19]
    ds_read_b64_tr_b16 a[148:149], v8 offset:16904
    v_cvt_pk_bf16_f32 v36, v24, v25
    v_mfma_f32_16x16x32_bf16 v[20:23], a[112:115], a[32:35], 0
    v_exp_f32 v26, v26
    v_mfma_f32_16x16x32_bf16 v[20:23], a[116:119], a[36:39], v[20:23]
    ds_read_b64_tr_b16 a[150:151], v8 offset:25096
    ds_read_b64_tr_b16 a[152:153], v8 offset:17152
    v_mfma_f32_16x16x32_bf16 v[20:23], a[120:123], a[40:43], v[20:23]
    v_exp_f32 v27, v27
    v_mfma_f32_16x16x32_bf16 v[20:23], a[124:127], a[44:47], v[20:23]
    s_waitcnt lgkmcnt(11)
    ds_read_b64_tr_b16 a[154:155], v8 offset:25344
    v_cvt_pk_bf16_f32 v37, v26, v27
    v_mfma_f32_16x16x32_bf16 v[64:67], a[128:131], v[32:35], v[64:67]
    s_waitcnt lgkmcnt(10)
    v_exp_f32 v28, v28
    v_mfma_f32_16x16x32_bf16 v[68:71], a[132:135], v[32:35], v[68:71]
    s_waitcnt lgkmcnt(8)
    ds_read_b64_tr_b16 a[156:157], v8 offset:17160
    ds_read_b64_tr_b16 a[158:159], v8 offset:25352
    v_mfma_f32_16x16x32_bf16 v[72:75], a[136:139], v[32:35], v[72:75]
    s_waitcnt lgkmcnt(8)
    v_exp_f32 v29, v29
    v_mfma_f32_16x16x32_bf16 v[76:79], a[140:143], v[32:35], v[76:79]
    s_waitcnt lgkmcnt(6)
    v_cvt_pk_bf16_f32 v38, v28, v29
    v_mfma_f32_16x16x32_bf16 v[80:83], a[144:147], v[32:35], v[80:83]
    s_waitcnt lgkmcnt(4)
    v_exp_f32 v30, v30
    v_mfma_f32_16x16x32_bf16 v[84:87], a[148:151], v[32:35], v[84:87]
    s_waitcnt lgkmcnt(2)
    buffer_load_dwordx4 v3, s[24:27], s63 offen offset:3072 nt lds
    v_mfma_f32_16x16x32_bf16 v[88:91], a[152:155], v[32:35], v[88:91]
    s_waitcnt lgkmcnt(0)
    v_exp_f32 v31, v31
    v_mfma_f32_16x16x32_bf16 v[92:95], a[156:159], v[32:35], v[92:95]
    v_cvt_pk_bf16_f32 v39, v30, v31
    v_mfma_f32_16x16x32_bf16 a[224:227], a[248:251], v[32:35], a[224:227]
    v_mfma_f32_16x16x32_bf16 v[24:27], a[96:99], a[48:51], 0
    v_exp_f32 v16, v16
    v_mfma_f32_16x16x32_bf16 v[24:27], a[100:103], a[52:55], v[24:27]
    buffer_load_dwordx4 a[160:163], v1, s[16:19], s50 offen offset:0 nt
    v_mfma_f32_16x16x32_bf16 v[24:27], a[104:107], a[56:59], v[24:27]
    v_exp_f32 v17, v17
    v_mfma_f32_16x16x32_bf16 v[24:27], a[108:111], a[60:63], v[24:27]
    v_cvt_pk_bf16_f32 v32, v16, v17
    v_mfma_f32_16x16x32_bf16 v[28:31], a[112:115], a[48:51], 0
    v_exp_f32 v18, v18
    v_mfma_f32_16x16x32_bf16 v[28:31], a[116:119], a[52:55], v[28:31]
    v_mfma_f32_16x16x32_bf16 v[28:31], a[120:123], a[56:59], v[28:31]
    v_exp_f32 v19, v19
    v_mfma_f32_16x16x32_bf16 v[28:31], a[124:127], a[60:63], v[28:31]
    v_cvt_pk_bf16_f32 v33, v18, v19
    v_mfma_f32_16x16x32_bf16 v[96:99], a[128:131], v[36:39], v[96:99]
    v_exp_f32 v20, v20
    v_mfma_f32_16x16x32_bf16 v[100:103], a[132:135], v[36:39], v[100:103]
    buffer_load_dwordx4 a[164:167], v1, s[16:19], s50 offen offset:64 nt
    v_mfma_f32_16x16x32_bf16 v[104:107], a[136:139], v[36:39], v[104:107]
    v_exp_f32 v21, v21
    v_mfma_f32_16x16x32_bf16 v[108:111], a[140:143], v[36:39], v[108:111]
    v_cvt_pk_bf16_f32 v34, v20, v21
    v_mfma_f32_16x16x32_bf16 v[112:115], a[144:147], v[36:39], v[112:115]
    v_exp_f32 v22, v22
    v_mfma_f32_16x16x32_bf16 v[116:119], a[148:151], v[36:39], v[116:119]
    v_mfma_f32_16x16x32_bf16 v[120:123], a[152:155], v[36:39], v[120:123]
    v_exp_f32 v23, v23
    v_mfma_f32_16x16x32_bf16 v[124:127], a[156:159], v[36:39], v[124:127]
    v_cvt_pk_bf16_f32 v35, v22, v23
    v_mfma_f32_16x16x32_bf16 a[228:231], a[248:251], v[36:39], a[228:231]
    v_mfma_f32_16x16x32_bf16 v[16:19], a[96:99], a[64:67], 0
    v_exp_f32 v24, v24
    v_mfma_f32_16x16x32_bf16 v[16:19], a[100:103], a[68:71], v[16:19]
    buffer_load_dwordx4 a[168:171], v1, s[16:19], s50 offen offset:128 nt
    v_mfma_f32_16x16x32_bf16 v[16:19], a[104:107], a[72:75], v[16:19]
    v_exp_f32 v25, v25
    v_mfma_f32_16x16x32_bf16 v[16:19], a[108:111], a[76:79], v[16:19]
    v_cvt_pk_bf16_f32 v36, v24, v25
    v_mfma_f32_16x16x32_bf16 v[20:23], a[112:115], a[64:67], 0
    v_exp_f32 v26, v26
    v_mfma_f32_16x16x32_bf16 v[20:23], a[116:119], a[68:71], v[20:23]
    v_mfma_f32_16x16x32_bf16 v[20:23], a[120:123], a[72:75], v[20:23]
    v_exp_f32 v27, v27
    v_mfma_f32_16x16x32_bf16 v[20:23], a[124:127], a[76:79], v[20:23]
    v_cvt_pk_bf16_f32 v37, v26, v27
    v_mfma_f32_16x16x32_bf16 v[128:131], a[128:131], v[32:35], v[128:131]
    v_exp_f32 v28, v28
    v_mfma_f32_16x16x32_bf16 v[132:135], a[132:135], v[32:35], v[132:135]
    buffer_load_dwordx4 a[172:175], v1, s[16:19], s50 offen offset:192 nt
    v_mfma_f32_16x16x32_bf16 v[136:139], a[136:139], v[32:35], v[136:139]
    v_exp_f32 v29, v29
    v_mfma_f32_16x16x32_bf16 v[140:143], a[140:143], v[32:35], v[140:143]
    v_cvt_pk_bf16_f32 v38, v28, v29
    v_mfma_f32_16x16x32_bf16 v[144:147], a[144:147], v[32:35], v[144:147]
    v_exp_f32 v30, v30
    v_mfma_f32_16x16x32_bf16 v[148:151], a[148:151], v[32:35], v[148:151]
    v_mfma_f32_16x16x32_bf16 v[152:155], a[152:155], v[32:35], v[152:155]
    v_exp_f32 v31, v31
    v_mfma_f32_16x16x32_bf16 v[156:159], a[156:159], v[32:35], v[156:159]
    s_waitcnt vmcnt(8)
    v_cvt_pk_bf16_f32 v39, v30, v31
    v_mfma_f32_16x16x32_bf16 a[232:235], a[248:251], v[32:35], a[232:235]
    s_barrier
    v_mfma_f32_16x16x32_bf16 v[24:27], a[96:99], a[80:83], 0
    v_exp_f32 v16, v16
    v_mfma_f32_16x16x32_bf16 v[24:27], a[100:103], a[84:87], v[24:27]
    ds_read_b128 a[96:99], v5 offset:32768
    ds_read_b128 a[100:103], v5 offset:33024
    v_mfma_f32_16x16x32_bf16 v[24:27], a[104:107], a[88:91], v[24:27]
    v_exp_f32 v17, v17
    v_mfma_f32_16x16x32_bf16 v[24:27], a[108:111], a[92:95], v[24:27]
    ds_read_b128 a[104:107], v5 offset:33280
    v_cvt_pk_bf16_f32 v32, v16, v17
    v_mfma_f32_16x16x32_bf16 v[28:31], a[112:115], a[80:83], 0
    v_exp_f32 v18, v18
    v_mfma_f32_16x16x32_bf16 v[28:31], a[116:119], a[84:87], v[28:31]
    ds_read_b128 a[108:111], v5 offset:33536
    ds_read_b128 a[112:115], v5 offset:40960
    v_mfma_f32_16x16x32_bf16 v[28:31], a[120:123], a[88:91], v[28:31]
L_m2:
    s_cbranch_execz L_back
    v_exp_f32 v19, v19
    v_mfma_f32_16x16x32_bf16 v[28:31], a[124:127], a[92:95], v[28:31]
    ds_read_b128 a[116:119], v5 offset:41216
    v_cvt_pk_bf16_f32 v33, v18, v19
    v_mfma_f32_16x16x32_bf16 v[160:163], a[128:131], v[36:39], v[160:163]
    v_exp_f32 v20, v20
    v_mfma_f32_16x16x32_bf16 v[164:167], a[132:135], v[36:39], v[164:167]
    ds_read_b128 a[120:123], v5 offset:41472
    ds_read_b128 a[124:127], v5 offset:41728
    v_mfma_f32_16x16x32_bf16 v[168:171], a[136:139], v[36:39], v[168:171]
    v_exp_f32 v21, v21
    v_mfma_f32_16x16x32_bf16 v[172:175], a[140:143], v[36:39], v[172:175]
    v_cvt_pk_bf16_f32 v34, v20, v21
    v_mfma_f32_16x16x32_bf16 v[176:179], a[144:147], v[36:39], v[176:179]
    v_exp_f32 v22, v22
    v_mfma_f32_16x16x32_bf16 v[180:183], a[148:151], v[36:39], v[180:183]
    v_mfma_f32_16x16x32_bf16 v[184:187], a[152:155], v[36:39], v[184:187]
    v_exp_f32 v23, v23
    v_mfma_f32_16x16x32_bf16 v[188:191], a[156:159], v[36:39], v[188:191]
    v_cvt_pk_bf16_f32 v35, v22, v23
    v_mfma_f32_16x16x32_bf16 a[236:239], a[248:251], v[36:39], a[236:239]
    s_waitcnt lgkmcnt(7)
    v_mfma_f32_16x16x32_bf16 v[16:19], a[96:99], a[0:3], 0
    s_waitcnt lgkmcnt(6)
    v_exp_f32 v24, v24
    v_mfma_f32_16x16x32_bf16 v[16:19], a[100:103], a[4:7], v[16:19]
    s_waitcnt lgkmcnt(5)
    s_add_u32 m0, s32, 131072
    v_mfma_f32_16x16x32_bf16 v[16:19], a[104:107], a[8:11], v[16:19]
    s_waitcnt lgkmcnt(4)
    v_exp_f32 v25, v25
    v_mfma_f32_16x16x32_bf16 v[16:19], a[108:111], a[12:15], v[16:19]
    s_waitcnt lgkmcnt(3)
    v_cvt_pk_bf16_f32 v36, v24, v25
    v_mfma_f32_16x16x32_bf16 v[20:23], a[112:115], a[0:3], 0
    s_waitcnt lgkmcnt(2)
    v_exp_f32 v26, v26
    v_mfma_f32_16x16x32_bf16 v[20:23], a[116:119], a[4:7], v[20:23]
    s_waitcnt lgkmcnt(1)
    buffer_load_dwordx4 v2, s[20:23], s64 offen offset:0 nt lds
    v_mfma_f32_16x16x32_bf16 v[20:23], a[120:123], a[8:11], v[20:23]
    s_waitcnt lgkmcnt(0)
    v_exp_f32 v27, v27
    v_mfma_f32_16x16x32_bf16 v[20:23], a[124:127], a[12:15], v[20:23]
    v_cvt_pk_bf16_f32 v37, v26, v27
    v_mfma_f32_16x16x32_bf16 v[192:195], a[128:131], v[32:35], v[192:195]
    v_exp_f32 v28, v28
    v_mfma_f32_16x16x32_bf16 v[196:199], a[132:135], v[32:35], v[196:199]
    v_mfma_f32_16x16x32_bf16 v[200:203], a[136:139], v[32:35], v[200:203]
    v_exp_f32 v29, v29
    v_mfma_f32_16x16x32_bf16 v[204:207], a[140:143], v[32:35], v[204:207]
    v_cvt_pk_bf16_f32 v38, v28, v29
    v_mfma_f32_16x16x32_bf16 v[208:211], a[144:147], v[32:35], v[208:211]
    v_exp_f32 v30, v30
    v_mfma_f32_16x16x32_bf16 v[212:215], a[148:151], v[32:35], v[212:215]
    v_mfma_f32_16x16x32_bf16 v[216:219], a[152:155], v[32:35], v[216:219]
    v_exp_f32 v31, v31
    v_mfma_f32_16x16x32_bf16 v[220:223], a[156:159], v[32:35], v[220:223]
    v_cvt_pk_bf16_f32 v39, v30, v31
    v_mfma_f32_16x16x32_bf16 a[240:243], a[248:251], v[32:35], a[240:243]
    v_mfma_f32_16x16x32_bf16 v[24:27], a[96:99], a[16:19], 0
    v_exp_f32 v16, v16
    v_mfma_f32_16x16x32_bf16 v[24:27], a[100:103], a[20:23], v[24:27]
    buffer_load_dwordx4 v2, s[20:23], s64 offen offset:1024 nt lds
    v_mfma_f32_16x16x32_bf16 v[24:27], a[104:107], a[24:27], v[24:27]
    v_exp_f32 v17, v17
    v_mfma_f32_16x16x32_bf16 v[24:27], a[108:111], a[28:31], v[24:27]
    v_cvt_pk_bf16_f32 v32, v16, v17
    v_mfma_f32_16x16x32_bf16 v[28:31], a[112:115], a[16:19], 0
    v_exp_f32 v18, v18
    v_mfma_f32_16x16x32_bf16 v[28:31], a[116:119], a[20:23], v[28:31]
    v_mfma_f32_16x16x32_bf16 v[28:31], a[120:123], a[24:27], v[28:31]
    v_exp_f32 v19, v19
    v_mfma_f32_16x16x32_bf16 v[28:31], a[124:127], a[28:31], v[28:31]
    v_cvt_pk_bf16_f32 v33, v18, v19
    v_mfma_f32_16x16x32_bf16 v[224:227], a[128:131], v[36:39], v[224:227]
    v_exp_f32 v20, v20
    v_mfma_f32_16x16x32_bf16 v[228:231], a[132:135], v[36:39], v[228:231]
    ds_read_b64_tr_b16 a[128:129], v8 offset:32768
    ds_read_b64_tr_b16 a[130:131], v8 offset:40960
    v_mfma_f32_16x16x32_bf16 v[232:235], a[136:139], v[36:39], v[232:235]
    v_exp_f32 v21, v21
    v_mfma_f32_16x16x32_bf16 v[236:239], a[140:143], v[36:39], v[236:239]
    ds_read_b64_tr_b16 a[132:133], v8 offset:32776
    v_cvt_pk_bf16_f32 v34, v20, v21
    v_mfma_f32_16x16x32_bf16 v[240:243], a[144:147], v[36:39], v[240:243]
    v_exp_f32 v22, v22
    v_mfma_f32_16x16x32_bf16 v[244:247], a[148:151], v[36:39], v[244:247]
    ds_read_b64_tr_b16 a[134:135], v8 offset:40968
    ds_read_b64_tr_b16 a[136:137], v8 offset:33024
    v_mfma_f32_16x16x32_bf16 v[248:251], a[152:155], v[36:39], v[248:251]
    v_exp_f32 v23, v23
    v_mfma_f32_16x16x32_bf16 v[252:255], a[156:159], v[36:39], v[252:255]
    ds_read_b64_tr_b16 a[138:139], v8 offset:41216
    v_cvt_pk_bf16_f32 v35, v22, v23
    v_mfma_f32_16x16x32_bf16 a[244:247], a[248:251], v[36:39], a[244:247]
    ds_read_b64_tr_b16 a[140:141], v8 offset:33032
    ds_read_b64_tr_b16 a[142:143], v8 offset:41224
    v_mfma_f32_16x16x32_bf16 v[16:19], a[96:99], a[32:35], 0
    v_exp_f32 v24, v24
    v_mfma_f32_16x16x32_bf16 v[16:19], a[100:103], a[36:39], v[16:19]
    ds_read_b64_tr_b16 a[144:145], v8 offset:33280
    ds_read_b64_tr_b16 a[146:147], v8 offset:41472
    v_mfma_f32_16x16x32_bf16 v[16:19], a[104:107], a[40:43], v[16:19]
    v_exp_f32 v25, v25
    v_mfma_f32_16x16x32_bf16 v[16:19], a[108:111], a[44:47], v[16:19]
    ds_read_b64_tr_b16 a[148:149], v8 offset:33288
    v_cvt_pk_bf16_f32 v36, v24, v25
    v_mfma_f32_16x16x32_bf16 v[20:23], a[112:115], a[32:35], 0
    v_exp_f32 v26, v26
    v_mfma_f32_16x16x32_bf16 v[20:23], a[116:119], a[36:39], v[20:23]
    ds_read_b64_tr_b16 a[150:151], v8 offset:41480
    ds_read_b64_tr_b16 a[152:153], v8 offset:33536
    v_mfma_f32_16x16x32_bf16 v[20:23], a[120:123], a[40:43], v[20:23]
    v_exp_f32 v27, v27
    v_mfma_f32_16x16x32_bf16 v[20:23], a[124:127], a[44:47], v[20:23]
    s_waitcnt lgkmcnt(11)
    ds_read_b64_tr_b16 a[154:155], v8 offset:41728
    v_cvt_pk_bf16_f32 v37, v26, v27
    v_mfma_f32_16x16x32_bf16 v[64:67], a[128:131], v[32:35], v[64:67]
    s_waitcnt lgkmcnt(10)
    v_exp_f32 v28, v28
    v_mfma_f32_16x16x32_bf16 v[68:71], a[132:135], v[32:35], v[68:71]
    s_waitcnt lgkmcnt(8)
    ds_read_b64_tr_b16 a[156:157], v8 offset:33544
    ds_read_b64_tr_b16 a[158:159], v8 offset:41736
    v_mfma_f32_16x16x32_bf16 v[72:75], a[136:139], v[32:35], v[72:75]
    s_waitcnt lgkmcnt(8)
    v_exp_f32 v29, v29
    v_mfma_f32_16x16x32_bf16 v[76:79], a[140:143], v[32:35], v[76:79]
    s_waitcnt lgkmcnt(6)
    v_cvt_pk_bf16_f32 v38, v28, v29
    v_mfma_f32_16x16x32_bf16 v[80:83], a[144:147], v[32:35], v[80:83]
    s_waitcnt lgkmcnt(4)
    v_exp_f32 v30, v30
    v_mfma_f32_16x16x32_bf16 v[84:87], a[148:151], v[32:35], v[84:87]
    s_waitcnt lgkmcnt(2)
    buffer_load_dwordx4 v3, s[24:27], s64 offen offset:2048 nt lds
    v_mfma_f32_16x16x32_bf16 v[88:91], a[152:155], v[32:35], v[88:91]
    s_waitcnt lgkmcnt(0)
    v_exp_f32 v31, v31
    v_mfma_f32_16x16x32_bf16 v[92:95], a[156:159], v[32:35], v[92:95]
    v_cvt_pk_bf16_f32 v39, v30, v31
    v_mfma_f32_16x16x32_bf16 a[224:227], a[248:251], v[32:35], a[224:227]
    v_mfma_f32_16x16x32_bf16 v[24:27], a[96:99], a[48:51], 0
    v_exp_f32 v16, v16
    v_mfma_f32_16x16x32_bf16 v[24:27], a[100:103], a[52:55], v[24:27]
    v_mfma_f32_16x16x32_bf16 v[24:27], a[104:107], a[56:59], v[24:27]
    v_exp_f32 v17, v17
    v_mfma_f32_16x16x32_bf16 v[24:27], a[108:111], a[60:63], v[24:27]
    v_cvt_pk_bf16_f32 v32, v16, v17
    v_mfma_f32_16x16x32_bf16 v[28:31], a[112:115], a[48:51], 0
    v_exp_f32 v18, v18
    v_mfma_f32_16x16x32_bf16 v[28:31], a[116:119], a[52:55], v[28:31]
    v_mfma_f32_16x16x32_bf16 v[28:31], a[120:123], a[56:59], v[28:31]
    v_exp_f32 v19, v19
    v_mfma_f32_16x16x32_bf16 v[28:31], a[124:127], a[60:63], v[28:31]
    v_cvt_pk_bf16_f32 v33, v18, v19
    v_mfma_f32_16x16x32_bf16 v[96:99], a[128:131], v[36:39], v[96:99]
    v_exp_f32 v20, v20
    v_mfma_f32_16x16x32_bf16 v[100:103], a[132:135], v[36:39], v[100:103]
    buffer_load_dwordx4 v3, s[24:27], s64 offen offset:3072 nt lds
    v_mfma_f32_16x16x32_bf16 v[104:107], a[136:139], v[36:39], v[104:107]
    v_exp_f32 v21, v21
    v_mfma_f32_16x16x32_bf16 v[108:111], a[140:143], v[36:39], v[108:111]
    v_cvt_pk_bf16_f32 v34, v20, v21
    v_mfma_f32_16x16x32_bf16 v[112:115], a[144:147], v[36:39], v[112:115]
    v_exp_f32 v22, v22
    v_mfma_f32_16x16x32_bf16 v[116:119], a[148:151], v[36:39], v[116:119]
    v_mfma_f32_16x16x32_bf16 v[120:123], a[152:155], v[36:39], v[120:123]
    v_exp_f32 v23, v23
    v_mfma_f32_16x16x32_bf16 v[124:127], a[156:159], v[36:39], v[124:127]
    v_cvt_pk_bf16_f32 v35, v22, v23
    v_mfma_f32_16x16x32_bf16 a[228:231], a[248:251], v[36:39], a[228:231]
    v_mfma_f32_16x16x32_bf16 v[16:19], a[96:99], a[64:67], 0
    s_add_u32 m0, s32, 147456
    v_exp_f32 v24, v24
    v_mfma_f32_16x16x32_bf16 v[16:19], a[100:103], a[68:71], v[16:19]
    buffer_load_dwordx4 v2, s[20:23], s65 offen offset:0 nt lds
    v_mfma_f32_16x16x32_bf16 v[16:19], a[104:107], a[72:75], v[16:19]
    v_exp_f32 v25, v25
    v_mfma_f32_16x16x32_bf16 v[16:19], a[108:111], a[76:79], v[16:19]
    v_cvt_pk_bf16_f32 v36, v24, v25
    v_mfma_f32_16x16x32_bf16 v[20:23], a[112:115], a[64:67], 0
    v_exp_f32 v26, v26
    v_mfma_f32_16x16x32_bf16 v[20:23], a[116:119], a[68:71], v[20:23]
    v_mfma_f32_16x16x32_bf16 v[20:23], a[120:123], a[72:75], v[20:23]
    v_exp_f32 v27, v27
    v_mfma_f32_16x16x32_bf16 v[20:23], a[124:127], a[76:79], v[20:23]
    v_cvt_pk_bf16_f32 v37, v26, v27
    v_mfma_f32_16x16x32_bf16 v[128:131], a[128:131], v[32:35], v[128:131]
    v_exp_f32 v28, v28
    v_mfma_f32_16x16x32_bf16 v[132:135], a[132:135], v[32:35], v[132:135]
    v_mfma_f32_16x16x32_bf16 v[136:139], a[136:139], v[32:35], v[136:139]
    v_exp_f32 v29, v29
    v_mfma_f32_16x16x32_bf16 v[140:143], a[140:143], v[32:35], v[140:143]
    v_cvt_pk_bf16_f32 v38, v28, v29
    v_mfma_f32_16x16x32_bf16 v[144:147], a[144:147], v[32:35], v[144:147]
    v_exp_f32 v30, v30
    v_mfma_f32_16x16x32_bf16 v[148:151], a[148:151], v[32:35], v[148:151]
    v_mfma_f32_16x16x32_bf16 v[152:155], a[152:155], v[32:35], v[152:155]
    v_exp_f32 v31, v31
    v_mfma_f32_16x16x32_bf16 v[156:159], a[156:159], v[32:35], v[156:159]
    s_waitcnt vmcnt(9)
    v_cvt_pk_bf16_f32 v39, v30, v31
    v_mfma_f32_16x16x32_bf16 a[232:235], a[248:251], v[32:35], a[232:235]
    s_barrier
    v_mfma_f32_16x16x32_bf16 v[24:27], a[96:99], a[80:83], 0
    v_exp_f32 v16, v16
    v_mfma_f32_16x16x32_bf16 v[24:27], a[100:103], a[84:87], v[24:27]
    ds_read_b128 a[96:99], v5 offset:49152
    ds_read_b128 a[100:103], v5 offset:49408
    v_mfma_f32_16x16x32_bf16 v[24:27], a[104:107], a[88:91], v[24:27]
    v_exp_f32 v17, v17
    v_mfma_f32_16x16x32_bf16 v[24:27], a[108:111], a[92:95], v[24:27]
    ds_read_b128 a[104:107], v5 offset:49664
    v_cvt_pk_bf16_f32 v32, v16, v17
    v_mfma_f32_16x16x32_bf16 v[28:31], a[112:115], a[80:83], 0
    v_exp_f32 v18, v18
    v_mfma_f32_16x16x32_bf16 v[28:31], a[116:119], a[84:87], v[28:31]
    ds_read_b128 a[108:111], v5 offset:49920
    ds_read_b128 a[112:115], v5 offset:57344
    v_mfma_f32_16x16x32_bf16 v[28:31], a[120:123], a[88:91], v[28:31]
    v_exp_f32 v19, v19
    v_mfma_f32_16x16x32_bf16 v[28:31], a[124:127], a[92:95], v[28:31]
    ds_read_b128 a[116:119], v5 offset:57600
    v_cvt_pk_bf16_f32 v33, v18, v19
    v_mfma_f32_16x16x32_bf16 v[160:163], a[128:131], v[36:39], v[160:163]
    v_exp_f32 v20, v20
    v_mfma_f32_16x16x32_bf16 v[164:167], a[132:135], v[36:39], v[164:167]
    ds_read_b128 a[120:123], v5 offset:57856
    ds_read_b128 a[124:127], v5 offset:58112
    v_mfma_f32_16x16x32_bf16 v[168:171], a[136:139], v[36:39], v[168:171]
    v_exp_f32 v21, v21
    v_mfma_f32_16x16x32_bf16 v[172:175], a[140:143], v[36:39], v[172:175]
    v_cvt_pk_bf16_f32 v34, v20, v21
    v_mfma_f32_16x16x32_bf16 v[176:179], a[144:147], v[36:39], v[176:179]
    v_exp_f32 v22, v22
    v_mfma_f32_16x16x32_bf16 v[180:183], a[148:151], v[36:39], v[180:183]
    buffer_load_dwordx4 v2, s[20:23], s65 offen offset:1024 nt lds
    v_mfma_f32_16x16x32_bf16 v[184:187], a[152:155], v[36:39], v[184:187]
    v_exp_f32 v23, v23
    v_mfma_f32_16x16x32_bf16 v[188:191], a[156:159], v[36:39], v[188:191]
    v_cvt_pk_bf16_f32 v35, v22, v23
    v_mfma_f32_16x16x32_bf16 a[236:239], a[248:251], v[36:39], a[236:239]
    s_waitcnt lgkmcnt(7)
    v_mfma_f32_16x16x32_bf16 v[16:19], a[96:99], a[0:3], 0
    s_waitcnt lgkmcnt(6)
    v_exp_f32 v24, v24
    v_mfma_f32_16x16x32_bf16 v[16:19], a[100:103], a[4:7], v[16:19]
    s_waitcnt lgkmcnt(5)
    v_mfma_f32_16x16x32_bf16 v[16:19], a[104:107], a[8:11], v[16:19]
    s_waitcnt lgkmcnt(4)
    v_exp_f32 v25, v25
    v_mfma_f32_16x16x32_bf16 v[16:19], a[108:111], a[12:15], v[16:19]
    s_waitcnt lgkmcnt(3)
    v_cvt_pk_bf16_f32 v36, v24, v25
    v_mfma_f32_16x16x32_bf16 v[20:23], a[112:115], a[0:3], 0
    s_waitcnt lgkmcnt(2)
    v_exp_f32 v26, v26
    v_mfma_f32_16x16x32_bf16 v[20:23], a[116:119], a[4:7], v[20:23]
    s_waitcnt lgkmcnt(1)
    v_mfma_f32_16x16x32_bf16 v[20:23], a[120:123], a[8:11], v[20:23]
    s_waitcnt lgkmcnt(0)
    v_exp_f32 v27, v27
    v_mfma_f32_16x16x32_bf16 v[20:23], a[124:127], a[12:15], v[20:23]
    v_cvt_pk_bf16_f32 v37, v26, v27
    v_mfma_f32_16x16x32_bf16 v[192:195], a[128:131], v[32:35], v[192:195]
    v_exp_f32 v28, v28
    v_mfma_f32_16x16x32_bf16 v[196:199], a[132:135], v[32:35], v[196:199]
    buffer_load_dwordx4 v3, s[24:27], s65 offen offset:2048 nt lds
    v_mfma_f32_16x16x32_bf16 v[200:203], a[136:139], v[32:35], v[200:203]
    v_exp_f32 v29, v29
    v_mfma_f32_16x16x32_bf16 v[204:207], a[140:143], v[32:35], v[204:207]
    v_cvt_pk_bf16_f32 v38, v28, v29
    v_mfma_f32_16x16x32_bf16 v[208:211], a[144:147], v[32:35], v[208:211]
    v_exp_f32 v30, v30
    v_mfma_f32_16x16x32_bf16 v[212:215], a[148:151], v[32:35], v[212:215]
    v_mfma_f32_16x16x32_bf16 v[216:219], a[152:155], v[32:35], v[216:219]
    v_exp_f32 v31, v31
    v_mfma_f32_16x16x32_bf16 v[220:223], a[156:159], v[32:35], v[220:223]
    v_cvt_pk_bf16_f32 v39, v30, v31
    v_mfma_f32_16x16x32_bf16 a[240:243], a[248:251], v[32:35], a[240:243]
    v_mfma_f32_16x16x32_bf16 v[24:27], a[96:99], a[16:19], 0
    v_exp_f32 v16, v16
    v_mfma_f32_16x16x32_bf16 v[24:27], a[100:103], a[20:23], v[24:27]
    v_mfma_f32_16x16x32_bf16 v[24:27], a[104:107], a[24:27], v[24:27]
    v_exp_f32 v17, v17
    v_mfma_f32_16x16x32_bf16 v[24:27], a[108:111], a[28:31], v[24:27]
    v_cvt_pk_bf16_f32 v32, v16, v17
    v_mfma_f32_16x16x32_bf16 v[28:31], a[112:115], a[16:19], 0
    v_exp_f32 v18, v18
    v_mfma_f32_16x16x32_bf16 v[28:31], a[116:119], a[20:23], v[28:31]
    buffer_load_dwordx4 v3, s[24:27], s65 offen offset:3072 nt lds
    v_mfma_f32_16x16x32_bf16 v[28:31], a[120:123], a[24:27], v[28:31]
    v_exp_f32 v19, v19
    v_mfma_f32_16x16x32_bf16 v[28:31], a[124:127], a[28:31], v[28:31]
    v_cvt_pk_bf16_f32 v33, v18, v19
    v_mfma_f32_16x16x32_bf16 v[224:227], a[128:131], v[36:39], v[224:227]
    v_exp_f32 v20, v20
    v_mfma_f32_16x16x32_bf16 v[228:231], a[132:135], v[36:39], v[228:231]
    ds_read_b64_tr_b16 a[128:129], v8 offset:49152
    ds_read_b64_tr_b16 a[130:131], v8 offset:57344
    v_mfma_f32_16x16x32_bf16 v[232:235], a[136:139], v[36:39], v[232:235]
    v_exp_f32 v21, v21
    v_mfma_f32_16x16x32_bf16 v[236:239], a[140:143], v[36:39], v[236:239]
    ds_read_b64_tr_b16 a[132:133], v8 offset:49160
    v_cvt_pk_bf16_f32 v34, v20, v21
    v_mfma_f32_16x16x32_bf16 v[240:243], a[144:147], v[36:39], v[240:243]
    v_exp_f32 v22, v22
    v_mfma_f32_16x16x32_bf16 v[244:247], a[148:151], v[36:39], v[244:247]
    ds_read_b64_tr_b16 a[134:135], v8 offset:57352
    ds_read_b64_tr_b16 a[136:137], v8 offset:49408
    v_mfma_f32_16x16x32_bf16 v[248:251], a[152:155], v[36:39], v[248:251]
    v_exp_f32 v23, v23
    v_mfma_f32_16x16x32_bf16 v[252:255], a[156:159], v[36:39], v[252:255]
    ds_read_b64_tr_b16 a[138:139], v8 offset:57600
    v_cvt_pk_bf16_f32 v35, v22, v23
    v_mfma_f32_16x16x32_bf16 a[244:247], a[248:251], v[36:39], a[244:247]
    ds_read_b64_tr_b16 a[140:141], v8 offset:49416
    ds_read_b64_tr_b16 a[142:143], v8 offset:57608
    v_mfma_f32_16x16x32_bf16 v[16:19], a[96:99], a[32:35], 0
    v_exp_f32 v24, v24
    v_mfma_f32_16x16x32_bf16 v[16:19], a[100:103], a[36:39], v[16:19]
    ds_read_b64_tr_b16 a[144:145], v8 offset:49664
    ds_read_b64_tr_b16 a[146:147], v8 offset:57856
    v_mfma_f32_16x16x32_bf16 v[16:19], a[104:107], a[40:43], v[16:19]
    v_exp_f32 v25, v25
    v_mfma_f32_16x16x32_bf16 v[16:19], a[108:111], a[44:47], v[16:19]
    ds_read_b64_tr_b16 a[148:149], v8 offset:49672
    v_cvt_pk_bf16_f32 v36, v24, v25
    v_mfma_f32_16x16x32_bf16 v[20:23], a[112:115], a[32:35], 0
    v_exp_f32 v26, v26
    v_mfma_f32_16x16x32_bf16 v[20:23], a[116:119], a[36:39], v[20:23]
    ds_read_b64_tr_b16 a[150:151], v8 offset:57864
    ds_read_b64_tr_b16 a[152:153], v8 offset:49920
    v_mfma_f32_16x16x32_bf16 v[20:23], a[120:123], a[40:43], v[20:23]
    v_exp_f32 v27, v27
    v_mfma_f32_16x16x32_bf16 v[20:23], a[124:127], a[44:47], v[20:23]
    s_waitcnt lgkmcnt(11)
    ds_read_b64_tr_b16 a[154:155], v8 offset:58112
    v_cvt_pk_bf16_f32 v37, v26, v27
    v_mfma_f32_16x16x32_bf16 v[64:67], a[128:131], v[32:35], v[64:67]
    s_waitcnt lgkmcnt(10)
    v_exp_f32 v28, v28
    v_mfma_f32_16x16x32_bf16 v[68:71], a[132:135], v[32:35], v[68:71]
    s_waitcnt lgkmcnt(8)
    ds_read_b64_tr_b16 a[156:157], v8 offset:49928
    ds_read_b64_tr_b16 a[158:159], v8 offset:58120
    v_mfma_f32_16x16x32_bf16 v[72:75], a[136:139], v[32:35], v[72:75]
    s_waitcnt lgkmcnt(8)
    v_exp_f32 v29, v29
    v_mfma_f32_16x16x32_bf16 v[76:79], a[140:143], v[32:35], v[76:79]
    s_waitcnt lgkmcnt(6)
    s_waitcnt vmcnt(8)
    v_cvt_pk_bf16_f32 v38, v28, v29
    v_mfma_f32_16x16x32_bf16 v[80:83], a[144:147], v[32:35], v[80:83]
    s_waitcnt lgkmcnt(4)
    v_exp_f32 v30, v30
    v_mfma_f32_16x16x32_bf16 v[84:87], a[148:151], v[32:35], v[84:87]
    s_waitcnt lgkmcnt(2)
    buffer_load_dwordx4 a[176:179], v1, s[16:19], s51 offen offset:0 nt
    v_mfma_f32_16x16x32_bf16 v[88:91], a[152:155], v[32:35], v[88:91]
    s_waitcnt lgkmcnt(0)
    v_exp_f32 v31, v31
    v_mfma_f32_16x16x32_bf16 v[92:95], a[156:159], v[32:35], v[92:95]
    v_cvt_pk_bf16_f32 v39, v30, v31
    v_accvgpr_read_b32 v41, a160
    v_mfma_f32_16x16x32_bf16 a[224:227], a[248:251], v[32:35], a[224:227]
    v_lshlrev_b32 v40, 16, v41
    v_and_b32 v41, s35, v41
    v_mfma_f32_16x16x32_bf16 v[24:27], a[96:99], a[48:51], 0
    v_exp_f32 v16, v16
    v_mfma_f32_16x16x32_bf16 v[24:27], a[100:103], a[52:55], v[24:27]
    v_mul_f32 v40, s34, v40
    v_mul_f32 v41, s34, v41
    v_mfma_f32_16x16x32_bf16 v[24:27], a[104:107], a[56:59], v[24:27]
    v_exp_f32 v17, v17
    v_mfma_f32_16x16x32_bf16 v[24:27], a[108:111], a[60:63], v[24:27]
    v_cvt_pk_bf16_f32 v32, v16, v17
    v_cvt_pk_bf16_f32 v40, v40, v41
    v_mfma_f32_16x16x32_bf16 v[28:31], a[112:115], a[48:51], 0
    v_exp_f32 v18, v18
    v_mfma_f32_16x16x32_bf16 v[28:31], a[116:119], a[52:55], v[28:31]
    v_accvgpr_write_b32 a160, v40
    v_accvgpr_read_b32 v41, a161
    v_mfma_f32_16x16x32_bf16 v[28:31], a[120:123], a[56:59], v[28:31]
    v_exp_f32 v19, v19
    v_mfma_f32_16x16x32_bf16 v[28:31], a[124:127], a[60:63], v[28:31]
    v_cvt_pk_bf16_f32 v33, v18, v19
    v_lshlrev_b32 v40, 16, v41
    v_mfma_f32_16x16x32_bf16 v[96:99], a[128:131], v[36:39], v[96:99]
    v_exp_f32 v20, v20
    v_mfma_f32_16x16x32_bf16 v[100:103], a[132:135], v[36:39], v[100:103]
    buffer_load_dwordx4 a[180:183], v1, s[16:19], s51 offen offset:64 nt
    v_mfma_f32_16x16x32_bf16 v[104:107], a[136:139], v[36:39], v[104:107]
    v_exp_f32 v21, v21
    v_mfma_f32_16x16x32_bf16 v[108:111], a[140:143], v[36:39], v[108:111]
    v_cvt_pk_bf16_f32 v34, v20, v21
    v_and_b32 v41, s35, v41
    v_mul_f32 v40, s34, v40
    v_mfma_f32_16x16x32_bf16 v[112:115], a[144:147], v[36:39], v[112:115]
    v_exp_f32 v22, v22
    v_mfma_f32_16x16x32_bf16 v[116:119], a[148:151], v[36:39], v[116:119]
    v_mul_f32 v41, s34, v41
    v_cvt_pk_bf16_f32 v40, v40, v41
    v_mfma_f32_16x16x32_bf16 v[120:123], a[152:155], v[36:39], v[120:123]
    v_exp_f32 v23, v23
    v_mfma_f32_16x16x32_bf16 v[124:127], a[156:159], v[36:39], v[124:127]
    v_cvt_pk_bf16_f32 v35, v22, v23
    v_accvgpr_write_b32 a161, v40
    v_mfma_f32_16x16x32_bf16 a[228:231], a[248:251], v[36:39], a[228:231]
    v_accvgpr_read_b32 v41, a162
    v_lshlrev_b32 v40, 16, v41
    v_mfma_f32_16x16x32_bf16 v[16:19], a[96:99], a[64:67], 0
    v_exp_f32 v24, v24
    v_mfma_f32_16x16x32_bf16 v[16:19], a[100:103], a[68:71], v[16:19]
    v_and_b32 v41, s35, v41
    v_mul_f32 v40, s34, v40
    v_mfma_f32_16x16x32_bf16 v[16:19], a[104:107], a[72:75], v[16:19]
    v_exp_f32 v25, v25
    v_mfma_f32_16x16x32_bf16 v[16:19], a[108:111], a[76:79], v[16:19]
    v_cvt_pk_bf16_f32 v36, v24, v25
    v_mul_f32 v41, s34, v41
    v_mfma_f32_16x16x32_bf16 v[20:23], a[112:115], a[64:67], 0
    v_exp_f32 v26, v26
    v_mfma_f32_16x16x32_bf16 v[20:23], a[116:119], a[68:71], v[20:23]
    buffer_load_dwordx4 a[184:187], v1, s[16:19], s51 offen offset:128 nt
    v_mfma_f32_16x16x32_bf16 v[20:23], a[120:123], a[72:75], v[20:23]
    v_exp_f32 v27, v27
    v_mfma_f32_16x16x32_bf16 v[20:23], a[124:127], a[76:79], v[20:23]
    v_cvt_pk_bf16_f32 v37, v26, v27
    v_cvt_pk_bf16_f32 v40, v40, v41
    v_mfma_f32_16x16x32_bf16 v[128:131], a[128:131], v[32:35], v[128:131]
    v_exp_f32 v28, v28
    v_mfma_f32_16x16x32_bf16 v[132:135], a[132:135], v[32:35], v[132:135]
    v_accvgpr_write_b32 a162, v40
    v_accvgpr_read_b32 v41, a163
    v_mfma_f32_16x16x32_bf16 v[136:139], a[136:139], v[32:35], v[136:139]
    v_exp_f32 v29, v29
    v_mfma_f32_16x16x32_bf16 v[140:143], a[140:143], v[32:35], v[140:143]
    v_cvt_pk_bf16_f32 v38, v28, v29
    v_lshlrev_b32 v40, 16, v41
    v_and_b32 v41, s35, v41
    v_mfma_f32_16x16x32_bf16 v[144:147], a[144:147], v[32:35], v[144:147]
    v_exp_f32 v30, v30
    v_mfma_f32_16x16x32_bf16 v[148:151], a[148:151], v[32:35], v[148:151]
    v_mul_f32 v40, s34, v40
    v_mul_f32 v41, s34, v41
    v_mfma_f32_16x16x32_bf16 v[152:155], a[152:155], v[32:35], v[152:155]
    v_exp_f32 v31, v31
    v_mfma_f32_16x16x32_bf16 v[156:159], a[156:159], v[32:35], v[156:159]
    s_waitcnt vmcnt(7)
    v_cvt_pk_bf16_f32 v39, v30, v31
    v_cvt_pk_bf16_f32 v40, v40, v41
    v_mfma_f32_16x16x32_bf16 a[232:235], a[248:251], v[32:35], a[232:235]
    s_barrier
    v_mfma_f32_16x16x32_bf16 v[24:27], a[96:99], a[80:83], 0
    v_exp_f32 v16, v16
    v_mfma_f32_16x16x32_bf16 v[24:27], a[100:103], a[84:87], v[24:27]
    ds_read_b128 a[96:99], v6 offset:0
    ds_read_b128 a[100:103], v6 offset:256
    v_mfma_f32_16x16x32_bf16 v[24:27], a[104:107], a[88:91], v[24:27]
    v_exp_f32 v17, v17
    v_mfma_f32_16x16x32_bf16 v[24:27], a[108:111], a[92:95], v[24:27]
    ds_read_b128 a[104:107], v6 offset:512
    v_cvt_pk_bf16_f32 v32, v16, v17
    v_mfma_f32_16x16x32_bf16 v[28:31], a[112:115], a[80:83], 0
    v_exp_f32 v18, v18
    v_mfma_f32_16x16x32_bf16 v[28:31], a[116:119], a[84:87], v[28:31]
    ds_read_b128 a[108:111], v6 offset:768
    ds_read_b128 a[112:115], v6 offset:8192
    v_mfma_f32_16x16x32_bf16 v[28:31], a[120:123], a[88:91], v[28:31]
    v_exp_f32 v19, v19
    v_mfma_f32_16x16x32_bf16 v[28:31], a[124:127], a[92:95], v[28:31]
    ds_read_b128 a[116:119], v6 offset:8448
    v_cvt_pk_bf16_f32 v33, v18, v19
    v_mfma_f32_16x16x32_bf16 v[160:163], a[128:131], v[36:39], v[160:163]
    v_exp_f32 v20, v20
    v_mfma_f32_16x16x32_bf16 v[164:167], a[132:135], v[36:39], v[164:167]
    ds_read_b128 a[120:123], v6 offset:8704
    ds_read_b128 a[124:127], v6 offset:8960
    v_mfma_f32_16x16x32_bf16 v[168:171], a[136:139], v[36:39], v[168:171]
    v_exp_f32 v21, v21
    v_mfma_f32_16x16x32_bf16 v[172:175], a[140:143], v[36:39], v[172:175]
    v_cvt_pk_bf16_f32 v34, v20, v21
    v_accvgpr_write_b32 a163, v40
    v_mfma_f32_16x16x32_bf16 v[176:179], a[144:147], v[36:39], v[176:179]
    v_exp_f32 v22, v22
    v_accvgpr_read_b32 v41, a164
    v_mfma_f32_16x16x32_bf16 v[180:183], a[148:151], v[36:39], v[180:183]
    buffer_load_dwordx4 a[188:191], v1, s[16:19], s51 offen offset:192 nt
    v_mfma_f32_16x16x32_bf16 v[184:187], a[152:155], v[36:39], v[184:187]
    v_exp_f32 v23, v23
    v_mfma_f32_16x16x32_bf16 v[188:191], a[156:159], v[36:39], v[188:191]
    v_cvt_pk_bf16_f32 v35, v22, v23
    v_lshlrev_b32 v40, 16, v41
    v_mfma_f32_16x16x32_bf16 a[236:239], a[248:251], v[36:39], a[236:239]
    s_waitcnt lgkmcnt(7)
    v_and_b32 v41, s35, v41
    v_mul_f32 v40, s34, v40
    v_mfma_f32_16x16x32_bf16 v[16:19], a[96:99], a[0:3], 0
    s_waitcnt lgkmcnt(6)
    v_exp_f32 v24, v24
    v_mfma_f32_16x16x32_bf16 v[16:19], a[100:103], a[4:7], v[16:19]
    s_waitcnt lgkmcnt(5)
    s_add_u32 m0, s32, 0
    v_mul_f32 v41, s34, v41
    v_mfma_f32_16x16x32_bf16 v[16:19], a[104:107], a[8:11], v[16:19]
    s_waitcnt lgkmcnt(4)
    v_exp_f32 v25, v25
    v_mfma_f32_16x16x32_bf16 v[16:19], a[108:111], a[12:15], v[16:19]
    s_waitcnt lgkmcnt(3)
    v_cvt_pk_bf16_f32 v36, v24, v25
    v_cvt_pk_bf16_f32 v40, v40, v41
    v_mfma_f32_16x16x32_bf16 v[20:23], a[112:115], a[0:3], 0
    s_waitcnt lgkmcnt(2)
    v_exp_f32 v26, v26
    v_mfma_f32_16x16x32_bf16 v[20:23], a[116:119], a[4:7], v[20:23]
    s_waitcnt lgkmcnt(1)
    buffer_load_dwordx4 v2, s[20:23], s66 offen offset:0 nt lds
    v_mfma_f32_16x16x32_bf16 v[20:23], a[120:123], a[8:11], v[20:23]
    s_waitcnt lgkmcnt(0)
    v_exp_f32 v27, v27
    v_mfma_f32_16x16x32_bf16 v[20:23], a[124:127], a[12:15], v[20:23]
    v_cvt_pk_bf16_f32 v37, v26, v27
    v_accvgpr_write_b32 a164, v40
    v_mfma_f32_16x16x32_bf16 v[192:195], a[128:131], v[32:35], v[192:195]
    v_exp_f32 v28, v28
    v_mfma_f32_16x16x32_bf16 v[196:199], a[132:135], v[32:35], v[196:199]
    v_accvgpr_read_b32 v41, a165
    v_lshlrev_b32 v40, 16, v41
    v_mfma_f32_16x16x32_bf16 v[200:203], a[136:139], v[32:35], v[200:203]
    v_exp_f32 v29, v29
    v_mfma_f32_16x16x32_bf16 v[204:207], a[140:143], v[32:35], v[204:207]
    v_cvt_pk_bf16_f32 v38, v28, v29
    v_and_b32 v41, s35, v41
    v_mfma_f32_16x16x32_bf16 v[208:211], a[144:147], v[32:35], v[208:211]
    v_exp_f32 v30, v30
    v_mfma_f32_16x16x32_bf16 v[212:215], a[148:151], v[32:35], v[212:215]
    v_mul_f32 v40, s34, v40
    v_mul_f32 v41, s34, v41
    v_cvt_pk_bf16_f32 v40, v40, v41
    v_mfma_f32_16x16x32_bf16 v[216:219], a[152:155], v[32:35], v[216:219]
    v_exp_f32 v31, v31
    v_mfma_f32_16x16x32_bf16 v[220:223], a[156:159], v[32:35], v[220:223]
    v_cvt_pk_bf16_f32 v39, v30, v31
    v_accvgpr_write_b32 a165, v40
    v_mfma_f32_16x16x32_bf16 a[240:243], a[248:251], v[32:35], a[240:243]
    v_accvgpr_read_b32 v41, a166
    v_lshlrev_b32 v40, 16, v41
    v_mfma_f32_16x16x32_bf16 v[24:27], a[96:99], a[16:19], 0
    v_exp_f32 v16, v16
    v_mfma_f32_16x16x32_bf16 v[24:27], a[100:103], a[20:23], v[24:27]
    buffer_load_dwordx4 v2, s[20:23], s66 offen offset:1024 nt lds
    v_mfma_f32_16x16x32_bf16 v[24:27], a[104:107], a[24:27], v[24:27]
    v_exp_f32 v17, v17
    v_mfma_f32_16x16x32_bf16 v[24:27], a[108:111], a[28:31], v[24:27]
    v_cvt_pk_bf16_f32 v32, v16, v17
    v_and_b32 v41, s35, v41
    v_mfma_f32_16x16x32_bf16 v[28:31], a[112:115], a[16:19], 0
    v_exp_f32 v18, v18
    v_mfma_f32_16x16x32_bf16 v[28:31], a[116:119], a[20:23], v[28:31]
    v_mul_f32 v40, s34, v40
    v_mul_f32 v41, s34, v41
    v_mfma_f32_16x16x32_bf16 v[28:31], a[120:123], a[24:27], v[28:31]
    v_exp_f32 v19, v19
    v_mfma_f32_16x16x32_bf16 v[28:31], a[124:127], a[28:31], v[28:31]
    v_cvt_pk_bf16_f32 v33, v18, v19
    v_cvt_pk_bf16_f32 v40, v40, v41
    v_mfma_f32_16x16x32_bf16 v[224:227], a[128:131], v[36:39], v[224:227]
    v_exp_f32 v20, v20
    v_mfma_f32_16x16x32_bf16 v[228:231], a[132:135], v[36:39], v[228:231]
    ds_read_b64_tr_b16 a[128:129], v9 offset:0
    ds_read_b64_tr_b16 a[130:131], v9 offset:8192
    v_mfma_f32_16x16x32_bf16 v[232:235], a[136:139], v[36:39], v[232:235]
    v_exp_f32 v21, v21
    v_mfma_f32_16x16x32_bf16 v[236:239], a[140:143], v[36:39], v[236:239]
    ds_read_b64_tr_b16 a[132:133], v9 offset:8
    v_cvt_pk_bf16_f32 v34, v20, v21
    v_mfma_f32_16x16x32_bf16 v[240:243], a[144:147], v[36:39], v[240:243]
    v_exp_f32 v22, v22
    v_mfma_f32_16x16x32_bf16 v[244:247], a[148:151], v[36:39], v[244:247]
    ds_read_b64_tr_b16 a[134:135], v9 offset:8200
    ds_read_b64_tr_b16 a[136:137], v9 offset:256
    v_accvgpr_write_b32 a166, v40
    v_mfma_f32_16x16x32_bf16 v[248:251], a[152:155], v[36:39], v[248:251]
    v_exp_f32 v23, v23
    v_mfma_f32_16x16x32_bf16 v[252:255], a[156:159], v[36:39], v[252:255]
    ds_read_b64_tr_b16 a[138:139], v9 offset:8448
    v_cvt_pk_bf16_f32 v35, v22, v23
    v_mfma_f32_16x16x32_bf16 a[244:247], a[248:251], v[36:39], a[244:247]
    ds_read_b64_tr_b16 a[140:141], v9 offset:264
    ds_read_b64_tr_b16 a[142:143], v9 offset:8456
    v_mfma_f32_16x16x32_bf16 v[16:19], a[96:99], a[32:35], 0
    v_exp_f32 v24, v24
    v_mfma_f32_16x16x32_bf16 v[16:19], a[100:103], a[36:39], v[16:19]
    ds_read_b64_tr_b16 a[144:145], v9 offset:512
    ds_read_b64_tr_b16 a[146:147], v9 offset:8704
    v_mfma_f32_16x16x32_bf16 v[16:19], a[104:107], a[40:43], v[16:19]
    v_exp_f32 v25, v25
    v_mfma_f32_16x16x32_bf16 v[16:19], a[108:111], a[44:47], v[16:19]
    ds_read_b64_tr_b16 a[148:149], v9 offset:520
    v_cvt_pk_bf16_f32 v36, v24, v25
    v_mfma_f32_16x16x32_bf16 v[20:23], a[112:115], a[32:35], 0
    v_exp_f32 v26, v26
    v_mfma_f32_16x16x32_bf16 v[20:23], a[116:119], a[36:39], v[20:23]
    ds_read_b64_tr_b16 a[150:151], v9 offset:8712
    ds_read_b64_tr_b16 a[152:153], v9 offset:768
    v_mfma_f32_16x16x32_bf16 v[20:23], a[120:123], a[40:43], v[20:23]
L_m3:
    s_cbranch_execz L_m4
    v_exp_f32 v27, v27
    v_mfma_f32_16x16x32_bf16 v[20:23], a[124:127], a[44:47], v[20:23]
    s_waitcnt lgkmcnt(11)
    ds_read_b64_tr_b16 a[154:155], v9 offset:8960
    v_cvt_pk_bf16_f32 v37, v26, v27
    v_mfma_f32_16x16x32_bf16 v[64:67], a[128:131], v[32:35], v[64:67]
    s_waitcnt lgkmcnt(10)
    v_exp_f32 v28, v28
    v_mfma_f32_16x16x32_bf16 v[68:71], a[132:135], v[32:35], v[68:71]
    s_waitcnt lgkmcnt(8)
    ds_read_b64_tr_b16 a[156:157], v9 offset:776
    ds_read_b64_tr_b16 a[158:159], v9 offset:8968
    v_mfma_f32_16x16x32_bf16 v[72:75], a[136:139], v[32:35], v[72:75]
    s_waitcnt lgkmcnt(8)
    v_exp_f32 v29, v29
    v_mfma_f32_16x16x32_bf16 v[76:79], a[140:143], v[32:35], v[76:79]
    s_waitcnt lgkmcnt(6)
    v_cvt_pk_bf16_f32 v38, v28, v29
    v_accvgpr_read_b32 v41, a167
    v_mfma_f32_16x16x32_bf16 v[80:83], a[144:147], v[32:35], v[80:83]
    s_waitcnt lgkmcnt(4)
    v_exp_f32 v30, v30
    v_mfma_f32_16x16x32_bf16 v[84:87], a[148:151], v[32:35], v[84:87]
    s_waitcnt lgkmcnt(2)
    buffer_load_dwordx4 v3, s[24:27], s66 offen offset:2048 nt lds
    v_lshlrev_b32 v40, 16, v41
    v_mfma_f32_16x16x32_bf16 v[88:91], a[152:155], v[32:35], v[88:91]
    s_waitcnt lgkmcnt(0)
    v_exp_f32 v31, v31
    v_mfma_f32_16x16x32_bf16 v[92:95], a[156:159], v[32:35], v[92:95]
    v_cvt_pk_bf16_f32 v39, v30, v31
    v_and_b32 v41, s35, v41
    v_mfma_f32_16x16x32_bf16 a[224:227], a[248:251], v[32:35], a[224:227]
    v_mul_f32 v40, s34, v40
    v_mul_f32 v41, s34, v41
    v_mfma_f32_16x16x32_bf16 v[24:27], a[96:99], a[48:51], 0
    v_exp_f32 v16, v16
    v_mfma_f32_16x16x32_bf16 v[24:27], a[100:103], a[52:55], v[24:27]
    v_cvt_pk_bf16_f32 v40, v40, v41
    v_accvgpr_write_b32 a167, v40
    v_mfma_f32_16x16x32_bf16 v[24:27], a[104:107], a[56:59], v[24:27]
    v_exp_f32 v17, v17
    v_mfma_f32_16x16x32_bf16 v[24:27], a[108:111], a[60:63], v[24:27]
    v_cvt_pk_bf16_f32 v32, v16, v17
    v_accvgpr_read_b32 v41, a168
    v_mfma_f32_16x16x32_bf16 v[28:31], a[112:115], a[48:51], 0
    v_exp_f32 v18, v18
    v_mfma_f32_16x16x32_bf16 v[28:31], a[116:119], a[52:55], v[28:31]
    v_lshlrev_b32 v40, 16, v41
    v_and_b32 v41, s35, v41
    v_mfma_f32_16x16x32_bf16 v[28:31], a[120:123], a[56:59], v[28:31]
    v_exp_f32 v19, v19
    v_mfma_f32_16x16x32_bf16 v[28:31], a[124:127], a[60:63], v[28:31]
    v_cvt_pk_bf16_f32 v33, v18, v19
    v_mul_f32 v40, s34, v40
    v_mfma_f32_16x16x32_bf16 v[96:99], a[128:131], v[36:39], v[96:99]
    v_exp_f32 v20, v20
    v_mfma_f32_16x16x32_bf16 v[100:103], a[132:135], v[36:39], v[100:103]
    buffer_load_dwordx4 v3, s[24:27], s66 offen offset:3072 nt lds
    v_mfma_f32_16x16x32_bf16 v[104:107], a[136:139], v[36:39], v[104:107]
    v_exp_f32 v21, v21
    v_mfma_f32_16x16x32_bf16 v[108:111], a[140:143], v[36:39], v[108:111]
    v_cvt_pk_bf16_f32 v34, v20, v21
    v_mul_f32 v41, s34, v41
    v_mfma_f32_16x16x32_bf16 v[112:115], a[144:147], v[36:39], v[112:115]
    v_exp_f32 v22, v22
    v_mfma_f32_16x16x32_bf16 v[116:119], a[148:151], v[36:39], v[116:119]
    v_cvt_pk_bf16_f32 v40, v40, v41
    v_accvgpr_write_b32 a168, v40
    v_mfma_f32_16x16x32_bf16 v[120:123], a[152:155], v[36:39], v[120:123]
    v_exp_f32 v23, v23
    v_accvgpr_read_b32 v41, a169
    v_mfma_f32_16x16x32_bf16 v[124:127], a[156:159], v[36:39], v[124:127]
    v_cvt_pk_bf16_f32 v35, v22, v23
    v_lshlrev_b32 v40, 16, v41
    v_mfma_f32_16x16x32_bf16 a[228:231], a[248:251], v[36:39], a[228:231]
    v_and_b32 v41, s35, v41
    v_mul_f32 v40, s34, v40
    v_mfma_f32_16x16x32_bf16 v[16:19], a[96:99], a[64:67], 0
    s_add_u32 m0, s32, 16384
    v_exp_f32 v24, v24
    v_mfma_f32_16x16x32_bf16 v[16:19], a[100:103], a[68:71], v[16:19]
    buffer_load_dwordx4 v2, s[20:23], s67 offen offset:0 nt lds
    v_mfma_f32_16x16x32_bf16 v[16:19], a[104:107], a[72:75], v[16:19]
    v_exp_f32 v25, v25
    v_mfma_f32_16x16x32_bf16 v[16:19], a[108:111], a[76:79], v[16:19]
    v_cvt_pk_bf16_f32 v36, v24, v25
    v_mul_f32 v41, s34, v41
    v_mfma_f32_16x16x32_bf16 v[20:23], a[112:115], a[64:67], 0
    v_exp_f32 v26, v26
    v_mfma_f32_16x16x32_bf16 v[20:23], a[116:119], a[68:71], v[20:23]
    v_cvt_pk_bf16_f32 v40, v40, v41
    v_accvgpr_write_b32 a169, v40
    v_mfma_f32_16x16x32_bf16 v[20:23], a[120:123], a[72:75], v[20:23]
    v_exp_f32 v27, v27
    v_mfma_f32_16x16x32_bf16 v[20:23], a[124:127], a[76:79], v[20:23]
    v_cvt_pk_bf16_f32 v37, v26, v27
    v_accvgpr_read_b32 v41, a170
    v_mfma_f32_16x16x32_bf16 v[128:131], a[128:131], v[32:35], v[128:131]
    v_exp_f32 v28, v28
    v_mfma_f32_16x16x32_bf16 v[132:135], a[132:135], v[32:35], v[132:135]
    v_lshlrev_b32 v40, 16, v41
    v_and_b32 v41, s35, v41
    v_mfma_f32_16x16x32_bf16 v[136:139], a[136:139], v[32:35], v[136:139]
    v_exp_f32 v29, v29
    v_mfma_f32_16x16x32_bf16 v[140:143], a[140:143], v[32:35], v[140:143]
    v_cvt_pk_bf16_f32 v38, v28, v29
    v_mul_f32 v40, s34, v40
    v_mfma_f32_16x16x32_bf16 v[144:147], a[144:147], v[32:35], v[144:147]
    v_exp_f32 v30, v30
    v_mfma_f32_16x16x32_bf16 v[148:151], a[148:151], v[32:35], v[148:151]
    v_mul_f32 v41, s34, v41
    v_cvt_pk_bf16_f32 v40, v40, v41
    v_mfma_f32_16x16x32_bf16 v[152:155], a[152:155], v[32:35], v[152:155]
    v_exp_f32 v31, v31
    v_accvgpr_write_b32 a170, v40
    v_mfma_f32_16x16x32_bf16 v[156:159], a[156:159], v[32:35], v[156:159]
    s_waitcnt vmcnt(9)
    v_cvt_pk_bf16_f32 v39, v30, v31
    v_accvgpr_read_b32 v41, a171
    v_mfma_f32_16x16x32_bf16 a[232:235], a[248:251], v[32:35], a[232:235]
    s_barrier
    v_mfma_f32_16x16x32_bf16 v[24:27], a[96:99], a[80:83], 0
    v_exp_f32 v16, v16
    v_mfma_f32_16x16x32_bf16 v[24:27], a[100:103], a[84:87], v[24:27]
    ds_read_b128 a[96:99], v6 offset:16384
    ds_read_b128 a[100:103], v6 offset:16640
    v_mfma_f32_16x16x32_bf16 v[24:27], a[104:107], a[88:91], v[24:27]
    v_exp_f32 v17, v17
    v_mfma_f32_16x16x32_bf16 v[24:27], a[108:111], a[92:95], v[24:27]
    ds_read_b128 a[104:107], v6 offset:16896
    v_cvt_pk_bf16_f32 v32, v16, v17
    v_mfma_f32_16x16x32_bf16 v[28:31], a[112:115], a[80:83], 0
    v_exp_f32 v18, v18
    v_mfma_f32_16x16x32_bf16 v[28:31], a[116:119], a[84:87], v[28:31]
    ds_read_b128 a[108:111], v6 offset:17152
    ds_read_b128 a[112:115], v6 offset:24576
    v_mfma_f32_16x16x32_bf16 v[28:31], a[120:123], a[88:91], v[28:31]
    v_exp_f32 v19, v19
    v_mfma_f32_16x16x32_bf16 v[28:31], a[124:127], a[92:95], v[28:31]
    ds_read_b128 a[116:119], v6 offset:24832
    v_cvt_pk_bf16_f32 v33, v18, v19
    v_mfma_f32_16x16x32_bf16 v[160:163], a[128:131], v[36:39], v[160:163]
    v_exp_f32 v20, v20
    v_mfma_f32_16x16x32_bf16 v[164:167], a[132:135], v[36:39], v[164:167]
    ds_read_b128 a[120:123], v6 offset:25088
    ds_read_b128 a[124:127], v6 offset:25344
    v_mfma_f32_16x16x32_bf16 v[168:171], a[136:139], v[36:39], v[168:171]
    v_exp_f32 v21, v21
    v_mfma_f32_16x16x32_bf16 v[172:175], a[140:143], v[36:39], v[172:175]
    v_cvt_pk_bf16_f32 v34, v20, v21
    v_lshlrev_b32 v40, 16, v41
    v_mfma_f32_16x16x32_bf16 v[176:179], a[144:147], v[36:39], v[176:179]
    v_exp_f32 v22, v22
    v_mfma_f32_16x16x32_bf16 v[180:183], a[148:151], v[36:39], v[180:183]
    buffer_load_dwordx4 v2, s[20:23], s67 offen offset:1024 nt lds
    v_mfma_f32_16x16x32_bf16 v[184:187], a[152:155], v[36:39], v[184:187]
    v_exp_f32 v23, v23
    v_mfma_f32_16x16x32_bf16 v[188:191], a[156:159], v[36:39], v[188:191]
    v_cvt_pk_bf16_f32 v35, v22, v23
    v_and_b32 v41, s35, v41
    v_mul_f32 v40, s34, v40
    v_mfma_f32_16x16x32_bf16 a[236:239], a[248:251], v[36:39], a[236:239]
    s_waitcnt lgkmcnt(7)
    v_mul_f32 v41, s34, v41
    v_cvt_pk_bf16_f32 v40, v40, v41
    v_mfma_f32_16x16x32_bf16 v[16:19], a[96:99], a[0:3], 0
    s_waitcnt lgkmcnt(6)
    v_exp_f32 v24, v24
    v_mfma_f32_16x16x32_bf16 v[16:19], a[100:103], a[4:7], v[16:19]
    s_waitcnt lgkmcnt(5)
    v_accvgpr_write_b32 a171, v40
    v_accvgpr_read_b32 v41, a172
    v_mfma_f32_16x16x32_bf16 v[16:19], a[104:107], a[8:11], v[16:19]
    s_waitcnt lgkmcnt(4)
    v_exp_f32 v25, v25
    v_mfma_f32_16x16x32_bf16 v[16:19], a[108:111], a[12:15], v[16:19]
    s_waitcnt lgkmcnt(3)
    v_cvt_pk_bf16_f32 v36, v24, v25
    v_lshlrev_b32 v40, 16, v41
    v_mfma_f32_16x16x32_bf16 v[20:23], a[112:115], a[0:3], 0
    s_waitcnt lgkmcnt(2)
    v_exp_f32 v26, v26
    v_mfma_f32_16x16x32_bf16 v[20:23], a[116:119], a[4:7], v[20:23]
    s_waitcnt lgkmcnt(1)
    v_and_b32 v41, s35, v41
    v_mul_f32 v40, s34, v40
    v_mfma_f32_16x16x32_bf16 v[20:23], a[120:123], a[8:11], v[20:23]
    s_waitcnt lgkmcnt(0)
    v_exp_f32 v27, v27
    v_mfma_f32_16x16x32_bf16 v[20:23], a[124:127], a[12:15], v[20:23]
    v_cvt_pk_bf16_f32 v37, v26, v27
    v_mul_f32 v41, s34, v41
    v_mfma_f32_16x16x32_bf16 v[192:195], a[128:131], v[32:35], v[192:195]
    v_exp_f32 v28, v28
    v_mfma_f32_16x16x32_bf16 v[196:199], a[132:135], v[32:35], v[196:199]
    buffer_load_dwordx4 v3, s[24:27], s67 offen offset:2048 nt lds
    v_mfma_f32_16x16x32_bf16 v[200:203], a[136:139], v[32:35], v[200:203]
    v_exp_f32 v29, v29
    v_mfma_f32_16x16x32_bf16 v[204:207], a[140:143], v[32:35], v[204:207]
    v_cvt_pk_bf16_f32 v38, v28, v29
    v_cvt_pk_bf16_f32 v40, v40, v41
    v_mfma_f32_16x16x32_bf16 v[208:211], a[144:147], v[32:35], v[208:211]
    v_exp_f32 v30, v30
    v_mfma_f32_16x16x32_bf16 v[212:215], a[148:151], v[32:35], v[212:215]
    v_accvgpr_write_b32 a172, v40
    v_accvgpr_read_b32 v41, a173
    v_mfma_f32_16x16x32_bf16 v[216:219], a[152:155], v[32:35], v[216:219]
    v_exp_f32 v31, v31
    v_mfma_f32_16x16x32_bf16 v[220:223], a[156:159], v[32:35], v[220:223]
    v_cvt_pk_bf16_f32 v39, v30, v31
    v_lshlrev_b32 v40, 16, v41
    v_mfma_f32_16x16x32_bf16 a[240:243], a[248:251], v[32:35], a[240:243]
    v_and_b32 v41, s35, v41
    v_mul_f32 v40, s34, v40
    v_mul_f32 v41, s34, v41
    v_mfma_f32_16x16x32_bf16 v[24:27], a[96:99], a[16:19], 0
    v_exp_f32 v16, v16
    v_mfma_f32_16x16x32_bf16 v[24:27], a[100:103], a[20:23], v[24:27]
    v_cvt_pk_bf16_f32 v40, v40, v41
    v_accvgpr_write_b32 a173, v40
    v_mfma_f32_16x16x32_bf16 v[24:27], a[104:107], a[24:27], v[24:27]
    v_exp_f32 v17, v17
    v_mfma_f32_16x16x32_bf16 v[24:27], a[108:111], a[28:31], v[24:27]
    v_cvt_pk_bf16_f32 v32, v16, v17
    v_accvgpr_read_b32 v41, a174
    v_mfma_f32_16x16x32_bf16 v[28:31], a[112:115], a[16:19], 0
    v_exp_f32 v18, v18
    v_mfma_f32_16x16x32_bf16 v[28:31], a[116:119], a[20:23], v[28:31]
    buffer_load_dwordx4 v3, s[24:27], s67 offen offset:3072 nt lds
    v_mfma_f32_16x16x32_bf16 v[28:31], a[120:123], a[24:27], v[28:31]
    v_exp_f32 v19, v19
    v_mfma_f32_16x16x32_bf16 v[28:31], a[124:127], a[28:31], v[28:31]
    v_cvt_pk_bf16_f32 v33, v18, v19
    v_lshlrev_b32 v40, 16, v41
    v_mfma_f32_16x16x32_bf16 v[224:227], a[128:131], v[36:39], v[224:227]
    v_exp_f32 v20, v20
    v_mfma_f32_16x16x32_bf16 v[228:231], a[132:135], v[36:39], v[228:231]
    ds_read_b64_tr_b16 a[128:129], v9 offset:16384
    ds_read_b64_tr_b16 a[130:131], v9 offset:24576
    v_mfma_f32_16x16x32_bf16 v[232:235], a[136:139], v[36:39], v[232:235]
    v_exp_f32 v21, v21
    v_mfma_f32_16x16x32_bf16 v[236:239], a[140:143], v[36:39], v[236:239]
    ds_read_b64_tr_b16 a[132:133], v9 offset:16392
    v_cvt_pk_bf16_f32 v34, v20, v21
    v_mfma_f32_16x16x32_bf16 v[240:243], a[144:147], v[36:39], v[240:243]
    v_exp_f32 v22, v22
    v_mfma_f32_16x16x32_bf16 v[244:247], a[148:151], v[36:39], v[244:247]
    ds_read_b64_tr_b16 a[134:135], v9 offset:24584
    ds_read_b64_tr_b16 a[136:137], v9 offset:16640
    v_mfma_f32_16x16x32_bf16 v[248:251], a[152:155], v[36:39], v[248:251]
    v_exp_f32 v23, v23
    v_mfma_f32_16x16x32_bf16 v[252:255], a[156:159], v[36:39], v[252:255]
    ds_read_b64_tr_b16 a[138:139], v9 offset:24832
    v_cvt_pk_bf16_f32 v35, v22, v23
    v_mfma_f32_16x16x32_bf16 a[244:247], a[248:251], v[36:39], a[244:247]
    ds_read_b64_tr_b16 a[140:141], v9 offset:16648
    ds_read_b64_tr_b16 a[142:143], v9 offset:24840
    v_and_b32 v41, s35, v41
    v_mfma_f32_16x16x32_bf16 v[16:19], a[96:99], a[32:35], 0
    v_exp_f32 v24, v24
    v_mfma_f32_16x16x32_bf16 v[16:19], a[100:103], a[36:39], v[16:19]
    ds_read_b64_tr_b16 a[144:145], v9 offset:16896
    ds_read_b64_tr_b16 a[146:147], v9 offset:25088
    v_mfma_f32_16x16x32_bf16 v[16:19], a[104:107], a[40:43], v[16:19]
    v_exp_f32 v25, v25
    v_mfma_f32_16x16x32_bf16 v[16:19], a[108:111], a[44:47], v[16:19]
    ds_read_b64_tr_b16 a[148:149], v9 offset:16904
    v_cvt_pk_bf16_f32 v36, v24, v25
    v_mfma_f32_16x16x32_bf16 v[20:23], a[112:115], a[32:35], 0
    v_exp_f32 v26, v26
    v_mfma_f32_16x16x32_bf16 v[20:23], a[116:119], a[36:39], v[20:23]
    ds_read_b64_tr_b16 a[150:151], v9 offset:25096
    ds_read_b64_tr_b16 a[152:153], v9 offset:17152
    v_mfma_f32_16x16x32_bf16 v[20:23], a[120:123], a[40:43], v[20:23]
    v_exp_f32 v27, v27
    v_mfma_f32_16x16x32_bf16 v[20:23], a[124:127], a[44:47], v[20:23]
    s_waitcnt lgkmcnt(11)
    ds_read_b64_tr_b16 a[154:155], v9 offset:25344
    v_cvt_pk_bf16_f32 v37, v26, v27
    v_mfma_f32_16x16x32_bf16 v[64:67], a[128:131], v[32:35], v[64:67]
    s_waitcnt lgkmcnt(10)
    v_exp_f32 v28, v28
    v_mfma_f32_16x16x32_bf16 v[68:71], a[132:135], v[32:35], v[68:71]
    s_waitcnt lgkmcnt(8)
    ds_read_b64_tr_b16 a[156:157], v9 offset:17160
    ds_read_b64_tr_b16 a[158:159], v9 offset:25352
    v_mfma_f32_16x16x32_bf16 v[72:75], a[136:139], v[32:35], v[72:75]
    s_waitcnt lgkmcnt(8)
    v_exp_f32 v29, v29
    v_mfma_f32_16x16x32_bf16 v[76:79], a[140:143], v[32:35], v[76:79]
    s_waitcnt lgkmcnt(6)
    v_cvt_pk_bf16_f32 v38, v28, v29
    v_mul_f32 v40, s34, v40
    v_mfma_f32_16x16x32_bf16 v[80:83], a[144:147], v[32:35], v[80:83]
    s_waitcnt lgkmcnt(4)
    v_exp_f32 v30, v30
    v_mfma_f32_16x16x32_bf16 v[84:87], a[148:151], v[32:35], v[84:87]
    s_waitcnt lgkmcnt(2)
    buffer_load_dwordx4 a[192:195], v1, s[16:19], s52 offen offset:0 nt
    v_mfma_f32_16x16x32_bf16 v[88:91], a[152:155], v[32:35], v[88:91]
    s_waitcnt lgkmcnt(0)
    v_exp_f32 v31, v31
    v_mfma_f32_16x16x32_bf16 v[92:95], a[156:159], v[32:35], v[92:95]
    v_cvt_pk_bf16_f32 v39, v30, v31
    v_mul_f32 v41, s34, v41
    v_mfma_f32_16x16x32_bf16 a[224:227], a[248:251], v[32:35], a[224:227]
    v_cvt_pk_bf16_f32 v40, v40, v41
    v_accvgpr_write_b32 a174, v40
    v_accvgpr_read_b32 v41, a175
    v_mfma_f32_16x16x32_bf16 v[24:27], a[96:99], a[48:51], 0
    v_exp_f32 v16, v16
    v_mfma_f32_16x16x32_bf16 v[24:27], a[100:103], a[52:55], v[24:27]
    v_lshlrev_b32 v40, 16, v41
    v_and_b32 v41, s35, v41
    v_mfma_f32_16x16x32_bf16 v[24:27], a[104:107], a[56:59], v[24:27]
    v_exp_f32 v17, v17
    v_mfma_f32_16x16x32_bf16 v[24:27], a[108:111], a[60:63], v[24:27]
    v_cvt_pk_bf16_f32 v32, v16, v17
    v_mul_f32 v40, s34, v40
    v_mfma_f32_16x16x32_bf16 v[28:31], a[112:115], a[48:51], 0
    v_exp_f32 v18, v18
    v_mfma_f32_16x16x32_bf16 v[28:31], a[116:119], a[52:55], v[28:31]
    v_mul_f32 v41, s34, v41
    v_cvt_pk_bf16_f32 v40, v40, v41
    v_mfma_f32_16x16x32_bf16 v[28:31], a[120:123], a[56:59], v[28:31]
    v_exp_f32 v19, v19
    v_mfma_f32_16x16x32_bf16 v[28:31], a[124:127], a[60:63], v[28:31]
    v_cvt_pk_bf16_f32 v33, v18, v19
    v_accvgpr_write_b32 a175, v40
    v_mfma_f32_16x16x32_bf16 v[96:99], a[128:131], v[36:39], v[96:99]
    v_exp_f32 v20, v20
    v_mfma_f32_16x16x32_bf16 v[100:103], a[132:135], v[36:39], v[100:103]
    buffer_load_dwordx4 a[196:199], v1, s[16:19], s52 offen offset:64 nt
    v_mfma_f32_16x16x32_bf16 v[104:107], a[136:139], v[36:39], v[104:107]
    v_exp_f32 v21, v21
    v_mfma_f32_16x16x32_bf16 v[108:111], a[140:143], v[36:39], v[108:111]
    v_cvt_pk_bf16_f32 v34, v20, v21
    v_mfma_f32_16x16x32_bf16 v[112:115], a[144:147], v[36:39], v[112:115]
    v_exp_f32 v22, v22
    v_mfma_f32_16x16x32_bf16 v[116:119], a[148:151], v[36:39], v[116:119]
    s_waitcnt vmcnt(10)
    v_mfma_f32_16x16x32_bf16 v[120:123], a[152:155], v[36:39], v[120:123]
    v_exp_f32 v23, v23
    v_mfma_f32_16x16x32_bf16 v[124:127], a[156:159], v[36:39], v[124:127]
    v_cvt_pk_bf16_f32 v35, v22, v23
    v_accvgpr_read_b32 v41, a176
    v_mfma_f32_16x16x32_bf16 a[228:231], a[248:251], v[36:39], a[228:231]
    v_lshlrev_b32 v40, 16, v41
    v_and_b32 v41, s35, v41
    v_mfma_f32_16x16x32_bf16 v[16:19], a[96:99], a[64:67], 0
    v_exp_f32 v24, v24
    v_mul_f32 v40, s34, v40
    v_mfma_f32_16x16x32_bf16 v[16:19], a[100:103], a[68:71], v[16:19]
    v_mul_f32 v41, s34, v41
    v_cvt_pk_bf16_f32 v40, v40, v41
    v_mfma_f32_16x16x32_bf16 v[16:19], a[104:107], a[72:75], v[16:19]
    v_exp_f32 v25, v25
    v_mfma_f32_16x16x32_bf16 v[16:19], a[108:111], a[76:79], v[16:19]
    v_cvt_pk_bf16_f32 v36, v24, v25
    v_accvgpr_write_b32 a176, v40
    v_mfma_f32_16x16x32_bf16 v[20:23], a[112:115], a[64:67], 0
    v_exp_f32 v26, v26
    v_mfma_f32_16x16x32_bf16 v[20:23], a[116:119], a[68:71], v[20:23]
    buffer_load_dwordx4 a[200:203], v1, s[16:19], s52 offen offset:128 nt
    v_mfma_f32_16x16x32_bf16 v[20:23], a[120:123], a[72:75], v[20:23]
    v_exp_f32 v27, v27
    v_mfma_f32_16x16x32_bf16 v[20:23], a[124:127], a[76:79], v[20:23]
    v_cvt_pk_bf16_f32 v37, v26, v27
    v_accvgpr_read_b32 v41, a177
    v_mfma_f32_16x16x32_bf16 v[128:131], a[128:131], v[32:35], v[128:131]
    v_exp_f32 v28, v28
    v_mfma_f32_16x16x32_bf16 v[132:135], a[132:135], v[32:35], v[132:135]
    v_lshlrev_b32 v40, 16, v41
    v_and_b32 v41, s35, v41
    v_mfma_f32_16x16x32_bf16 v[136:139], a[136:139], v[32:35], v[136:139]
    v_exp_f32 v29, v29
    v_mfma_f32_16x16x32_bf16 v[140:143], a[140:143], v[32:35], v[140:143]
    v_cvt_pk_bf16_f32 v38, v28, v29
    v_mul_f32 v40, s34, v40
    v_mfma_f32_16x16x32_bf16 v[144:147], a[144:147], v[32:35], v[144:147]
    v_exp_f32 v30, v30
    v_mfma_f32_16x16x32_bf16 v[148:151], a[148:151], v[32:35], v[148:151]
    v_mul_f32 v41, s34, v41
    v_cvt_pk_bf16_f32 v40, v40, v41
    v_mfma_f32_16x16x32_bf16 v[152:155], a[152:155], v[32:35], v[152:155]
    v_exp_f32 v31, v31
    v_mfma_f32_16x16x32_bf16 v[156:159], a[156:159], v[32:35], v[156:159]
    s_waitcnt vmcnt(7)
    v_cvt_pk_bf16_f32 v39, v30, v31
    v_accvgpr_write_b32 a177, v40
    v_mfma_f32_16x16x32_bf16 a[232:235], a[248:251], v[32:35], a[232:235]
    s_barrier
    v_mfma_f32_16x16x32_bf16 v[24:27], a[96:99], a[80:83], 0
    v_exp_f32 v16, v16
    v_mfma_f32_16x16x32_bf16 v[24:27], a[100:103], a[84:87], v[24:27]
    ds_read_b128 a[96:99], v4 offset:0
    ds_read_b128 a[100:103], v4 offset:256
    v_accvgpr_read_b32 v41, a178
    v_mfma_f32_16x16x32_bf16 v[24:27], a[104:107], a[88:91], v[24:27]
    v_exp_f32 v17, v17
    v_mfma_f32_16x16x32_bf16 v[24:27], a[108:111], a[92:95], v[24:27]
    ds_read_b128 a[104:107], v4 offset:512
    v_cvt_pk_bf16_f32 v32, v16, v17
    v_mfma_f32_16x16x32_bf16 v[28:31], a[112:115], a[80:83], 0
    v_exp_f32 v18, v18
    v_mfma_f32_16x16x32_bf16 v[28:31], a[116:119], a[84:87], v[28:31]
    ds_read_b128 a[108:111], v4 offset:768
    ds_read_b128 a[112:115], v4 offset:8192
    v_mfma_f32_16x16x32_bf16 v[28:31], a[120:123], a[88:91], v[28:31]
    v_exp_f32 v19, v19
    v_mfma_f32_16x16x32_bf16 v[28:31], a[124:127], a[92:95], v[28:31]
    ds_read_b128 a[116:119], v4 offset:8448
    v_cvt_pk_bf16_f32 v33, v18, v19
    v_mfma_f32_16x16x32_bf16 v[160:163], a[128:131], v[36:39], v[160:163]
    v_exp_f32 v20, v20
    v_mfma_f32_16x16x32_bf16 v[164:167], a[132:135], v[36:39], v[164:167]
    ds_read_b128 a[120:123], v4 offset:8704
    ds_read_b128 a[124:127], v4 offset:8960
    v_mfma_f32_16x16x32_bf16 v[168:171], a[136:139], v[36:39], v[168:171]
    v_exp_f32 v21, v21
    v_mfma_f32_16x16x32_bf16 v[172:175], a[140:143], v[36:39], v[172:175]
    v_cvt_pk_bf16_f32 v34, v20, v21
    v_lshlrev_b32 v40, 16, v41
    v_mfma_f32_16x16x32_bf16 v[176:179], a[144:147], v[36:39], v[176:179]
    v_exp_f32 v22, v22
    v_mfma_f32_16x16x32_bf16 v[180:183], a[148:151], v[36:39], v[180:183]
    buffer_load_dwordx4 a[204:207], v1, s[16:19], s52 offen offset:192 nt
    v_mfma_f32_16x16x32_bf16 v[184:187], a[152:155], v[36:39], v[184:187]
    s_add_u32 m0, s32, 32768
    v_exp_f32 v23, v23
    v_mfma_f32_16x16x32_bf16 v[188:191], a[156:159], v[36:39], v[188:191]
    v_cvt_pk_bf16_f32 v35, v22, v23
    v_and_b32 v41, s35, v41
    v_mfma_f32_16x16x32_bf16 a[236:239], a[248:251], v[36:39], a[236:239]
    s_waitcnt lgkmcnt(7)
    buffer_load_dwordx4 v2, s[20:23], s68 offen offset:0 nt lds
    v_mfma_f32_16x16x32_bf16 v[16:19], a[96:99], a[0:3], 0
    s_waitcnt lgkmcnt(6)
    v_exp_f32 v24, v24
    v_mfma_f32_16x16x32_bf16 v[16:19], a[100:103], a[4:7], v[16:19]
    s_waitcnt lgkmcnt(5)
    v_mul_f32 v40, s34, v40
    v_mul_f32 v41, s34, v41
    v_cvt_pk_bf16_f32 v40, v40, v41
    v_mfma_f32_16x16x32_bf16 v[16:19], a[104:107], a[8:11], v[16:19]
    s_waitcnt lgkmcnt(4)
    v_exp_f32 v25, v25
    v_mfma_f32_16x16x32_bf16 v[16:19], a[108:111], a[12:15], v[16:19]
    s_waitcnt lgkmcnt(3)
    v_cvt_pk_bf16_f32 v36, v24, v25
    v_accvgpr_write_b32 a178, v40
    v_mfma_f32_16x16x32_bf16 v[20:23], a[112:115], a[0:3], 0
    s_waitcnt lgkmcnt(2)
    v_exp_f32 v26, v26
    v_mfma_f32_16x16x32_bf16 v[20:23], a[116:119], a[4:7], v[20:23]
    s_waitcnt lgkmcnt(1)
    v_accvgpr_read_b32 v41, a179
    v_lshlrev_b32 v40, 16, v41
    v_mfma_f32_16x16x32_bf16 v[20:23], a[120:123], a[8:11], v[20:23]
    s_waitcnt lgkmcnt(0)
    v_exp_f32 v27, v27
    v_mfma_f32_16x16x32_bf16 v[20:23], a[124:127], a[12:15], v[20:23]
    v_cvt_pk_bf16_f32 v37, v26, v27
    v_and_b32 v41, s35, v41
    v_mfma_f32_16x16x32_bf16 v[192:195], a[128:131], v[32:35], v[192:195]
    v_exp_f32 v28, v28
    v_mfma_f32_16x16x32_bf16 v[196:199], a[132:135], v[32:35], v[196:199]
    v_mul_f32 v40, s34, v40
    v_mul_f32 v41, s34, v41
    v_mfma_f32_16x16x32_bf16 v[200:203], a[136:139], v[32:35], v[200:203]
    v_exp_f32 v29, v29
    v_mfma_f32_16x16x32_bf16 v[204:207], a[140:143], v[32:35], v[204:207]
    v_cvt_pk_bf16_f32 v38, v28, v29
    v_cvt_pk_bf16_f32 v40, v40, v41
    v_mfma_f32_16x16x32_bf16 v[208:211], a[144:147], v[32:35], v[208:211]
    v_exp_f32 v30, v30
    v_mfma_f32_16x16x32_bf16 v[212:215], a[148:151], v[32:35], v[212:215]
    buffer_load_dwordx4 v2, s[20:23], s68 offen offset:1024 nt lds
    v_mfma_f32_16x16x32_bf16 v[216:219], a[152:155], v[32:35], v[216:219]
    v_exp_f32 v31, v31
    v_mfma_f32_16x16x32_bf16 v[220:223], a[156:159], v[32:35], v[220:223]
    v_cvt_pk_bf16_f32 v39, v30, v31
    v_accvgpr_write_b32 a179, v40
    v_mfma_f32_16x16x32_bf16 a[240:243], a[248:251], v[32:35], a[240:243]
    v_accvgpr_read_b32 v41, a180
    v_lshlrev_b32 v40, 16, v41
    v_mfma_f32_16x16x32_bf16 v[24:27], a[96:99], a[16:19], 0
    v_exp_f32 v16, v16
    v_mfma_f32_16x16x32_bf16 v[24:27], a[100:103], a[20:23], v[24:27]
    v_and_b32 v41, s35, v41
    v_mul_f32 v40, s34, v40
    v_mfma_f32_16x16x32_bf16 v[24:27], a[104:107], a[24:27], v[24:27]
    v_exp_f32 v17, v17
    v_mul_f32 v41, s34, v41
    v_mfma_f32_16x16x32_bf16 v[24:27], a[108:111], a[28:31], v[24:27]
    v_cvt_pk_bf16_f32 v32, v16, v17
    v_cvt_pk_bf16_f32 v40, v40, v41
    v_mfma_f32_16x16x32_bf16 v[28:31], a[112:115], a[16:19], 0
    v_exp_f32 v18, v18
    v_mfma_f32_16x16x32_bf16 v[28:31], a[116:119], a[20:23], v[28:31]
    v_accvgpr_write_b32 a180, v40
    v_accvgpr_read_b32 v41, a181
    v_mfma_f32_16x16x32_bf16 v[28:31], a[120:123], a[24:27], v[28:31]
    v_exp_f32 v19, v19
    v_mfma_f32_16x16x32_bf16 v[28:31], a[124:127], a[28:31], v[28:31]
    v_cvt_pk_bf16_f32 v33, v18, v19
    v_lshlrev_b32 v40, 16, v41
    v_mfma_f32_16x16x32_bf16 v[224:227], a[128:131], v[36:39], v[224:227]
    v_exp_f32 v20, v20
    v_mfma_f32_16x16x32_bf16 v[228:231], a[132:135], v[36:39], v[228:231]
    ds_read_b64_tr_b16 a[128:129], v7 offset:0
    ds_read_b64_tr_b16 a[130:131], v7 offset:8192
    v_mfma_f32_16x16x32_bf16 v[232:235], a[136:139], v[36:39], v[232:235]
    v_exp_f32 v21, v21
    v_mfma_f32_16x16x32_bf16 v[236:239], a[140:143], v[36:39], v[236:239]
    ds_read_b64_tr_b16 a[132:133], v7 offset:8
    v_cvt_pk_bf16_f32 v34, v20, v21
    v_mfma_f32_16x16x32_bf16 v[240:243], a[144:147], v[36:39], v[240:243]
    v_exp_f32 v22, v22
    v_mfma_f32_16x16x32_bf16 v[244:247], a[148:151], v[36:39], v[244:247]
    ds_read_b64_tr_b16 a[134:135], v7 offset:8200
    ds_read_b64_tr_b16 a[136:137], v7 offset:256
    v_mfma_f32_16x16x32_bf16 v[248:251], a[152:155], v[36:39], v[248:251]
    v_exp_f32 v23, v23
    v_mfma_f32_16x16x32_bf16 v[252:255], a[156:159], v[36:39], v[252:255]
    ds_read_b64_tr_b16 a[138:139], v7 offset:8448
    v_cvt_pk_bf16_f32 v35, v22, v23
    v_mfma_f32_16x16x32_bf16 a[244:247], a[248:251], v[36:39], a[244:247]
    ds_read_b64_tr_b16 a[140:141], v7 offset:264
    ds_read_b64_tr_b16 a[142:143], v7 offset:8456
    v_mfma_f32_16x16x32_bf16 v[16:19], a[96:99], a[32:35], 0
    v_exp_f32 v24, v24
    v_mfma_f32_16x16x32_bf16 v[16:19], a[100:103], a[36:39], v[16:19]
    ds_read_b64_tr_b16 a[144:145], v7 offset:512
    ds_read_b64_tr_b16 a[146:147], v7 offset:8704
    v_mfma_f32_16x16x32_bf16 v[16:19], a[104:107], a[40:43], v[16:19]
    v_exp_f32 v25, v25
    v_and_b32 v41, s35, v41
    v_mfma_f32_16x16x32_bf16 v[16:19], a[108:111], a[44:47], v[16:19]
    ds_read_b64_tr_b16 a[148:149], v7 offset:520
    v_cvt_pk_bf16_f32 v36, v24, v25
    v_mfma_f32_16x16x32_bf16 v[20:23], a[112:115], a[32:35], 0
    v_exp_f32 v26, v26
    v_mfma_f32_16x16x32_bf16 v[20:23], a[116:119], a[36:39], v[20:23]
    ds_read_b64_tr_b16 a[150:151], v7 offset:8712
    ds_read_b64_tr_b16 a[152:153], v7 offset:768
    v_mfma_f32_16x16x32_bf16 v[20:23], a[120:123], a[40:43], v[20:23]
    v_exp_f32 v27, v27
    v_mfma_f32_16x16x32_bf16 v[20:23], a[124:127], a[44:47], v[20:23]
    s_waitcnt lgkmcnt(11)
    ds_read_b64_tr_b16 a[154:155], v7 offset:8960
    v_cvt_pk_bf16_f32 v37, v26, v27
    v_mfma_f32_16x16x32_bf16 v[64:67], a[128:131], v[32:35], v[64:67]
    s_waitcnt lgkmcnt(10)
    v_exp_f32 v28, v28
    v_mfma_f32_16x16x32_bf16 v[68:71], a[132:135], v[32:35], v[68:71]
    s_waitcnt lgkmcnt(8)
    ds_read_b64_tr_b16 a[156:157], v7 offset:776
    ds_read_b64_tr_b16 a[158:159], v7 offset:8968
    v_mfma_f32_16x16x32_bf16 v[72:75], a[136:139], v[32:35], v[72:75]
    s_waitcnt lgkmcnt(8)
    v_exp_f32 v29, v29
    v_mfma_f32_16x16x32_bf16 v[76:79], a[140:143], v[32:35], v[76:79]
    s_waitcnt lgkmcnt(6)
    v_cvt_pk_bf16_f32 v38, v28, v29
    v_mul_f32 v40, s34, v40
    v_mfma_f32_16x16x32_bf16 v[80:83], a[144:147], v[32:35], v[80:83]
    s_waitcnt lgkmcnt(4)
    v_exp_f32 v30, v30
    v_mfma_f32_16x16x32_bf16 v[84:87], a[148:151], v[32:35], v[84:87]
    s_waitcnt lgkmcnt(2)
    buffer_load_dwordx4 v3, s[24:27], s68 offen offset:2048 nt lds
    v_mfma_f32_16x16x32_bf16 v[88:91], a[152:155], v[32:35], v[88:91]
    s_waitcnt lgkmcnt(0)
    v_exp_f32 v31, v31
    v_mfma_f32_16x16x32_bf16 v[92:95], a[156:159], v[32:35], v[92:95]
    v_cvt_pk_bf16_f32 v39, v30, v31
    v_mul_f32 v41, s34, v41
    v_mfma_f32_16x16x32_bf16 a[224:227], a[248:251], v[32:35], a[224:227]
    v_cvt_pk_bf16_f32 v40, v40, v41
    v_accvgpr_write_b32 a181, v40
    v_mfma_f32_16x16x32_bf16 v[24:27], a[96:99], a[48:51], 0
    v_exp_f32 v16, v16
    v_mfma_f32_16x16x32_bf16 v[24:27], a[100:103], a[52:55], v[24:27]
    v_accvgpr_read_b32 v41, a182
    v_lshlrev_b32 v40, 16, v41
    v_mfma_f32_16x16x32_bf16 v[24:27], a[104:107], a[56:59], v[24:27]
    v_exp_f32 v17, v17
    v_and_b32 v41, s35, v41
    v_mfma_f32_16x16x32_bf16 v[24:27], a[108:111], a[60:63], v[24:27]
    v_cvt_pk_bf16_f32 v32, v16, v17
    v_mul_f32 v40, s34, v40
    v_mfma_f32_16x16x32_bf16 v[28:31], a[112:115], a[48:51], 0
    v_exp_f32 v18, v18
    v_mfma_f32_16x16x32_bf16 v[28:31], a[116:119], a[52:55], v[28:31]
    v_mul_f32 v41, s34, v41
    v_cvt_pk_bf16_f32 v40, v40, v41
    v_mfma_f32_16x16x32_bf16 v[28:31], a[120:123], a[56:59], v[28:31]
    v_exp_f32 v19, v19
    v_mfma_f32_16x16x32_bf16 v[28:31], a[124:127], a[60:63], v[28:31]
    v_cvt_pk_bf16_f32 v33, v18, v19
    v_accvgpr_write_b32 a182, v40
    v_mfma_f32_16x16x32_bf16 v[96:99], a[128:131], v[36:39], v[96:99]
    v_exp_f32 v20, v20
    v_mfma_f32_16x16x32_bf16 v[100:103], a[132:135], v[36:39], v[100:103]
    buffer_load_dwordx4 v3, s[24:27], s68 offen offset:3072 nt lds
    v_mfma_f32_16x16x32_bf16 v[104:107], a[136:139], v[36:39], v[104:107]
    v_exp_f32 v21, v21
    v_mfma_f32_16x16x32_bf16 v[108:111], a[140:143], v[36:39], v[108:111]
    v_cvt_pk_bf16_f32 v34, v20, v21
    v_accvgpr_read_b32 v41, a183
    v_mfma_f32_16x16x32_bf16 v[112:115], a[144:147], v[36:39], v[112:115]
    v_exp_f32 v22, v22
    v_mfma_f32_16x16x32_bf16 v[116:119], a[148:151], v[36:39], v[116:119]
    buffer_load_dwordx4 a[208:211], v1, s[16:19], s53 offen offset:0 nt
    v_mfma_f32_16x16x32_bf16 v[120:123], a[152:155], v[36:39], v[120:123]
    v_exp_f32 v23, v23
    v_mfma_f32_16x16x32_bf16 v[124:127], a[156:159], v[36:39], v[124:127]
L_m4:
    s_cbranch_execz L_m5
    v_cvt_pk_bf16_f32 v35, v22, v23
    v_lshlrev_b32 v40, 16, v41
    v_mfma_f32_16x16x32_bf16 a[228:231], a[248:251], v[36:39], a[228:231]
    v_and_b32 v41, s35, v41
    v_mul_f32 v40, s34, v40
    v_mfma_f32_16x16x32_bf16 v[16:19], a[96:99], a[64:67], 0
    v_exp_f32 v24, v24
    v_mfma_f32_16x16x32_bf16 v[16:19], a[100:103], a[68:71], v[16:19]
    v_mul_f32 v41, s34, v41
    v_cvt_pk_bf16_f32 v40, v40, v41
    v_mfma_f32_16x16x32_bf16 v[16:19], a[104:107], a[72:75], v[16:19]
    v_exp_f32 v25, v25
    v_accvgpr_write_b32 a183, v40
    v_mfma_f32_16x16x32_bf16 v[16:19], a[108:111], a[76:79], v[16:19]
    v_cvt_pk_bf16_f32 v36, v24, v25
    v_accvgpr_read_b32 v41, a184
    v_mfma_f32_16x16x32_bf16 v[20:23], a[112:115], a[64:67], 0
    v_exp_f32 v26, v26
    v_mfma_f32_16x16x32_bf16 v[20:23], a[116:119], a[68:71], v[20:23]
    v_lshlrev_b32 v40, 16, v41
    v_and_b32 v41, s35, v41
    v_mfma_f32_16x16x32_bf16 v[20:23], a[120:123], a[72:75], v[20:23]
    v_exp_f32 v27, v27
    v_mfma_f32_16x16x32_bf16 v[20:23], a[124:127], a[76:79], v[20:23]
    v_cvt_pk_bf16_f32 v37, v26, v27
    v_mul_f32 v40, s34, v40
    v_mfma_f32_16x16x32_bf16 v[128:131], a[128:131], v[32:35], v[128:131]
    v_exp_f32 v28, v28
    v_mfma_f32_16x16x32_bf16 v[132:135], a[132:135], v[32:35], v[132:135]
    buffer_load_dwordx4 a[212:215], v1, s[16:19], s53 offen offset:64 nt
    v_mfma_f32_16x16x32_bf16 v[136:139], a[136:139], v[32:35], v[136:139]
    v_exp_f32 v29, v29
    v_mfma_f32_16x16x32_bf16 v[140:143], a[140:143], v[32:35], v[140:143]
    v_cvt_pk_bf16_f32 v38, v28, v29
    v_mul_f32 v41, s34, v41
    v_mfma_f32_16x16x32_bf16 v[144:147], a[144:147], v[32:35], v[144:147]
    v_exp_f32 v30, v30
    v_mfma_f32_16x16x32_bf16 v[148:151], a[148:151], v[32:35], v[148:151]
    v_cvt_pk_bf16_f32 v40, v40, v41
    v_accvgpr_write_b32 a184, v40
    v_mfma_f32_16x16x32_bf16 v[152:155], a[152:155], v[32:35], v[152:155]
    v_exp_f32 v31, v31
    v_mfma_f32_16x16x32_bf16 v[156:159], a[156:159], v[32:35], v[156:159]
    s_waitcnt vmcnt(10)
    v_cvt_pk_bf16_f32 v39, v30, v31
    v_accvgpr_read_b32 v41, a185
    v_mfma_f32_16x16x32_bf16 a[232:235], a[248:251], v[32:35], a[232:235]
    s_barrier
    v_mfma_f32_16x16x32_bf16 v[24:27], a[96:99], a[80:83], 0
    v_exp_f32 v16, v16
    v_mfma_f32_16x16x32_bf16 v[24:27], a[100:103], a[84:87], v[24:27]
    ds_read_b128 a[96:99], v4 offset:16384
    ds_read_b128 a[100:103], v4 offset:16640
    v_mfma_f32_16x16x32_bf16 v[24:27], a[104:107], a[88:91], v[24:27]
    v_exp_f32 v17, v17
    v_mfma_f32_16x16x32_bf16 v[24:27], a[108:111], a[92:95], v[24:27]
    ds_read_b128 a[104:107], v4 offset:16896
    v_cvt_pk_bf16_f32 v32, v16, v17
    v_mfma_f32_16x16x32_bf16 v[28:31], a[112:115], a[80:83], 0
    v_exp_f32 v18, v18
    v_lshlrev_b32 v40, 16, v41
    v_mfma_f32_16x16x32_bf16 v[28:31], a[116:119], a[84:87], v[28:31]
    ds_read_b128 a[108:111], v4 offset:17152
    ds_read_b128 a[112:115], v4 offset:24576
    v_mfma_f32_16x16x32_bf16 v[28:31], a[120:123], a[88:91], v[28:31]
    v_exp_f32 v19, v19
    v_mfma_f32_16x16x32_bf16 v[28:31], a[124:127], a[92:95], v[28:31]
    ds_read_b128 a[116:119], v4 offset:24832
    v_cvt_pk_bf16_f32 v33, v18, v19
    v_mfma_f32_16x16x32_bf16 v[160:163], a[128:131], v[36:39], v[160:163]
    v_exp_f32 v20, v20
    v_mfma_f32_16x16x32_bf16 v[164:167], a[132:135], v[36:39], v[164:167]
    ds_read_b128 a[120:123], v4 offset:25088
    ds_read_b128 a[124:127], v4 offset:25344
    v_mfma_f32_16x16x32_bf16 v[168:171], a[136:139], v[36:39], v[168:171]
    v_exp_f32 v21, v21
    v_mfma_f32_16x16x32_bf16 v[172:175], a[140:143], v[36:39], v[172:175]
    v_cvt_pk_bf16_f32 v34, v20, v21
    v_and_b32 v41, s35, v41
    v_mfma_f32_16x16x32_bf16 v[176:179], a[144:147], v[36:39], v[176:179]
    v_exp_f32 v22, v22
    v_mfma_f32_16x16x32_bf16 v[180:183], a[148:151], v[36:39], v[180:183]
    buffer_load_dwordx4 a[216:219], v1, s[16:19], s53 offen offset:128 nt
    v_mfma_f32_16x16x32_bf16 v[184:187], a[152:155], v[36:39], v[184:187]
    v_exp_f32 v23, v23
    v_mfma_f32_16x16x32_bf16 v[188:191], a[156:159], v[36:39], v[188:191]
    v_cvt_pk_bf16_f32 v35, v22, v23
    v_mul_f32 v40, s34, v40
    v_mfma_f32_16x16x32_bf16 a[236:239], a[248:251], v[36:39], a[236:239]
    s_waitcnt lgkmcnt(7)
    v_mul_f32 v41, s34, v41
    v_cvt_pk_bf16_f32 v40, v40, v41
    v_mfma_f32_16x16x32_bf16 v[16:19], a[96:99], a[0:3], 0
    s_waitcnt lgkmcnt(6)
    v_exp_f32 v24, v24
    v_mfma_f32_16x16x32_bf16 v[16:19], a[100:103], a[4:7], v[16:19]
    s_waitcnt lgkmcnt(5)
    v_accvgpr_write_b32 a185, v40
    v_accvgpr_read_b32 v41, a186
    v_mfma_f32_16x16x32_bf16 v[16:19], a[104:107], a[8:11], v[16:19]
    s_waitcnt lgkmcnt(4)
    v_exp_f32 v25, v25
    v_mfma_f32_16x16x32_bf16 v[16:19], a[108:111], a[12:15], v[16:19]
    s_waitcnt lgkmcnt(3)
    v_cvt_pk_bf16_f32 v36, v24, v25
    v_lshlrev_b32 v40, 16, v41
    v_mfma_f32_16x16x32_bf16 v[20:23], a[112:115], a[0:3], 0
    s_waitcnt lgkmcnt(2)
    v_exp_f32 v26, v26
    v_and_b32 v41, s35, v41
    v_mfma_f32_16x16x32_bf16 v[20:23], a[116:119], a[4:7], v[20:23]
    s_waitcnt lgkmcnt(1)
    v_mul_f32 v40, s34, v40
    v_mul_f32 v41, s34, v41
    v_mfma_f32_16x16x32_bf16 v[20:23], a[120:123], a[8:11], v[20:23]
    s_waitcnt lgkmcnt(0)
    v_exp_f32 v27, v27
    v_mfma_f32_16x16x32_bf16 v[20:23], a[124:127], a[12:15], v[20:23]
    v_cvt_pk_bf16_f32 v37, v26, v27
    v_cvt_pk_bf16_f32 v40, v40, v41
    v_mfma_f32_16x16x32_bf16 v[192:195], a[128:131], v[32:35], v[192:195]
    v_exp_f32 v28, v28
    v_mfma_f32_16x16x32_bf16 v[196:199], a[132:135], v[32:35], v[196:199]
    buffer_load_dwordx4 a[220:223], v1, s[16:19], s53 offen offset:192 nt
    v_mfma_f32_16x16x32_bf16 v[200:203], a[136:139], v[32:35], v[200:203]
    s_add_u32 m0, s32, 49152
    v_exp_f32 v29, v29
    v_mfma_f32_16x16x32_bf16 v[204:207], a[140:143], v[32:35], v[204:207]
    v_cvt_pk_bf16_f32 v38, v28, v29
    v_accvgpr_write_b32 a186, v40
    v_mfma_f32_16x16x32_bf16 v[208:211], a[144:147], v[32:35], v[208:211]
    v_exp_f32 v30, v30
    v_mfma_f32_16x16x32_bf16 v[212:215], a[148:151], v[32:35], v[212:215]
    buffer_load_dwordx4 v2, s[20:23], s69 offen offset:0 nt lds
    v_mfma_f32_16x16x32_bf16 v[216:219], a[152:155], v[32:35], v[216:219]
    v_exp_f32 v31, v31
    v_mfma_f32_16x16x32_bf16 v[220:223], a[156:159], v[32:35], v[220:223]
    v_cvt_pk_bf16_f32 v39, v30, v31
    v_accvgpr_read_b32 v41, a187
    v_mfma_f32_16x16x32_bf16 a[240:243], a[248:251], v[32:35], a[240:243]
    v_lshlrev_b32 v40, 16, v41
    v_and_b32 v41, s35, v41
    v_mfma_f32_16x16x32_bf16 v[24:27], a[96:99], a[16:19], 0
    v_exp_f32 v16, v16
    v_mfma_f32_16x16x32_bf16 v[24:27], a[100:103], a[20:23], v[24:27]
    v_mul_f32 v40, s34, v40
    v_mul_f32 v41, s34, v41
    v_mfma_f32_16x16x32_bf16 v[24:27], a[104:107], a[24:27], v[24:27]
    v_exp_f32 v17, v17
    v_mfma_f32_16x16x32_bf16 v[24:27], a[108:111], a[28:31], v[24:27]
    v_cvt_pk_bf16_f32 v32, v16, v17
    v_cvt_pk_bf16_f32 v40, v40, v41
    v_mfma_f32_16x16x32_bf16 v[28:31], a[112:115], a[16:19], 0
    v_exp_f32 v18, v18
    v_accvgpr_write_b32 a187, v40
    v_mfma_f32_16x16x32_bf16 v[28:31], a[116:119], a[20:23], v[28:31]
    v_accvgpr_read_b32 v41, a188
    v_lshlrev_b32 v40, 16, v41
    v_mfma_f32_16x16x32_bf16 v[28:31], a[120:123], a[24:27], v[28:31]
    v_exp_f32 v19, v19
    v_mfma_f32_16x16x32_bf16 v[28:31], a[124:127], a[28:31], v[28:31]
    v_cvt_pk_bf16_f32 v33, v18, v19
    v_and_b32 v41, s35, v41
    v_mfma_f32_16x16x32_bf16 v[224:227], a[128:131], v[36:39], v[224:227]
    v_exp_f32 v20, v20
    v_mfma_f32_16x16x32_bf16 v[228:231], a[132:135], v[36:39], v[228:231]
    ds_read_b64_tr_b16 a[128:129], v7 offset:16384
    ds_read_b64_tr_b16 a[130:131], v7 offset:24576
    v_mfma_f32_16x16x32_bf16 v[232:235], a[136:139], v[36:39], v[232:235]
    v_exp_f32 v21, v21
    v_mfma_f32_16x16x32_bf16 v[236:239], a[140:143], v[36:39], v[236:239]
    ds_read_b64_tr_b16 a[132:133], v7 offset:16392
    v_cvt_pk_bf16_f32 v34, v20, v21
    v_mfma_f32_16x16x32_bf16 v[240:243], a[144:147], v[36:39], v[240:243]
    v_exp_f32 v22, v22
    v_mfma_f32_16x16x32_bf16 v[244:247], a[148:151], v[36:39], v[244:247]
    ds_read_b64_tr_b16 a[134:135], v7 offset:24584
    ds_read_b64_tr_b16 a[136:137], v7 offset:16640
    v_mfma_f32_16x16x32_bf16 v[248:251], a[152:155], v[36:39], v[248:251]
    v_exp_f32 v23, v23
    v_mfma_f32_16x16x32_bf16 v[252:255], a[156:159], v[36:39], v[252:255]
    ds_read_b64_tr_b16 a[138:139], v7 offset:24832
    v_cvt_pk_bf16_f32 v35, v22, v23
    v_mfma_f32_16x16x32_bf16 a[244:247], a[248:251], v[36:39], a[244:247]
    ds_read_b64_tr_b16 a[140:141], v7 offset:16648
    ds_read_b64_tr_b16 a[142:143], v7 offset:24840
    v_mfma_f32_16x16x32_bf16 v[16:19], a[96:99], a[32:35], 0
    v_exp_f32 v24, v24
    v_mfma_f32_16x16x32_bf16 v[16:19], a[100:103], a[36:39], v[16:19]
    ds_read_b64_tr_b16 a[144:145], v7 offset:16896
    ds_read_b64_tr_b16 a[146:147], v7 offset:25088
    v_mfma_f32_16x16x32_bf16 v[16:19], a[104:107], a[40:43], v[16:19]
    v_exp_f32 v25, v25
    v_mfma_f32_16x16x32_bf16 v[16:19], a[108:111], a[44:47], v[16:19]
    ds_read_b64_tr_b16 a[148:149], v7 offset:16904
    v_cvt_pk_bf16_f32 v36, v24, v25
    v_mfma_f32_16x16x32_bf16 v[20:23], a[112:115], a[32:35], 0
    v_exp_f32 v26, v26
    v_mfma_f32_16x16x32_bf16 v[20:23], a[116:119], a[36:39], v[20:23]
    ds_read_b64_tr_b16 a[150:151], v7 offset:25096
    ds_read_b64_tr_b16 a[152:153], v7 offset:17152
    v_mul_f32 v40, s34, v40
    v_mfma_f32_16x16x32_bf16 v[20:23], a[120:123], a[40:43], v[20:23]
    v_exp_f32 v27, v27
    v_mfma_f32_16x16x32_bf16 v[20:23], a[124:127], a[44:47], v[20:23]
    s_waitcnt lgkmcnt(11)
    ds_read_b64_tr_b16 a[154:155], v7 offset:25344
    v_cvt_pk_bf16_f32 v37, v26, v27
    v_mfma_f32_16x16x32_bf16 v[64:67], a[128:131], v[32:35], v[64:67]
    s_waitcnt lgkmcnt(10)
    v_exp_f32 v28, v28
    v_mfma_f32_16x16x32_bf16 v[68:71], a[132:135], v[32:35], v[68:71]
    s_waitcnt lgkmcnt(8)
    ds_read_b64_tr_b16 a[156:157], v7 offset:17160
    ds_read_b64_tr_b16 a[158:159], v7 offset:25352
    v_mfma_f32_16x16x32_bf16 v[72:75], a[136:139], v[32:35], v[72:75]
    s_waitcnt lgkmcnt(8)
    v_exp_f32 v29, v29
    v_mfma_f32_16x16x32_bf16 v[76:79], a[140:143], v[32:35], v[76:79]
    s_waitcnt lgkmcnt(6)
    v_cvt_pk_bf16_f32 v38, v28, v29
    v_mul_f32 v41, s34, v41
    v_mfma_f32_16x16x32_bf16 v[80:83], a[144:147], v[32:35], v[80:83]
    s_waitcnt lgkmcnt(4)
    v_exp_f32 v30, v30
    v_mfma_f32_16x16x32_bf16 v[84:87], a[148:151], v[32:35], v[84:87]
    s_waitcnt lgkmcnt(2)
    buffer_load_dwordx4 v2, s[20:23], s69 offen offset:1024 nt lds
    v_mfma_f32_16x16x32_bf16 v[88:91], a[152:155], v[32:35], v[88:91]
    s_waitcnt lgkmcnt(0)
    v_exp_f32 v31, v31
    v_mfma_f32_16x16x32_bf16 v[92:95], a[156:159], v[32:35], v[92:95]
    v_cvt_pk_bf16_f32 v39, v30, v31
    v_cvt_pk_bf16_f32 v40, v40, v41
    v_mfma_f32_16x16x32_bf16 a[224:227], a[248:251], v[32:35], a[224:227]
    v_accvgpr_write_b32 a188, v40
    v_accvgpr_read_b32 v41, a189
    v_mfma_f32_16x16x32_bf16 v[24:27], a[96:99], a[48:51], 0
    v_exp_f32 v16, v16
    v_mfma_f32_16x16x32_bf16 v[24:27], a[100:103], a[52:55], v[24:27]
    v_lshlrev_b32 v40, 16, v41
    v_and_b32 v41, s35, v41
    v_mfma_f32_16x16x32_bf16 v[24:27], a[104:107], a[56:59], v[24:27]
    v_exp_f32 v17, v17
    v_mfma_f32_16x16x32_bf16 v[24:27], a[108:111], a[60:63], v[24:27]
    v_cvt_pk_bf16_f32 v32, v16, v17
    v_mul_f32 v40, s34, v40
    v_mfma_f32_16x16x32_bf16 v[28:31], a[112:115], a[48:51], 0
    v_exp_f32 v18, v18
    v_mfma_f32_16x16x32_bf16 v[28:31], a[116:119], a[52:55], v[28:31]
    v_mul_f32 v41, s34, v41
    v_cvt_pk_bf16_f32 v40, v40, v41
    v_accvgpr_write_b32 a189, v40
    v_mfma_f32_16x16x32_bf16 v[28:31], a[120:123], a[56:59], v[28:31]
    v_exp_f32 v19, v19
    v_mfma_f32_16x16x32_bf16 v[28:31], a[124:127], a[60:63], v[28:31]
    v_cvt_pk_bf16_f32 v33, v18, v19
    v_accvgpr_read_b32 v41, a190
    v_mfma_f32_16x16x32_bf16 v[96:99], a[128:131], v[36:39], v[96:99]
    v_exp_f32 v20, v20
    v_mfma_f32_16x16x32_bf16 v[100:103], a[132:135], v[36:39], v[100:103]
    buffer_load_dwordx4 v3, s[24:27], s69 offen offset:2048 nt lds
    v_mfma_f32_16x16x32_bf16 v[104:107], a[136:139], v[36:39], v[104:107]
    v_exp_f32 v21, v21
    v_mfma_f32_16x16x32_bf16 v[108:111], a[140:143], v[36:39], v[108:111]
    v_cvt_pk_bf16_f32 v34, v20, v21
    v_lshlrev_b32 v40, 16, v41
    v_mfma_f32_16x16x32_bf16 v[112:115], a[144:147], v[36:39], v[112:115]
    v_exp_f32 v22, v22
    v_mfma_f32_16x16x32_bf16 v[116:119], a[148:151], v[36:39], v[116:119]
    s_waitcnt vmcnt(11)
    v_and_b32 v41, s35, v41
    v_mul_f32 v40, s34, v40
    v_mfma_f32_16x16x32_bf16 v[120:123], a[152:155], v[36:39], v[120:123]
    v_exp_f32 v23, v23
    v_mfma_f32_16x16x32_bf16 v[124:127], a[156:159], v[36:39], v[124:127]
    v_cvt_pk_bf16_f32 v35, v22, v23
    v_mul_f32 v41, s34, v41
    v_mfma_f32_16x16x32_bf16 a[228:231], a[248:251], v[36:39], a[228:231]
    v_cvt_pk_bf16_f32 v40, v40, v41
    v_accvgpr_write_b32 a190, v40
    v_mfma_f32_16x16x32_bf16 v[16:19], a[96:99], a[64:67], 0
    v_exp_f32 v24, v24
    v_mfma_f32_16x16x32_bf16 v[16:19], a[100:103], a[68:71], v[16:19]
    v_accvgpr_read_b32 v41, a191
    v_lshlrev_b32 v40, 16, v41
    v_mfma_f32_16x16x32_bf16 v[16:19], a[104:107], a[72:75], v[16:19]
    v_exp_f32 v25, v25
    v_mfma_f32_16x16x32_bf16 v[16:19], a[108:111], a[76:79], v[16:19]
    v_cvt_pk_bf16_f32 v36, v24, v25
    v_and_b32 v41, s35, v41
    v_mfma_f32_16x16x32_bf16 v[20:23], a[112:115], a[64:67], 0
    v_exp_f32 v26, v26
    v_mfma_f32_16x16x32_bf16 v[20:23], a[116:119], a[68:71], v[20:23]
    buffer_load_dwordx4 v3, s[24:27], s69 offen offset:3072 nt lds
    v_mul_f32 v40, s34, v40
    v_mfma_f32_16x16x32_bf16 v[20:23], a[120:123], a[72:75], v[20:23]
    s_add_u32 m0, s32, 65536
    v_exp_f32 v27, v27
    v_mfma_f32_16x16x32_bf16 v[20:23], a[124:127], a[76:79], v[20:23]
    v_cvt_pk_bf16_f32 v37, v26, v27
    v_mul_f32 v41, s34, v41
    v_mfma_f32_16x16x32_bf16 v[128:131], a[128:131], v[32:35], v[128:131]
    v_exp_f32 v28, v28
    v_mfma_f32_16x16x32_bf16 v[132:135], a[132:135], v[32:35], v[132:135]
    buffer_load_dwordx4 v2, s[20:23], s70 offen offset:0 nt lds
    v_mfma_f32_16x16x32_bf16 v[136:139], a[136:139], v[32:35], v[136:139]
    v_exp_f32 v29, v29
    v_mfma_f32_16x16x32_bf16 v[140:143], a[140:143], v[32:35], v[140:143]
    v_cvt_pk_bf16_f32 v38, v28, v29
    v_cvt_pk_bf16_f32 v40, v40, v41
    v_mfma_f32_16x16x32_bf16 v[144:147], a[144:147], v[32:35], v[144:147]
    v_exp_f32 v30, v30
    v_mfma_f32_16x16x32_bf16 v[148:151], a[148:151], v[32:35], v[148:151]
    v_accvgpr_write_b32 a191, v40
    v_accvgpr_read_b32 v41, a192
    v_mfma_f32_16x16x32_bf16 v[152:155], a[152:155], v[32:35], v[152:155]
    v_exp_f32 v31, v31
    v_mfma_f32_16x16x32_bf16 v[156:159], a[156:159], v[32:35], v[156:159]
    s_waitcnt vmcnt(9)
    v_cvt_pk_bf16_f32 v39, v30, v31
    v_lshlrev_b32 v40, 16, v41
    v_mfma_f32_16x16x32_bf16 a[232:235], a[248:251], v[32:35], a[232:235]
    s_barrier
    v_mfma_f32_16x16x32_bf16 v[24:27], a[96:99], a[80:83], 0
    v_exp_f32 v16, v16
    v_mfma_f32_16x16x32_bf16 v[24:27], a[100:103], a[84:87], v[24:27]
    ds_read_b128 a[96:99], v4 offset:32768
    ds_read_b128 a[100:103], v4 offset:33024
    v_mfma_f32_16x16x32_bf16 v[24:27], a[104:107], a[88:91], v[24:27]
    v_exp_f32 v17, v17
    v_mfma_f32_16x16x32_bf16 v[24:27], a[108:111], a[92:95], v[24:27]
    ds_read_b128 a[104:107], v4 offset:33280
    v_cvt_pk_bf16_f32 v32, v16, v17
    v_mfma_f32_16x16x32_bf16 v[28:31], a[112:115], a[80:83], 0
    v_exp_f32 v18, v18
    v_mfma_f32_16x16x32_bf16 v[28:31], a[116:119], a[84:87], v[28:31]
    ds_read_b128 a[108:111], v4 offset:33536
    ds_read_b128 a[112:115], v4 offset:40960
    v_mfma_f32_16x16x32_bf16 v[28:31], a[120:123], a[88:91], v[28:31]
    v_exp_f32 v19, v19
    v_mfma_f32_16x16x32_bf16 v[28:31], a[124:127], a[92:95], v[28:31]
    ds_read_b128 a[116:119], v4 offset:41216
    v_cvt_pk_bf16_f32 v33, v18, v19
    v_and_b32 v41, s35, v41
    v_mfma_f32_16x16x32_bf16 v[160:163], a[128:131], v[36:39], v[160:163]
    v_exp_f32 v20, v20
    v_mfma_f32_16x16x32_bf16 v[164:167], a[132:135], v[36:39], v[164:167]
    ds_read_b128 a[120:123], v4 offset:41472
    ds_read_b128 a[124:127], v4 offset:41728
    v_mfma_f32_16x16x32_bf16 v[168:171], a[136:139], v[36:39], v[168:171]
    v_exp_f32 v21, v21
    v_mfma_f32_16x16x32_bf16 v[172:175], a[140:143], v[36:39], v[172:175]
    v_cvt_pk_bf16_f32 v34, v20, v21
    v_mul_f32 v40, s34, v40
    v_mfma_f32_16x16x32_bf16 v[176:179], a[144:147], v[36:39], v[176:179]
    v_exp_f32 v22, v22
    v_mfma_f32_16x16x32_bf16 v[180:183], a[148:151], v[36:39], v[180:183]
    buffer_load_dwordx4 v2, s[20:23], s70 offen offset:1024 nt lds
    v_mfma_f32_16x16x32_bf16 v[184:187], a[152:155], v[36:39], v[184:187]
    v_exp_f32 v23, v23
    v_mfma_f32_16x16x32_bf16 v[188:191], a[156:159], v[36:39], v[188:191]
    v_cvt_pk_bf16_f32 v35, v22, v23
    v_mul_f32 v41, s34, v41
    v_mfma_f32_16x16x32_bf16 a[236:239], a[248:251], v[36:39], a[236:239]
    s_waitcnt lgkmcnt(7)
    v_cvt_pk_bf16_f32 v40, v40, v41
    v_accvgpr_write_b32 a192, v40
    v_mfma_f32_16x16x32_bf16 v[16:19], a[96:99], a[0:3], 0
    s_waitcnt lgkmcnt(6)
    v_exp_f32 v24, v24
    v_mfma_f32_16x16x32_bf16 v[16:19], a[100:103], a[4:7], v[16:19]
    s_waitcnt lgkmcnt(5)
    v_accvgpr_read_b32 v41, a193
    v_lshlrev_b32 v40, 16, v41
    v_mfma_f32_16x16x32_bf16 v[16:19], a[104:107], a[8:11], v[16:19]
    s_waitcnt lgkmcnt(4)
    v_exp_f32 v25, v25
    v_mfma_f32_16x16x32_bf16 v[16:19], a[108:111], a[12:15], v[16:19]
    s_waitcnt lgkmcnt(3)
    v_cvt_pk_bf16_f32 v36, v24, v25
    v_and_b32 v41, s35, v41
    v_mfma_f32_16x16x32_bf16 v[20:23], a[112:115], a[0:3], 0
    s_waitcnt lgkmcnt(2)
    v_exp_f32 v26, v26
    v_mfma_f32_16x16x32_bf16 v[20:23], a[116:119], a[4:7], v[20:23]
    s_waitcnt lgkmcnt(1)
    v_mul_f32 v40, s34, v40
    v_mul_f32 v41, s34, v41
    v_mfma_f32_16x16x32_bf16 v[20:23], a[120:123], a[8:11], v[20:23]
    s_waitcnt lgkmcnt(0)
    v_exp_f32 v27, v27
    v_mfma_f32_16x16x32_bf16 v[20:23], a[124:127], a[12:15], v[20:23]
    v_cvt_pk_bf16_f32 v37, v26, v27
    v_cvt_pk_bf16_f32 v40, v40, v41
    v_accvgpr_write_b32 a193, v40
    v_mfma_f32_16x16x32_bf16 v[192:195], a[128:131], v[32:35], v[192:195]
    v_exp_f32 v28, v28
    v_mfma_f32_16x16x32_bf16 v[196:199], a[132:135], v[32:35], v[196:199]
    buffer_load_dwordx4 v3, s[24:27], s70 offen offset:2048 nt lds
    v_mfma_f32_16x16x32_bf16 v[200:203], a[136:139], v[32:35], v[200:203]
    v_exp_f32 v29, v29
    v_mfma_f32_16x16x32_bf16 v[204:207], a[140:143], v[32:35], v[204:207]
    v_cvt_pk_bf16_f32 v38, v28, v29
    v_accvgpr_read_b32 v41, a194
    v_mfma_f32_16x16x32_bf16 v[208:211], a[144:147], v[32:35], v[208:211]
    v_exp_f32 v30, v30
    v_mfma_f32_16x16x32_bf16 v[212:215], a[148:151], v[32:35], v[212:215]
    v_lshlrev_b32 v40, 16, v41
    v_and_b32 v41, s35, v41
    v_mfma_f32_16x16x32_bf16 v[216:219], a[152:155], v[32:35], v[216:219]
    v_exp_f32 v31, v31
    v_mfma_f32_16x16x32_bf16 v[220:223], a[156:159], v[32:35], v[220:223]
    v_cvt_pk_bf16_f32 v39, v30, v31
    v_mul_f32 v40, s34, v40
    v_mfma_f32_16x16x32_bf16 a[240:243], a[248:251], v[32:35], a[240:243]
    v_mul_f32 v41, s34, v41
    v_cvt_pk_bf16_f32 v40, v40, v41
    v_mfma_f32_16x16x32_bf16 v[24:27], a[96:99], a[16:19], 0
    v_exp_f32 v16, v16
    v_mfma_f32_16x16x32_bf16 v[24:27], a[100:103], a[20:23], v[24:27]
    v_accvgpr_write_b32 a194, v40
    v_accvgpr_read_b32 v41, a195
    v_mfma_f32_16x16x32_bf16 v[24:27], a[104:107], a[24:27], v[24:27]
    v_exp_f32 v17, v17
    v_mfma_f32_16x16x32_bf16 v[24:27], a[108:111], a[28:31], v[24:27]
    v_cvt_pk_bf16_f32 v32, v16, v17
    v_lshlrev_b32 v40, 16, v41
    v_mfma_f32_16x16x32_bf16 v[28:31], a[112:115], a[16:19], 0
    v_exp_f32 v18, v18
    v_mfma_f32_16x16x32_bf16 v[28:31], a[116:119], a[20:23], v[28:31]
    buffer_load_dwordx4 v3, s[24:27], s70 offen offset:3072 nt lds
    v_mfma_f32_16x16x32_bf16 v[28:31], a[120:123], a[24:27], v[28:31]
    v_exp_f32 v19, v19
    v_mfma_f32_16x16x32_bf16 v[28:31], a[124:127], a[28:31], v[28:31]
    v_cvt_pk_bf16_f32 v33, v18, v19
    v_and_b32 v41, s35, v41
    v_mul_f32 v40, s34, v40
    v_mfma_f32_16x16x32_bf16 v[224:227], a[128:131], v[36:39], v[224:227]
    s_add_u32 m0, s32, 81920
    v_exp_f32 v20, v20
    v_mfma_f32_16x16x32_bf16 v[228:231], a[132:135], v[36:39], v[228:231]
    ds_read_b64_tr_b16 a[128:129], v7 offset:32768
    ds_read_b64_tr_b16 a[130:131], v7 offset:40960
    v_mfma_f32_16x16x32_bf16 v[232:235], a[136:139], v[36:39], v[232:235]
    v_exp_f32 v21, v21
    v_mfma_f32_16x16x32_bf16 v[236:239], a[140:143], v[36:39], v[236:239]
    ds_read_b64_tr_b16 a[132:133], v7 offset:32776
    v_cvt_pk_bf16_f32 v34, v20, v21
    v_mfma_f32_16x16x32_bf16 v[240:243], a[144:147], v[36:39], v[240:243]
    v_exp_f32 v22, v22
    v_mfma_f32_16x16x32_bf16 v[244:247], a[148:151], v[36:39], v[244:247]
    ds_read_b64_tr_b16 a[134:135], v7 offset:40968
    ds_read_b64_tr_b16 a[136:137], v7 offset:33024
    v_mfma_f32_16x16x32_bf16 v[248:251], a[152:155], v[36:39], v[248:251]
    v_exp_f32 v23, v23
    v_mfma_f32_16x16x32_bf16 v[252:255], a[156:159], v[36:39], v[252:255]
    ds_read_b64_tr_b16 a[138:139], v7 offset:41216
    v_cvt_pk_bf16_f32 v35, v22, v23
    v_mfma_f32_16x16x32_bf16 a[244:247], a[248:251], v[36:39], a[244:247]
    ds_read_b64_tr_b16 a[140:141], v7 offset:33032
    ds_read_b64_tr_b16 a[142:143], v7 offset:41224
    v_mfma_f32_16x16x32_bf16 v[16:19], a[96:99], a[32:35], 0
    v_exp_f32 v24, v24
    v_mfma_f32_16x16x32_bf16 v[16:19], a[100:103], a[36:39], v[16:19]
    ds_read_b64_tr_b16 a[144:145], v7 offset:33280
    ds_read_b64_tr_b16 a[146:147], v7 offset:41472
    v_mfma_f32_16x16x32_bf16 v[16:19], a[104:107], a[40:43], v[16:19]
    v_exp_f32 v25, v25
    v_mfma_f32_16x16x32_bf16 v[16:19], a[108:111], a[44:47], v[16:19]
    ds_read_b64_tr_b16 a[148:149], v7 offset:33288
    v_cvt_pk_bf16_f32 v36, v24, v25
    v_mfma_f32_16x16x32_bf16 v[20:23], a[112:115], a[32:35], 0
    v_exp_f32 v26, v26
    v_mfma_f32_16x16x32_bf16 v[20:23], a[116:119], a[36:39], v[20:23]
    ds_read_b64_tr_b16 a[150:151], v7 offset:41480
    ds_read_b64_tr_b16 a[152:153], v7 offset:33536
    v_mfma_f32_16x16x32_bf16 v[20:23], a[120:123], a[40:43], v[20:23]
    v_exp_f32 v27, v27
    v_mfma_f32_16x16x32_bf16 v[20:23], a[124:127], a[44:47], v[20:23]
    s_waitcnt lgkmcnt(11)
    ds_read_b64_tr_b16 a[154:155], v7 offset:41728
    v_cvt_pk_bf16_f32 v37, v26, v27
    v_mfma_f32_16x16x32_bf16 v[64:67], a[128:131], v[32:35], v[64:67]
    s_waitcnt lgkmcnt(10)
    v_exp_f32 v28, v28
    v_mul_f32 v41, s34, v41
    v_mfma_f32_16x16x32_bf16 v[68:71], a[132:135], v[32:35], v[68:71]
    s_waitcnt lgkmcnt(8)
    ds_read_b64_tr_b16 a[156:157], v7 offset:33544
    ds_read_b64_tr_b16 a[158:159], v7 offset:41736
    v_mfma_f32_16x16x32_bf16 v[72:75], a[136:139], v[32:35], v[72:75]
    s_waitcnt lgkmcnt(8)
    v_exp_f32 v29, v29
    v_mfma_f32_16x16x32_bf16 v[76:79], a[140:143], v[32:35], v[76:79]
    s_waitcnt lgkmcnt(6)
    v_cvt_pk_bf16_f32 v38, v28, v29
    v_cvt_pk_bf16_f32 v40, v40, v41
    v_mfma_f32_16x16x32_bf16 v[80:83], a[144:147], v[32:35], v[80:83]
    s_waitcnt lgkmcnt(4)
    v_exp_f32 v30, v30
    v_mfma_f32_16x16x32_bf16 v[84:87], a[148:151], v[32:35], v[84:87]
    s_waitcnt lgkmcnt(2)
    buffer_load_dwordx4 v2, s[20:23], s71 offen offset:0 nt lds
    v_mfma_f32_16x16x32_bf16 v[88:91], a[152:155], v[32:35], v[88:91]
    s_waitcnt lgkmcnt(0)
    v_exp_f32 v31, v31
    v_mfma_f32_16x16x32_bf16 v[92:95], a[156:159], v[32:35], v[92:95]
    v_cvt_pk_bf16_f32 v39, v30, v31
    v_accvgpr_write_b32 a195, v40
    v_mfma_f32_16x16x32_bf16 a[224:227], a[248:251], v[32:35], a[224:227]
    v_accvgpr_read_b32 v41, a196
    v_lshlrev_b32 v40, 16, v41
    v_mfma_f32_16x16x32_bf16 v[24:27], a[96:99], a[48:51], 0
    v_exp_f32 v16, v16
    v_mfma_f32_16x16x32_bf16 v[24:27], a[100:103], a[52:55], v[24:27]
    v_and_b32 v41, s35, v41
    v_mul_f32 v40, s34, v40
    v_mfma_f32_16x16x32_bf16 v[24:27], a[104:107], a[56:59], v[24:27]
    v_exp_f32 v17, v17
    v_mfma_f32_16x16x32_bf16 v[24:27], a[108:111], a[60:63], v[24:27]
    v_cvt_pk_bf16_f32 v32, v16, v17
    v_mul_f32 v41, s34, v41
    v_mfma_f32_16x16x32_bf16 v[28:31], a[112:115], a[48:51], 0
    v_exp_f32 v18, v18
    v_mfma_f32_16x16x32_bf16 v[28:31], a[116:119], a[52:55], v[28:31]
    v_cvt_pk_bf16_f32 v40, v40, v41
    v_accvgpr_write_b32 a196, v40
    v_mfma_f32_16x16x32_bf16 v[28:31], a[120:123], a[56:59], v[28:31]
    v_exp_f32 v19, v19
    v_mfma_f32_16x16x32_bf16 v[28:31], a[124:127], a[60:63], v[28:31]
    v_cvt_pk_bf16_f32 v33, v18, v19
    v_accvgpr_read_b32 v41, a197
    v_mfma_f32_16x16x32_bf16 v[96:99], a[128:131], v[36:39], v[96:99]
    v_exp_f32 v20, v20
    v_lshlrev_b32 v40, 16, v41
    v_mfma_f32_16x16x32_bf16 v[100:103], a[132:135], v[36:39], v[100:103]
    buffer_load_dwordx4 v2, s[20:23], s71 offen offset:1024 nt lds
    v_mfma_f32_16x16x32_bf16 v[104:107], a[136:139], v[36:39], v[104:107]
    v_exp_f32 v21, v21
    v_mfma_f32_16x16x32_bf16 v[108:111], a[140:143], v[36:39], v[108:111]
    v_cvt_pk_bf16_f32 v34, v20, v21
    v_and_b32 v41, s35, v41
    v_mfma_f32_16x16x32_bf16 v[112:115], a[144:147], v[36:39], v[112:115]
    v_exp_f32 v22, v22
    v_mfma_f32_16x16x32_bf16 v[116:119], a[148:151], v[36:39], v[116:119]
    v_mul_f32 v40, s34, v40
    v_mul_f32 v41, s34, v41
    v_mfma_f32_16x16x32_bf16 v[120:123], a[152:155], v[36:39], v[120:123]
    v_exp_f32 v23, v23
    v_mfma_f32_16x16x32_bf16 v[124:127], a[156:159], v[36:39], v[124:127]
    v_cvt_pk_bf16_f32 v35, v22, v23
    v_cvt_pk_bf16_f32 v40, v40, v41
    v_mfma_f32_16x16x32_bf16 a[228:231], a[248:251], v[36:39], a[228:231]
    v_accvgpr_write_b32 a197, v40
    v_accvgpr_read_b32 v41, a198
    v_mfma_f32_16x16x32_bf16 v[16:19], a[96:99], a[64:67], 0
    v_exp_f32 v24, v24
    v_mfma_f32_16x16x32_bf16 v[16:19], a[100:103], a[68:71], v[16:19]
    v_lshlrev_b32 v40, 16, v41
    v_and_b32 v41, s35, v41
    v_mfma_f32_16x16x32_bf16 v[16:19], a[104:107], a[72:75], v[16:19]
    v_exp_f32 v25, v25
    v_mfma_f32_16x16x32_bf16 v[16:19], a[108:111], a[76:79], v[16:19]
    v_cvt_pk_bf16_f32 v36, v24, v25
    v_mul_f32 v40, s34, v40
    v_mfma_f32_16x16x32_bf16 v[20:23], a[112:115], a[64:67], 0
    v_exp_f32 v26, v26
    v_mfma_f32_16x16x32_bf16 v[20:23], a[116:119], a[68:71], v[20:23]
    buffer_load_dwordx4 v3, s[24:27], s71 offen offset:2048 nt lds
    v_mfma_f32_16x16x32_bf16 v[20:23], a[120:123], a[72:75], v[20:23]
    v_exp_f32 v27, v27
    v_mfma_f32_16x16x32_bf16 v[20:23], a[124:127], a[76:79], v[20:23]
    v_cvt_pk_bf16_f32 v37, v26, v27
    v_mul_f32 v41, s34, v41
    v_mfma_f32_16x16x32_bf16 v[128:131], a[128:131], v[32:35], v[128:131]
    v_exp_f32 v28, v28
    v_cvt_pk_bf16_f32 v40, v40, v41
    v_mfma_f32_16x16x32_bf16 v[132:135], a[132:135], v[32:35], v[132:135]
    s_waitcnt vmcnt(11)
    v_accvgpr_write_b32 a198, v40
    v_accvgpr_read_b32 v41, a199
    v_mfma_f32_16x16x32_bf16 v[136:139], a[136:139], v[32:35], v[136:139]
    v_exp_f32 v29, v29
    v_mfma_f32_16x16x32_bf16 v[140:143], a[140:143], v[32:35], v[140:143]
    v_cvt_pk_bf16_f32 v38, v28, v29
    v_lshlrev_b32 v40, 16, v41
    v_mfma_f32_16x16x32_bf16 v[144:147], a[144:147], v[32:35], v[144:147]
    v_exp_f32 v30, v30
    v_mfma_f32_16x16x32_bf16 v[148:151], a[148:151], v[32:35], v[148:151]
    v_and_b32 v41, s35, v41
    v_mul_f32 v40, s34, v40
    v_mfma_f32_16x16x32_bf16 v[152:155], a[152:155], v[32:35], v[152:155]
    v_exp_f32 v31, v31
    v_mfma_f32_16x16x32_bf16 v[156:159], a[156:159], v[32:35], v[156:159]
    s_waitcnt vmcnt(7)
    v_cvt_pk_bf16_f32 v39, v30, v31
    v_mul_f32 v41, s34, v41
    v_mfma_f32_16x16x32_bf16 a[232:235], a[248:251], v[32:35], a[232:235]
    s_barrier
    v_mfma_f32_16x16x32_bf16 v[24:27], a[96:99], a[80:83], 0
    v_exp_f32 v16, v16
    v_mfma_f32_16x16x32_bf16 v[24:27], a[100:103], a[84:87], v[24:27]
    ds_read_b128 a[96:99], v4 offset:49152
    ds_read_b128 a[100:103], v4 offset:49408
    v_mfma_f32_16x16x32_bf16 v[24:27], a[104:107], a[88:91], v[24:27]
    v_exp_f32 v17, v17
    v_mfma_f32_16x16x32_bf16 v[24:27], a[108:111], a[92:95], v[24:27]
    ds_read_b128 a[104:107], v4 offset:49664
    v_cvt_pk_bf16_f32 v32, v16, v17
    v_mfma_f32_16x16x32_bf16 v[28:31], a[112:115], a[80:83], 0
    v_exp_f32 v18, v18
    v_mfma_f32_16x16x32_bf16 v[28:31], a[116:119], a[84:87], v[28:31]
    ds_read_b128 a[108:111], v4 offset:49920
    ds_read_b128 a[112:115], v4 offset:57344
    v_mfma_f32_16x16x32_bf16 v[28:31], a[120:123], a[88:91], v[28:31]
    v_exp_f32 v19, v19
    v_mfma_f32_16x16x32_bf16 v[28:31], a[124:127], a[92:95], v[28:31]
    ds_read_b128 a[116:119], v4 offset:57600
    v_cvt_pk_bf16_f32 v33, v18, v19
    v_mfma_f32_16x16x32_bf16 v[160:163], a[128:131], v[36:39], v[160:163]
L_m5:
    s_cbranch_execz L_back
    v_exp_f32 v20, v20
    v_mfma_f32_16x16x32_bf16 v[164:167], a[132:135], v[36:39], v[164:167]
    ds_read_b128 a[120:123], v4 offset:57856
    ds_read_b128 a[124:127], v4 offset:58112
    v_mfma_f32_16x16x32_bf16 v[168:171], a[136:139], v[36:39], v[168:171]
    v_exp_f32 v21, v21
    v_cvt_pk_bf16_f32 v40, v40, v41
    v_mfma_f32_16x16x32_bf16 v[172:175], a[140:143], v[36:39], v[172:175]
    v_cvt_pk_bf16_f32 v34, v20, v21
    v_accvgpr_write_b32 a199, v40
    v_mfma_f32_16x16x32_bf16 v[176:179], a[144:147], v[36:39], v[176:179]
    v_exp_f32 v22, v22
    v_mfma_f32_16x16x32_bf16 v[180:183], a[148:151], v[36:39], v[180:183]
    buffer_load_dwordx4 v3, s[24:27], s71 offen offset:3072 nt lds
    v_mfma_f32_16x16x32_bf16 v[184:187], a[152:155], v[36:39], v[184:187]
    v_exp_f32 v23, v23
    v_mfma_f32_16x16x32_bf16 v[188:191], a[156:159], v[36:39], v[188:191]
    v_cvt_pk_bf16_f32 v35, v22, v23
    v_accvgpr_read_b32 v41, a200
    v_mfma_f32_16x16x32_bf16 a[236:239], a[248:251], v[36:39], a[236:239]
    s_waitcnt lgkmcnt(7)
    v_lshlrev_b32 v40, 16, v41
    v_and_b32 v41, s35, v41
    v_mfma_f32_16x16x32_bf16 v[16:19], a[96:99], a[0:3], 0
    s_waitcnt lgkmcnt(6)
    v_exp_f32 v24, v24
    v_mfma_f32_16x16x32_bf16 v[16:19], a[100:103], a[4:7], v[16:19]
    s_waitcnt lgkmcnt(5)
    v_mul_f32 v40, s34, v40
    v_mul_f32 v41, s34, v41
    v_mfma_f32_16x16x32_bf16 v[16:19], a[104:107], a[8:11], v[16:19]
    s_waitcnt lgkmcnt(4)
    v_exp_f32 v25, v25
    v_mfma_f32_16x16x32_bf16 v[16:19], a[108:111], a[12:15], v[16:19]
    s_waitcnt lgkmcnt(3)
    v_cvt_pk_bf16_f32 v36, v24, v25
    v_cvt_pk_bf16_f32 v40, v40, v41
    v_mfma_f32_16x16x32_bf16 v[20:23], a[112:115], a[0:3], 0
    s_waitcnt lgkmcnt(2)
    v_exp_f32 v26, v26
    v_mfma_f32_16x16x32_bf16 v[20:23], a[116:119], a[4:7], v[20:23]
    s_waitcnt lgkmcnt(1)
    v_accvgpr_write_b32 a200, v40
    v_accvgpr_read_b32 v41, a201
    v_mfma_f32_16x16x32_bf16 v[20:23], a[120:123], a[8:11], v[20:23]
    s_waitcnt lgkmcnt(0)
    v_exp_f32 v27, v27
    v_mfma_f32_16x16x32_bf16 v[20:23], a[124:127], a[12:15], v[20:23]
    v_cvt_pk_bf16_f32 v37, v26, v27
    v_lshlrev_b32 v40, 16, v41
    v_mfma_f32_16x16x32_bf16 v[192:195], a[128:131], v[32:35], v[192:195]
    v_exp_f32 v28, v28
    v_mfma_f32_16x16x32_bf16 v[196:199], a[132:135], v[32:35], v[196:199]
    v_and_b32 v41, s35, v41
    v_mul_f32 v40, s34, v40
    v_mfma_f32_16x16x32_bf16 v[200:203], a[136:139], v[32:35], v[200:203]
    v_exp_f32 v29, v29
    v_mul_f32 v41, s34, v41
    v_mfma_f32_16x16x32_bf16 v[204:207], a[140:143], v[32:35], v[204:207]
    v_cvt_pk_bf16_f32 v38, v28, v29
    v_cvt_pk_bf16_f32 v40, v40, v41
    v_mfma_f32_16x16x32_bf16 v[208:211], a[144:147], v[32:35], v[208:211]
    v_exp_f32 v30, v30
    v_mfma_f32_16x16x32_bf16 v[212:215], a[148:151], v[32:35], v[212:215]
    v_accvgpr_write_b32 a201, v40
    v_accvgpr_read_b32 v41, a202
    v_mfma_f32_16x16x32_bf16 v[216:219], a[152:155], v[32:35], v[216:219]
    v_exp_f32 v31, v31
    v_mfma_f32_16x16x32_bf16 v[220:223], a[156:159], v[32:35], v[220:223]
    v_cvt_pk_bf16_f32 v39, v30, v31
    v_lshlrev_b32 v40, 16, v41
    v_mfma_f32_16x16x32_bf16 a[240:243], a[248:251], v[32:35], a[240:243]
    v_and_b32 v41, s35, v41
    v_mul_f32 v40, s34, v40
    v_mfma_f32_16x16x32_bf16 v[24:27], a[96:99], a[16:19], 0
    v_exp_f32 v16, v16
    v_mfma_f32_16x16x32_bf16 v[24:27], a[100:103], a[20:23], v[24:27]
    v_mul_f32 v41, s34, v41
    v_cvt_pk_bf16_f32 v40, v40, v41
    v_mfma_f32_16x16x32_bf16 v[24:27], a[104:107], a[24:27], v[24:27]
    v_exp_f32 v17, v17
    v_mfma_f32_16x16x32_bf16 v[24:27], a[108:111], a[28:31], v[24:27]
    v_cvt_pk_bf16_f32 v32, v16, v17
    v_accvgpr_write_b32 a202, v40
    v_mfma_f32_16x16x32_bf16 v[28:31], a[112:115], a[16:19], 0
    v_exp_f32 v18, v18
    v_mfma_f32_16x16x32_bf16 v[28:31], a[116:119], a[20:23], v[28:31]
    v_accvgpr_read_b32 v41, a203
    v_lshlrev_b32 v40, 16, v41
    v_mfma_f32_16x16x32_bf16 v[28:31], a[120:123], a[24:27], v[28:31]
    v_exp_f32 v19, v19
    v_mfma_f32_16x16x32_bf16 v[28:31], a[124:127], a[28:31], v[28:31]
    v_cvt_pk_bf16_f32 v33, v18, v19
    v_and_b32 v41, s35, v41
    v_mfma_f32_16x16x32_bf16 v[224:227], a[128:131], v[36:39], v[224:227]
    v_exp_f32 v20, v20
    v_mfma_f32_16x16x32_bf16 v[228:231], a[132:135], v[36:39], v[228:231]
    ds_read_b64_tr_b16 a[128:129], v7 offset:49152
    ds_read_b64_tr_b16 a[130:131], v7 offset:57344
    v_mfma_f32_16x16x32_bf16 v[232:235], a[136:139], v[36:39], v[232:235]
    v_exp_f32 v21, v21
    v_mul_f32 v40, s34, v40
    v_mfma_f32_16x16x32_bf16 v[236:239], a[140:143], v[36:39], v[236:239]
    ds_read_b64_tr_b16 a[132:133], v7 offset:49160
    v_cvt_pk_bf16_f32 v34, v20, v21
    v_mfma_f32_16x16x32_bf16 v[240:243], a[144:147], v[36:39], v[240:243]
    v_exp_f32 v22, v22
    v_mfma_f32_16x16x32_bf16 v[244:247], a[148:151], v[36:39], v[244:247]
    ds_read_b64_tr_b16 a[134:135], v7 offset:57352
    ds_read_b64_tr_b16 a[136:137], v7 offset:49408
    v_mfma_f32_16x16x32_bf16 v[248:251], a[152:155], v[36:39], v[248:251]
    v_exp_f32 v23, v23
    v_mfma_f32_16x16x32_bf16 v[252:255], a[156:159], v[36:39], v[252:255]
    ds_read_b64_tr_b16 a[138:139], v7 offset:57600
    v_cvt_pk_bf16_f32 v35, v22, v23
    v_mfma_f32_16x16x32_bf16 a[244:247], a[248:251], v[36:39], a[244:247]
    ds_read_b64_tr_b16 a[140:141], v7 offset:49416
    ds_read_b64_tr_b16 a[142:143], v7 offset:57608
    v_mfma_f32_16x16x32_bf16 v[16:19], a[96:99], a[32:35], 0
    v_exp_f32 v24, v24
    v_mfma_f32_16x16x32_bf16 v[16:19], a[100:103], a[36:39], v[16:19]
    ds_read_b64_tr_b16 a[144:145], v7 offset:49664
    ds_read_b64_tr_b16 a[146:147], v7 offset:57856
    v_mfma_f32_16x16x32_bf16 v[16:19], a[104:107], a[40:43], v[16:19]
    v_exp_f32 v25, v25
    v_mfma_f32_16x16x32_bf16 v[16:19], a[108:111], a[44:47], v[16:19]
    ds_read_b64_tr_b16 a[148:149], v7 offset:49672
    v_cvt_pk_bf16_f32 v36, v24, v25
    v_mfma_f32_16x16x32_bf16 v[20:23], a[112:115], a[32:35], 0
    v_exp_f32 v26, v26
    v_mfma_f32_16x16x32_bf16 v[20:23], a[116:119], a[36:39], v[20:23]
    ds_read_b64_tr_b16 a[150:151], v7 offset:57864
    ds_read_b64_tr_b16 a[152:153], v7 offset:49920
    v_mfma_f32_16x16x32_bf16 v[20:23], a[120:123], a[40:43], v[20:23]
    v_exp_f32 v27, v27
    v_mfma_f32_16x16x32_bf16 v[20:23], a[124:127], a[44:47], v[20:23]
    s_waitcnt lgkmcnt(11)
    ds_read_b64_tr_b16 a[154:155], v7 offset:58112
    v_cvt_pk_bf16_f32 v37, v26, v27
    v_mfma_f32_16x16x32_bf16 v[64:67], a[128:131], v[32:35], v[64:67]
    s_waitcnt lgkmcnt(10)
    v_exp_f32 v28, v28
    v_mfma_f32_16x16x32_bf16 v[68:71], a[132:135], v[32:35], v[68:71]
    s_waitcnt lgkmcnt(8)
    ds_read_b64_tr_b16 a[156:157], v7 offset:49928
    ds_read_b64_tr_b16 a[158:159], v7 offset:58120
    v_mfma_f32_16x16x32_bf16 v[72:75], a[136:139], v[32:35], v[72:75]
    s_waitcnt lgkmcnt(8)
    v_exp_f32 v29, v29
    v_mul_f32 v41, s34, v41
    v_mfma_f32_16x16x32_bf16 v[76:79], a[140:143], v[32:35], v[76:79]
    s_waitcnt lgkmcnt(6)
    v_cvt_pk_bf16_f32 v38, v28, v29
    v_cvt_pk_bf16_f32 v40, v40, v41
    v_mfma_f32_16x16x32_bf16 v[80:83], a[144:147], v[32:35], v[80:83]
    s_waitcnt lgkmcnt(4)
    v_exp_f32 v30, v30
    v_mfma_f32_16x16x32_bf16 v[84:87], a[148:151], v[32:35], v[84:87]
    s_waitcnt lgkmcnt(2)
    v_accvgpr_write_b32 a203, v40
    v_accvgpr_read_b32 v41, a204
    v_mfma_f32_16x16x32_bf16 v[88:91], a[152:155], v[32:35], v[88:91]
    s_waitcnt lgkmcnt(0)
    v_exp_f32 v31, v31
    v_mfma_f32_16x16x32_bf16 v[92:95], a[156:159], v[32:35], v[92:95]
    v_cvt_pk_bf16_f32 v39, v30, v31
    v_lshlrev_b32 v40, 16, v41
    v_mfma_f32_16x16x32_bf16 a[224:227], a[248:251], v[32:35], a[224:227]
    v_and_b32 v41, s35, v41
    v_mul_f32 v40, s34, v40
    v_mfma_f32_16x16x32_bf16 v[24:27], a[96:99], a[48:51], 0
    v_exp_f32 v16, v16
    v_mfma_f32_16x16x32_bf16 v[24:27], a[100:103], a[52:55], v[24:27]
    v_mul_f32 v41, s34, v41
    v_cvt_pk_bf16_f32 v40, v40, v41
    v_mfma_f32_16x16x32_bf16 v[24:27], a[104:107], a[56:59], v[24:27]
    v_exp_f32 v17, v17
    v_mfma_f32_16x16x32_bf16 v[24:27], a[108:111], a[60:63], v[24:27]
    v_cvt_pk_bf16_f32 v32, v16, v17
    v_accvgpr_write_b32 a204, v40
    v_mfma_f32_16x16x32_bf16 v[28:31], a[112:115], a[48:51], 0
    v_exp_f32 v18, v18
    v_mfma_f32_16x16x32_bf16 v[28:31], a[116:119], a[52:55], v[28:31]
    v_accvgpr_read_b32 v41, a205
    v_lshlrev_b32 v40, 16, v41
    v_mfma_f32_16x16x32_bf16 v[28:31], a[120:123], a[56:59], v[28:31]
    v_exp_f32 v19, v19
    v_mfma_f32_16x16x32_bf16 v[28:31], a[124:127], a[60:63], v[28:31]
    v_cvt_pk_bf16_f32 v33, v18, v19
    v_and_b32 v41, s35, v41
    v_mfma_f32_16x16x32_bf16 v[96:99], a[128:131], v[36:39], v[96:99]
    v_exp_f32 v20, v20
    v_mfma_f32_16x16x32_bf16 v[100:103], a[132:135], v[36:39], v[100:103]
    v_mul_f32 v40, s34, v40
    v_mul_f32 v41, s34, v41
    v_mfma_f32_16x16x32_bf16 v[104:107], a[136:139], v[36:39], v[104:107]
    v_exp_f32 v21, v21
    v_mfma_f32_16x16x32_bf16 v[108:111], a[140:143], v[36:39], v[108:111]
    v_cvt_pk_bf16_f32 v34, v20, v21
    v_cvt_pk_bf16_f32 v40, v40, v41
    v_accvgpr_write_b32 a205, v40
    v_mfma_f32_16x16x32_bf16 v[112:115], a[144:147], v[36:39], v[112:115]
    v_exp_f32 v22, v22
    v_mfma_f32_16x16x32_bf16 v[116:119], a[148:151], v[36:39], v[116:119]
    v_accvgpr_read_b32 v41, a206
    v_lshlrev_b32 v40, 16, v41
    v_mfma_f32_16x16x32_bf16 v[120:123], a[152:155], v[36:39], v[120:123]
    v_exp_f32 v23, v23
    v_mfma_f32_16x16x32_bf16 v[124:127], a[156:159], v[36:39], v[124:127]
    v_cvt_pk_bf16_f32 v35, v22, v23
    v_and_b32 v41, s35, v41
    v_mfma_f32_16x16x32_bf16 a[228:231], a[248:251], v[36:39], a[228:231]
    v_mul_f32 v40, s34, v40
    v_mul_f32 v41, s34, v41
    v_mfma_f32_16x16x32_bf16 v[16:19], a[96:99], a[64:67], 0
    v_exp_f32 v24, v24
    v_mfma_f32_16x16x32_bf16 v[16:19], a[100:103], a[68:71], v[16:19]
    v_cvt_pk_bf16_f32 v40, v40, v41
    v_accvgpr_write_b32 a206, v40
    v_mfma_f32_16x16x32_bf16 v[16:19], a[104:107], a[72:75], v[16:19]
    v_exp_f32 v25, v25
    v_mfma_f32_16x16x32_bf16 v[16:19], a[108:111], a[76:79], v[16:19]
    v_cvt_pk_bf16_f32 v36, v24, v25
    v_accvgpr_read_b32 v41, a207
    v_mfma_f32_16x16x32_bf16 v[20:23], a[112:115], a[64:67], 0
    v_exp_f32 v26, v26
    v_mfma_f32_16x16x32_bf16 v[20:23], a[116:119], a[68:71], v[20:23]
    v_lshlrev_b32 v40, 16, v41
    v_and_b32 v41, s35, v41
    v_mfma_f32_16x16x32_bf16 v[20:23], a[120:123], a[72:75], v[20:23]
    v_exp_f32 v27, v27
    v_mfma_f32_16x16x32_bf16 v[20:23], a[124:127], a[76:79], v[20:23]
    v_cvt_pk_bf16_f32 v37, v26, v27
    v_mul_f32 v40, s34, v40
    v_mfma_f32_16x16x32_bf16 v[128:131], a[128:131], v[32:35], v[128:131]
    v_exp_f32 v28, v28
    v_mfma_f32_16x16x32_bf16 v[132:135], a[132:135], v[32:35], v[132:135]
    v_mul_f32 v41, s34, v41
    v_cvt_pk_bf16_f32 v40, v40, v41
    v_mfma_f32_16x16x32_bf16 v[136:139], a[136:139], v[32:35], v[136:139]
    v_exp_f32 v29, v29
    v_mfma_f32_16x16x32_bf16 v[140:143], a[140:143], v[32:35], v[140:143]
    v_cvt_pk_bf16_f32 v38, v28, v29
    v_accvgpr_write_b32 a207, v40
    v_accvgpr_read_b32 v41, a208
    v_mfma_f32_16x16x32_bf16 v[144:147], a[144:147], v[32:35], v[144:147]
    v_exp_f32 v30, v30
    v_mfma_f32_16x16x32_bf16 v[148:151], a[148:151], v[32:35], v[148:151]
    v_lshlrev_b32 v40, 16, v41
    v_and_b32 v41, s35, v41
    v_mfma_f32_16x16x32_bf16 v[152:155], a[152:155], v[32:35], v[152:155]
    v_exp_f32 v31, v31
    v_mfma_f32_16x16x32_bf16 v[156:159], a[156:159], v[32:35], v[156:159]
    s_waitcnt vmcnt(4)
    v_cvt_pk_bf16_f32 v39, v30, v31
    v_mul_f32 v40, s34, v40
    v_mfma_f32_16x16x32_bf16 a[232:235], a[248:251], v[32:35], a[232:235]
    s_barrier
    v_mfma_f32_16x16x32_bf16 v[24:27], a[96:99], a[80:83], 0
    v_exp_f32 v16, v16
    v_mfma_f32_16x16x32_bf16 v[24:27], a[100:103], a[84:87], v[24:27]
    ds_read_b128 a[96:99], v5 offset:0
    ds_read_b128 a[100:103], v5 offset:256
    v_mfma_f32_16x16x32_bf16 v[24:27], a[104:107], a[88:91], v[24:27]
    v_exp_f32 v17, v17
    v_mfma_f32_16x16x32_bf16 v[24:27], a[108:111], a[92:95], v[24:27]
    ds_read_b128 a[104:107], v5 offset:512
    v_cvt_pk_bf16_f32 v32, v16, v17
    v_mfma_f32_16x16x32_bf16 v[28:31], a[112:115], a[80:83], 0
    v_exp_f32 v18, v18
    v_mfma_f32_16x16x32_bf16 v[28:31], a[116:119], a[84:87], v[28:31]
    ds_read_b128 a[108:111], v5 offset:768
    ds_read_b128 a[112:115], v5 offset:8192
    v_mfma_f32_16x16x32_bf16 v[28:31], a[120:123], a[88:91], v[28:31]
    v_exp_f32 v19, v19
    v_mfma_f32_16x16x32_bf16 v[28:31], a[124:127], a[92:95], v[28:31]
    ds_read_b128 a[116:119], v5 offset:8448
    v_cvt_pk_bf16_f32 v33, v18, v19
    v_mfma_f32_16x16x32_bf16 v[160:163], a[128:131], v[36:39], v[160:163]
    v_exp_f32 v20, v20
    v_mfma_f32_16x16x32_bf16 v[164:167], a[132:135], v[36:39], v[164:167]
    ds_read_b128 a[120:123], v5 offset:8704
    ds_read_b128 a[124:127], v5 offset:8960
    v_mfma_f32_16x16x32_bf16 v[168:171], a[136:139], v[36:39], v[168:171]
    v_exp_f32 v21, v21
    v_mfma_f32_16x16x32_bf16 v[172:175], a[140:143], v[36:39], v[172:175]
    v_cvt_pk_bf16_f32 v34, v20, v21
    v_mul_f32 v41, s34, v41
    v_mfma_f32_16x16x32_bf16 v[176:179], a[144:147], v[36:39], v[176:179]
    v_exp_f32 v22, v22
    v_cvt_pk_bf16_f32 v40, v40, v41
    v_mfma_f32_16x16x32_bf16 v[180:183], a[148:151], v[36:39], v[180:183]
    v_accvgpr_write_b32 a208, v40
    v_accvgpr_read_b32 v41, a209
    v_mfma_f32_16x16x32_bf16 v[184:187], a[152:155], v[36:39], v[184:187]
    v_exp_f32 v23, v23
    v_mfma_f32_16x16x32_bf16 v[188:191], a[156:159], v[36:39], v[188:191]
    v_cvt_pk_bf16_f32 v35, v22, v23
    v_lshlrev_b32 v40, 16, v41
    v_mfma_f32_16x16x32_bf16 a[236:239], a[248:251], v[36:39], a[236:239]
    s_waitcnt lgkmcnt(7)
    v_and_b32 v41, s35, v41
    v_mul_f32 v40, s34, v40
    v_mfma_f32_16x16x32_bf16 v[16:19], a[96:99], a[0:3], 0
    s_waitcnt lgkmcnt(6)
    v_exp_f32 v24, v24
    v_mfma_f32_16x16x32_bf16 v[16:19], a[100:103], a[4:7], v[16:19]
    s_waitcnt lgkmcnt(5)
    v_mul_f32 v41, s34, v41
    v_cvt_pk_bf16_f32 v40, v40, v41
    v_mfma_f32_16x16x32_bf16 v[16:19], a[104:107], a[8:11], v[16:19]
    s_waitcnt lgkmcnt(4)
    v_exp_f32 v25, v25
    v_mfma_f32_16x16x32_bf16 v[16:19], a[108:111], a[12:15], v[16:19]
    s_waitcnt lgkmcnt(3)
    v_cvt_pk_bf16_f32 v36, v24, v25
    v_accvgpr_write_b32 a209, v40
    v_mfma_f32_16x16x32_bf16 v[20:23], a[112:115], a[0:3], 0
    s_waitcnt lgkmcnt(2)
    v_exp_f32 v26, v26
    v_mfma_f32_16x16x32_bf16 v[20:23], a[116:119], a[4:7], v[20:23]
    s_waitcnt lgkmcnt(1)
    v_accvgpr_read_b32 v41, a210
    v_lshlrev_b32 v40, 16, v41
    v_mfma_f32_16x16x32_bf16 v[20:23], a[120:123], a[8:11], v[20:23]
    s_waitcnt lgkmcnt(0)
    v_exp_f32 v27, v27
    v_mfma_f32_16x16x32_bf16 v[20:23], a[124:127], a[12:15], v[20:23]
    v_cvt_pk_bf16_f32 v37, v26, v27
    v_and_b32 v41, s35, v41
    v_mfma_f32_16x16x32_bf16 v[192:195], a[128:131], v[32:35], v[192:195]
    v_exp_f32 v28, v28
    v_mfma_f32_16x16x32_bf16 v[196:199], a[132:135], v[32:35], v[196:199]
    v_mul_f32 v40, s34, v40
    v_mul_f32 v41, s34, v41
    v_mfma_f32_16x16x32_bf16 v[200:203], a[136:139], v[32:35], v[200:203]
    v_exp_f32 v29, v29
    v_mfma_f32_16x16x32_bf16 v[204:207], a[140:143], v[32:35], v[204:207]
    v_cvt_pk_bf16_f32 v38, v28, v29
    v_cvt_pk_bf16_f32 v40, v40, v41
    v_mfma_f32_16x16x32_bf16 v[208:211], a[144:147], v[32:35], v[208:211]
    v_exp_f32 v30, v30
    v_mfma_f32_16x16x32_bf16 v[212:215], a[148:151], v[32:35], v[212:215]
    v_accvgpr_write_b32 a210, v40
    v_accvgpr_read_b32 v41, a211
    v_lshlrev_b32 v40, 16, v41
    v_mfma_f32_16x16x32_bf16 v[216:219], a[152:155], v[32:35], v[216:219]
    v_exp_f32 v31, v31
    v_mfma_f32_16x16x32_bf16 v[220:223], a[156:159], v[32:35], v[220:223]
    v_cvt_pk_bf16_f32 v39, v30, v31
    v_and_b32 v41, s35, v41
    v_mfma_f32_16x16x32_bf16 a[240:243], a[248:251], v[32:35], a[240:243]
    v_mul_f32 v40, s34, v40
    v_mul_f32 v41, s34, v41
    v_mfma_f32_16x16x32_bf16 v[24:27], a[96:99], a[16:19], 0
    v_exp_f32 v16, v16
    v_mfma_f32_16x16x32_bf16 v[24:27], a[100:103], a[20:23], v[24:27]
    v_cvt_pk_bf16_f32 v40, v40, v41
    v_accvgpr_write_b32 a211, v40
    v_mfma_f32_16x16x32_bf16 v[24:27], a[104:107], a[24:27], v[24:27]
    v_exp_f32 v17, v17
    v_mfma_f32_16x16x32_bf16 v[24:27], a[108:111], a[28:31], v[24:27]
    v_cvt_pk_bf16_f32 v32, v16, v17
    v_accvgpr_read_b32 v41, a212
    v_mfma_f32_16x16x32_bf16 v[28:31], a[112:115], a[16:19], 0
    v_exp_f32 v18, v18
    v_mfma_f32_16x16x32_bf16 v[28:31], a[116:119], a[20:23], v[28:31]
    v_lshlrev_b32 v40, 16, v41
    v_and_b32 v41, s35, v41
    v_mfma_f32_16x16x32_bf16 v[28:31], a[120:123], a[24:27], v[28:31]
    v_exp_f32 v19, v19
    v_mfma_f32_16x16x32_bf16 v[28:31], a[124:127], a[28:31], v[28:31]
    v_cvt_pk_bf16_f32 v33, v18, v19
    v_mul_f32 v40, s34, v40
    v_mfma_f32_16x16x32_bf16 v[224:227], a[128:131], v[36:39], v[224:227]
    v_exp_f32 v20, v20
    v_mfma_f32_16x16x32_bf16 v[228:231], a[132:135], v[36:39], v[228:231]
    ds_read_b64_tr_b16 a[128:129], v8 offset:0
    ds_read_b64_tr_b16 a[130:131], v8 offset:8192
    v_mfma_f32_16x16x32_bf16 v[232:235], a[136:139], v[36:39], v[232:235]
    v_exp_f32 v21, v21
    v_mfma_f32_16x16x32_bf16 v[236:239], a[140:143], v[36:39], v[236:239]
    ds_read_b64_tr_b16 a[132:133], v8 offset:8
    v_cvt_pk_bf16_f32 v34, v20, v21
    v_mfma_f32_16x16x32_bf16 v[240:243], a[144:147], v[36:39], v[240:243]
    v_exp_f32 v22, v22
    v_mfma_f32_16x16x32_bf16 v[244:247], a[148:151], v[36:39], v[244:247]
    ds_read_b64_tr_b16 a[134:135], v8 offset:8200
    ds_read_b64_tr_b16 a[136:137], v8 offset:256
    v_mul_f32 v41, s34, v41
    v_mfma_f32_16x16x32_bf16 v[248:251], a[152:155], v[36:39], v[248:251]
    v_exp_f32 v23, v23
    v_mfma_f32_16x16x32_bf16 v[252:255], a[156:159], v[36:39], v[252:255]
    ds_read_b64_tr_b16 a[138:139], v8 offset:8448
    v_cvt_pk_bf16_f32 v35, v22, v23
    v_mfma_f32_16x16x32_bf16 a[244:247], a[248:251], v[36:39], a[244:247]
    ds_read_b64_tr_b16 a[140:141], v8 offset:264
    ds_read_b64_tr_b16 a[142:143], v8 offset:8456
    v_mfma_f32_16x16x32_bf16 v[16:19], a[96:99], a[32:35], 0
    v_exp_f32 v24, v24
    v_mfma_f32_16x16x32_bf16 v[16:19], a[100:103], a[36:39], v[16:19]
    ds_read_b64_tr_b16 a[144:145], v8 offset:512
    ds_read_b64_tr_b16 a[146:147], v8 offset:8704
    v_mfma_f32_16x16x32_bf16 v[16:19], a[104:107], a[40:43], v[16:19]
    v_exp_f32 v25, v25
    v_mfma_f32_16x16x32_bf16 v[16:19], a[108:111], a[44:47], v[16:19]
    ds_read_b64_tr_b16 a[148:149], v8 offset:520
    v_cvt_pk_bf16_f32 v36, v24, v25
    v_mfma_f32_16x16x32_bf16 v[20:23], a[112:115], a[32:35], 0
    v_exp_f32 v26, v26
    v_mfma_f32_16x16x32_bf16 v[20:23], a[116:119], a[36:39], v[20:23]
    ds_read_b64_tr_b16 a[150:151], v8 offset:8712
    ds_read_b64_tr_b16 a[152:153], v8 offset:768
    v_mfma_f32_16x16x32_bf16 v[20:23], a[120:123], a[40:43], v[20:23]
    v_exp_f32 v27, v27
    v_mfma_f32_16x16x32_bf16 v[20:23], a[124:127], a[44:47], v[20:23]
    s_waitcnt lgkmcnt(11)
    ds_read_b64_tr_b16 a[154:155], v8 offset:8960
    v_cvt_pk_bf16_f32 v37, v26, v27
    v_mfma_f32_16x16x32_bf16 v[64:67], a[128:131], v[32:35], v[64:67]
    s_waitcnt lgkmcnt(10)
    v_exp_f32 v28, v28
    v_mfma_f32_16x16x32_bf16 v[68:71], a[132:135], v[32:35], v[68:71]
    s_waitcnt lgkmcnt(8)
    ds_read_b64_tr_b16 a[156:157], v8 offset:776
    ds_read_b64_tr_b16 a[158:159], v8 offset:8968
    v_mfma_f32_16x16x32_bf16 v[72:75], a[136:139], v[32:35], v[72:75]
    s_waitcnt lgkmcnt(8)
    v_exp_f32 v29, v29
    v_mfma_f32_16x16x32_bf16 v[76:79], a[140:143], v[32:35], v[76:79]
    s_waitcnt lgkmcnt(6)
    v_cvt_pk_bf16_f32 v38, v28, v29
    v_cvt_pk_bf16_f32 v40, v40, v41
    v_mfma_f32_16x16x32_bf16 v[80:83], a[144:147], v[32:35], v[80:83]
    s_waitcnt lgkmcnt(4)
    v_exp_f32 v30, v30
    v_mfma_f32_16x16x32_bf16 v[84:87], a[148:151], v[32:35], v[84:87]
    s_waitcnt lgkmcnt(2)
    v_accvgpr_write_b32 a212, v40
    v_accvgpr_read_b32 v41, a213
    v_lshlrev_b32 v40, 16, v41
    v_mfma_f32_16x16x32_bf16 v[88:91], a[152:155], v[32:35], v[88:91]
    s_waitcnt lgkmcnt(0)
    v_exp_f32 v31, v31
    v_mfma_f32_16x16x32_bf16 v[92:95], a[156:159], v[32:35], v[92:95]
    v_cvt_pk_bf16_f32 v39, v30, v31
    v_and_b32 v41, s35, v41
    v_mfma_f32_16x16x32_bf16 a[224:227], a[248:251], v[32:35], a[224:227]
    v_mul_f32 v40, s34, v40
    v_mul_f32 v41, s34, v41
    v_mfma_f32_16x16x32_bf16 v[24:27], a[96:99], a[48:51], 0
    v_exp_f32 v16, v16
    v_mfma_f32_16x16x32_bf16 v[24:27], a[100:103], a[52:55], v[24:27]
    v_cvt_pk_bf16_f32 v40, v40, v41
    v_accvgpr_write_b32 a213, v40
    v_mfma_f32_16x16x32_bf16 v[24:27], a[104:107], a[56:59], v[24:27]
    v_exp_f32 v17, v17
    v_mfma_f32_16x16x32_bf16 v[24:27], a[108:111], a[60:63], v[24:27]
    v_cvt_pk_bf16_f32 v32, v16, v17
    v_accvgpr_read_b32 v41, a214
    v_mfma_f32_16x16x32_bf16 v[28:31], a[112:115], a[48:51], 0
    v_exp_f32 v18, v18
    v_mfma_f32_16x16x32_bf16 v[28:31], a[116:119], a[52:55], v[28:31]
    v_lshlrev_b32 v40, 16, v41
    v_and_b32 v41, s35, v41
    v_mfma_f32_16x16x32_bf16 v[28:31], a[120:123], a[56:59], v[28:31]
    v_exp_f32 v19, v19
    v_mfma_f32_16x16x32_bf16 v[28:31], a[124:127], a[60:63], v[28:31]
    v_cvt_pk_bf16_f32 v33, v18, v19
    v_mul_f32 v40, s34, v40
    v_mfma_f32_16x16x32_bf16 v[96:99], a[128:131], v[36:39], v[96:99]
    v_exp_f32 v20, v20
    v_mfma_f32_16x16x32_bf16 v[100:103], a[132:135], v[36:39], v[100:103]
    v_mul_f32 v41, s34, v41
    v_cvt_pk_bf16_f32 v40, v40, v41
    v_mfma_f32_16x16x32_bf16 v[104:107], a[136:139], v[36:39], v[104:107]
    v_exp_f32 v21, v21
    v_mfma_f32_16x16x32_bf16 v[108:111], a[140:143], v[36:39], v[108:111]
    v_cvt_pk_bf16_f32 v34, v20, v21
    v_accvgpr_write_b32 a214, v40
    v_mfma_f32_16x16x32_bf16 v[112:115], a[144:147], v[36:39], v[112:115]
    v_exp_f32 v22, v22
    v_mfma_f32_16x16x32_bf16 v[116:119], a[148:151], v[36:39], v[116:119]
    v_accvgpr_read_b32 v41, a215
    v_lshlrev_b32 v40, 16, v41
    v_mfma_f32_16x16x32_bf16 v[120:123], a[152:155], v[36:39], v[120:123]
    v_exp_f32 v23, v23
    v_and_b32 v41, s35, v41
    v_mfma_f32_16x16x32_bf16 v[124:127], a[156:159], v[36:39], v[124:127]
    v_cvt_pk_bf16_f32 v35, v22, v23
    v_mul_f32 v40, s34, v40
    v_mfma_f32_16x16x32_bf16 a[228:231], a[248:251], v[36:39], a[228:231]
    v_mul_f32 v41, s34, v41
    v_cvt_pk_bf16_f32 v40, v40, v41
    v_mfma_f32_16x16x32_bf16 v[16:19], a[96:99], a[64:67], 0
    v_exp_f32 v24, v24
    v_mfma_f32_16x16x32_bf16 v[16:19], a[100:103], a[68:71], v[16:19]
    v_accvgpr_write_b32 a215, v40
    v_accvgpr_read_b32 v41, a216
    v_mfma_f32_16x16x32_bf16 v[16:19], a[104:107], a[72:75], v[16:19]
    v_exp_f32 v25, v25
    v_mfma_f32_16x16x32_bf16 v[16:19], a[108:111], a[76:79], v[16:19]
    v_cvt_pk_bf16_f32 v36, v24, v25
    v_lshlrev_b32 v40, 16, v41
    v_mfma_f32_16x16x32_bf16 v[20:23], a[112:115], a[64:67], 0
    v_exp_f32 v26, v26
    v_mfma_f32_16x16x32_bf16 v[20:23], a[116:119], a[68:71], v[20:23]
    v_and_b32 v41, s35, v41
    v_mul_f32 v40, s34, v40
    v_mfma_f32_16x16x32_bf16 v[20:23], a[120:123], a[72:75], v[20:23]
    v_exp_f32 v27, v27
    v_mfma_f32_16x16x32_bf16 v[20:23], a[124:127], a[76:79], v[20:23]
    v_cvt_pk_bf16_f32 v37, v26, v27
    v_mul_f32 v41, s34, v41
    v_mfma_f32_16x16x32_bf16 v[128:131], a[128:131], v[32:35], v[128:131]
    v_exp_f32 v28, v28
    v_mfma_f32_16x16x32_bf16 v[132:135], a[132:135], v[32:35], v[132:135]
    v_cvt_pk_bf16_f32 v40, v40, v41
    v_accvgpr_write_b32 a216, v40
    v_mfma_f32_16x16x32_bf16 v[136:139], a[136:139], v[32:35], v[136:139]
    v_exp_f32 v29, v29
    v_mfma_f32_16x16x32_bf16 v[140:143], a[140:143], v[32:35], v[140:143]
    v_cvt_pk_bf16_f32 v38, v28, v29
    v_accvgpr_read_b32 v41, a217
    v_mfma_f32_16x16x32_bf16 v[144:147], a[144:147], v[32:35], v[144:147]
    v_exp_f32 v30, v30
    v_mfma_f32_16x16x32_bf16 v[148:151], a[148:151], v[32:35], v[148:151]
    v_lshlrev_b32 v40, 16, v41
    v_and_b32 v41, s35, v41
    v_mfma_f32_16x16x32_bf16 v[152:155], a[152:155], v[32:35], v[152:155]
    v_exp_f32 v31, v31
    v_mul_f32 v40, s34, v40
    v_mfma_f32_16x16x32_bf16 v[156:159], a[156:159], v[32:35], v[156:159]
    s_waitcnt vmcnt(0)
    v_cvt_pk_bf16_f32 v39, v30, v31
    v_mul_f32 v41, s34, v41
    v_mfma_f32_16x16x32_bf16 a[232:235], a[248:251], v[32:35], a[232:235]
    s_barrier
    v_mfma_f32_16x16x32_bf16 v[24:27], a[96:99], a[80:83], 0
    v_exp_f32 v16, v16
    v_mfma_f32_16x16x32_bf16 v[24:27], a[100:103], a[84:87], v[24:27]
    ds_read_b128 a[96:99], v5 offset:16384
    ds_read_b128 a[100:103], v5 offset:16640
    v_mfma_f32_16x16x32_bf16 v[24:27], a[104:107], a[88:91], v[24:27]
    v_exp_f32 v17, v17
    v_mfma_f32_16x16x32_bf16 v[24:27], a[108:111], a[92:95], v[24:27]
    ds_read_b128 a[104:107], v5 offset:16896
    v_cvt_pk_bf16_f32 v32, v16, v17
    v_mfma_f32_16x16x32_bf16 v[28:31], a[112:115], a[80:83], 0
    v_exp_f32 v18, v18
    v_mfma_f32_16x16x32_bf16 v[28:31], a[116:119], a[84:87], v[28:31]
    ds_read_b128 a[108:111], v5 offset:17152
    ds_read_b128 a[112:115], v5 offset:24576
    v_mfma_f32_16x16x32_bf16 v[28:31], a[120:123], a[88:91], v[28:31]
    v_exp_f32 v19, v19
    v_mfma_f32_16x16x32_bf16 v[28:31], a[124:127], a[92:95], v[28:31]
    ds_read_b128 a[116:119], v5 offset:24832
    v_cvt_pk_bf16_f32 v33, v18, v19
    v_mfma_f32_16x16x32_bf16 v[160:163], a[128:131], v[36:39], v[160:163]
    v_exp_f32 v20, v20
    v_mfma_f32_16x16x32_bf16 v[164:167], a[132:135], v[36:39], v[164:167]
    ds_read_b128 a[120:123], v5 offset:25088
    ds_read_b128 a[124:127], v5 offset:25344
    v_mfma_f32_16x16x32_bf16 v[168:171], a[136:139], v[36:39], v[168:171]
    v_exp_f32 v21, v21
    v_mfma_f32_16x16x32_bf16 v[172:175], a[140:143], v[36:39], v[172:175]
    v_cvt_pk_bf16_f32 v34, v20, v21
    v_add_u32 v4, s42, v4
    v_mfma_f32_16x16x32_bf16 v[176:179], a[144:147], v[36:39], v[176:179]
    v_exp_f32 v22, v22
    v_mfma_f32_16x16x32_bf16 v[180:183], a[148:151], v[36:39], v[180:183]
    v_add_u32 v5, s42, v5
    v_add_u32 v6, s42, v6
    v_mfma_f32_16x16x32_bf16 v[184:187], a[152:155], v[36:39], v[184:187]
    v_exp_f32 v23, v23
    v_mfma_f32_16x16x32_bf16 v[188:191], a[156:159], v[36:39], v[188:191]
    v_cvt_pk_bf16_f32 v35, v22, v23
    v_cvt_pk_bf16_f32 v40, v40, v41
    v_accvgpr_write_b32 a217, v40
    v_mfma_f32_16x16x32_bf16 a[236:239], a[248:251], v[36:39], a[236:239]
    s_waitcnt lgkmcnt(7)
    v_accvgpr_read_b32 v41, a218
    v_lshlrev_b32 v40, 16, v41
    v_mfma_f32_16x16x32_bf16 v[16:19], a[96:99], a[0:3], 0
    s_waitcnt lgkmcnt(6)
    v_exp_f32 v24, v24
    v_mfma_f32_16x16x32_bf16 v[16:19], a[100:103], a[4:7], v[16:19]
    s_waitcnt lgkmcnt(5)
    v_and_b32 v41, s35, v41
    v_mul_f32 v40, s34, v40
    v_mfma_f32_16x16x32_bf16 v[16:19], a[104:107], a[8:11], v[16:19]
    s_waitcnt lgkmcnt(4)
    v_exp_f32 v25, v25
    v_mfma_f32_16x16x32_bf16 v[16:19], a[108:111], a[12:15], v[16:19]
    s_waitcnt lgkmcnt(3)
    v_cvt_pk_bf16_f32 v36, v24, v25
    v_mul_f32 v41, s34, v41
    v_mfma_f32_16x16x32_bf16 v[20:23], a[112:115], a[0:3], 0
    s_waitcnt lgkmcnt(2)
    v_exp_f32 v26, v26
    v_mfma_f32_16x16x32_bf16 v[20:23], a[116:119], a[4:7], v[20:23]
    s_waitcnt lgkmcnt(1)
    v_cvt_pk_bf16_f32 v40, v40, v41
    v_accvgpr_write_b32 a218, v40
    v_mfma_f32_16x16x32_bf16 v[20:23], a[120:123], a[8:11], v[20:23]
    s_waitcnt lgkmcnt(0)
    v_exp_f32 v27, v27
    v_mfma_f32_16x16x32_bf16 v[20:23], a[124:127], a[12:15], v[20:23]
    v_cvt_pk_bf16_f32 v37, v26, v27
    v_accvgpr_read_b32 v41, a219
    v_mfma_f32_16x16x32_bf16 v[192:195], a[128:131], v[32:35], v[192:195]
    v_exp_f32 v28, v28
    v_mfma_f32_16x16x32_bf16 v[196:199], a[132:135], v[32:35], v[196:199]
    v_lshlrev_b32 v40, 16, v41
    v_and_b32 v41, s35, v41
    v_mfma_f32_16x16x32_bf16 v[200:203], a[136:139], v[32:35], v[200:203]
    v_exp_f32 v29, v29
    v_mfma_f32_16x16x32_bf16 v[204:207], a[140:143], v[32:35], v[204:207]
    v_cvt_pk_bf16_f32 v38, v28, v29
    v_mul_f32 v40, s34, v40
    v_mfma_f32_16x16x32_bf16 v[208:211], a[144:147], v[32:35], v[208:211]
    v_exp_f32 v30, v30
    v_mfma_f32_16x16x32_bf16 v[212:215], a[148:151], v[32:35], v[212:215]
    v_mul_f32 v41, s34, v41
    v_cvt_pk_bf16_f32 v40, v40, v41
    v_mfma_f32_16x16x32_bf16 v[216:219], a[152:155], v[32:35], v[216:219]
    v_exp_f32 v31, v31
    v_mfma_f32_16x16x32_bf16 v[220:223], a[156:159], v[32:35], v[220:223]
L_m6:
    s_cbranch_execz L_m7
    v_cvt_pk_bf16_f32 v39, v30, v31
    v_accvgpr_write_b32 a219, v40
    v_mfma_f32_16x16x32_bf16 a[240:243], a[248:251], v[32:35], a[240:243]
    v_accvgpr_read_b32 v41, a220
    v_lshlrev_b32 v40, 16, v41
    v_and_b32 v41, s35, v41
    v_mfma_f32_16x16x32_bf16 v[24:27], a[96:99], a[16:19], 0
    v_exp_f32 v16, v16
    v_mfma_f32_16x16x32_bf16 v[24:27], a[100:103], a[20:23], v[24:27]
    v_mul_f32 v40, s34, v40
    v_mul_f32 v41, s34, v41
    v_mfma_f32_16x16x32_bf16 v[24:27], a[104:107], a[24:27], v[24:27]
    v_exp_f32 v17, v17
    v_mfma_f32_16x16x32_bf16 v[24:27], a[108:111], a[28:31], v[24:27]
    v_cvt_pk_bf16_f32 v32, v16, v17
    v_cvt_pk_bf16_f32 v40, v40, v41
    v_mfma_f32_16x16x32_bf16 v[28:31], a[112:115], a[16:19], 0
    v_exp_f32 v18, v18
    v_mfma_f32_16x16x32_bf16 v[28:31], a[116:119], a[20:23], v[28:31]
    v_accvgpr_write_b32 a220, v40
    v_accvgpr_read_b32 v41, a221
    v_mfma_f32_16x16x32_bf16 v[28:31], a[120:123], a[24:27], v[28:31]
    v_exp_f32 v19, v19
    v_mfma_f32_16x16x32_bf16 v[28:31], a[124:127], a[28:31], v[28:31]
    v_cvt_pk_bf16_f32 v33, v18, v19
    v_lshlrev_b32 v40, 16, v41
    v_mfma_f32_16x16x32_bf16 v[224:227], a[128:131], v[36:39], v[224:227]
    v_exp_f32 v20, v20
    v_mfma_f32_16x16x32_bf16 v[228:231], a[132:135], v[36:39], v[228:231]
    ds_read_b64_tr_b16 a[128:129], v8 offset:16384
    ds_read_b64_tr_b16 a[130:131], v8 offset:24576
    v_mfma_f32_16x16x32_bf16 v[232:235], a[136:139], v[36:39], v[232:235]
    v_exp_f32 v21, v21
    v_mfma_f32_16x16x32_bf16 v[236:239], a[140:143], v[36:39], v[236:239]
    ds_read_b64_tr_b16 a[132:133], v8 offset:16392
    v_cvt_pk_bf16_f32 v34, v20, v21
    v_mfma_f32_16x16x32_bf16 v[240:243], a[144:147], v[36:39], v[240:243]
    v_exp_f32 v22, v22
    v_mfma_f32_16x16x32_bf16 v[244:247], a[148:151], v[36:39], v[244:247]
    ds_read_b64_tr_b16 a[134:135], v8 offset:24584
    ds_read_b64_tr_b16 a[136:137], v8 offset:16640
    v_mfma_f32_16x16x32_bf16 v[248:251], a[152:155], v[36:39], v[248:251]
    v_exp_f32 v23, v23
    v_mfma_f32_16x16x32_bf16 v[252:255], a[156:159], v[36:39], v[252:255]
    ds_read_b64_tr_b16 a[138:139], v8 offset:24832
    v_cvt_pk_bf16_f32 v35, v22, v23
    v_mfma_f32_16x16x32_bf16 a[244:247], a[248:251], v[36:39], a[244:247]
    ds_read_b64_tr_b16 a[140:141], v8 offset:16648
    ds_read_b64_tr_b16 a[142:143], v8 offset:24840
    v_and_b32 v41, s35, v41
    v_mfma_f32_16x16x32_bf16 v[16:19], a[96:99], a[32:35], 0
    v_exp_f32 v24, v24
    v_mfma_f32_16x16x32_bf16 v[16:19], a[100:103], a[36:39], v[16:19]
    ds_read_b64_tr_b16 a[144:145], v8 offset:16896
    ds_read_b64_tr_b16 a[146:147], v8 offset:25088
    v_mfma_f32_16x16x32_bf16 v[16:19], a[104:107], a[40:43], v[16:19]
    v_exp_f32 v25, v25
    v_mfma_f32_16x16x32_bf16 v[16:19], a[108:111], a[44:47], v[16:19]
    ds_read_b64_tr_b16 a[148:149], v8 offset:16904
    v_cvt_pk_bf16_f32 v36, v24, v25
    v_mfma_f32_16x16x32_bf16 v[20:23], a[112:115], a[32:35], 0
    v_exp_f32 v26, v26
    v_mfma_f32_16x16x32_bf16 v[20:23], a[116:119], a[36:39], v[20:23]
    ds_read_b64_tr_b16 a[150:151], v8 offset:25096
    ds_read_b64_tr_b16 a[152:153], v8 offset:17152
    v_mfma_f32_16x16x32_bf16 v[20:23], a[120:123], a[40:43], v[20:23]
    v_exp_f32 v27, v27
    v_mfma_f32_16x16x32_bf16 v[20:23], a[124:127], a[44:47], v[20:23]
    s_waitcnt lgkmcnt(11)
    ds_read_b64_tr_b16 a[154:155], v8 offset:25344
    v_cvt_pk_bf16_f32 v37, v26, v27
    v_mfma_f32_16x16x32_bf16 v[64:67], a[128:131], v[32:35], v[64:67]
    s_waitcnt lgkmcnt(10)
    v_exp_f32 v28, v28
    v_mfma_f32_16x16x32_bf16 v[68:71], a[132:135], v[32:35], v[68:71]
    s_waitcnt lgkmcnt(8)
    ds_read_b64_tr_b16 a[156:157], v8 offset:17160
    ds_read_b64_tr_b16 a[158:159], v8 offset:25352
    v_mfma_f32_16x16x32_bf16 v[72:75], a[136:139], v[32:35], v[72:75]
    s_waitcnt lgkmcnt(8)
    v_exp_f32 v29, v29
    v_mfma_f32_16x16x32_bf16 v[76:79], a[140:143], v[32:35], v[76:79]
    s_waitcnt lgkmcnt(6)
    v_cvt_pk_bf16_f32 v38, v28, v29
    v_add_u32 v7, s42, v7
    v_mfma_f32_16x16x32_bf16 v[80:83], a[144:147], v[32:35], v[80:83]
    s_waitcnt lgkmcnt(4)
    v_exp_f32 v30, v30
    v_mfma_f32_16x16x32_bf16 v[84:87], a[148:151], v[32:35], v[84:87]
    s_waitcnt lgkmcnt(2)
    v_add_u32 v8, s42, v8
    v_add_u32 v9, s42, v9
    v_mfma_f32_16x16x32_bf16 v[88:91], a[152:155], v[32:35], v[88:91]
    s_waitcnt lgkmcnt(0)
    v_exp_f32 v31, v31
    v_mfma_f32_16x16x32_bf16 v[92:95], a[156:159], v[32:35], v[92:95]
    v_cvt_pk_bf16_f32 v39, v30, v31
    v_mul_f32 v40, s34, v40
    v_mfma_f32_16x16x32_bf16 a[224:227], a[248:251], v[32:35], a[224:227]
    v_mul_f32 v41, s34, v41
    v_cvt_pk_bf16_f32 v40, v40, v41
    v_accvgpr_write_b32 a221, v40
    v_mfma_f32_16x16x32_bf16 v[24:27], a[96:99], a[48:51], 0
    v_exp_f32 v16, v16
    v_mfma_f32_16x16x32_bf16 v[24:27], a[100:103], a[52:55], v[24:27]
    v_accvgpr_read_b32 v41, a222
    v_lshlrev_b32 v40, 16, v41
    v_mfma_f32_16x16x32_bf16 v[24:27], a[104:107], a[56:59], v[24:27]
    v_exp_f32 v17, v17
    v_mfma_f32_16x16x32_bf16 v[24:27], a[108:111], a[60:63], v[24:27]
    v_cvt_pk_bf16_f32 v32, v16, v17
    v_and_b32 v41, s35, v41
    v_mfma_f32_16x16x32_bf16 v[28:31], a[112:115], a[48:51], 0
    v_exp_f32 v18, v18
    v_mfma_f32_16x16x32_bf16 v[28:31], a[116:119], a[52:55], v[28:31]
    v_mul_f32 v40, s34, v40
    v_mul_f32 v41, s34, v41
    v_mfma_f32_16x16x32_bf16 v[28:31], a[120:123], a[56:59], v[28:31]
    v_exp_f32 v19, v19
    v_mfma_f32_16x16x32_bf16 v[28:31], a[124:127], a[60:63], v[28:31]
    v_cvt_pk_bf16_f32 v33, v18, v19
    v_cvt_pk_bf16_f32 v40, v40, v41
    v_mfma_f32_16x16x32_bf16 v[96:99], a[128:131], v[36:39], v[96:99]
    v_exp_f32 v20, v20
    v_mfma_f32_16x16x32_bf16 v[100:103], a[132:135], v[36:39], v[100:103]
    v_accvgpr_write_b32 a222, v40
    v_accvgpr_read_b32 v41, a223
    v_mfma_f32_16x16x32_bf16 v[104:107], a[136:139], v[36:39], v[104:107]
    v_exp_f32 v21, v21
    v_mfma_f32_16x16x32_bf16 v[108:111], a[140:143], v[36:39], v[108:111]
    v_cvt_pk_bf16_f32 v34, v20, v21
    v_lshlrev_b32 v40, 16, v41
    v_mfma_f32_16x16x32_bf16 v[112:115], a[144:147], v[36:39], v[112:115]
    v_exp_f32 v22, v22
    v_mfma_f32_16x16x32_bf16 v[116:119], a[148:151], v[36:39], v[116:119]
    v_and_b32 v41, s35, v41
    v_mul_f32 v40, s34, v40
    v_mfma_f32_16x16x32_bf16 v[120:123], a[152:155], v[36:39], v[120:123]
    v_exp_f32 v23, v23
    v_mfma_f32_16x16x32_bf16 v[124:127], a[156:159], v[36:39], v[124:127]
    v_cvt_pk_bf16_f32 v35, v22, v23
    v_mul_f32 v41, s34, v41
    v_mfma_f32_16x16x32_bf16 a[228:231], a[248:251], v[36:39], a[228:231]
    v_cvt_pk_bf16_f32 v40, v40, v41
    v_accvgpr_write_b32 a223, v40
    v_mfma_f32_16x16x32_bf16 v[16:19], a[96:99], a[64:67], 0
    v_exp_f32 v24, v24
    v_mfma_f32_16x16x32_bf16 v[16:19], a[100:103], a[68:71], v[16:19]
    v_accvgpr_read_b32 v10, a224
    v_subrev_u32 v42, s38, v10
    v_cmp_lt_u32 vcc, s39, v42
    v_mfma_f32_16x16x32_bf16 v[16:19], a[104:107], a[72:75], v[16:19]
    v_exp_f32 v25, v25
    v_mfma_f32_16x16x32_bf16 v[16:19], a[108:111], a[76:79], v[16:19]
    v_cvt_pk_bf16_f32 v36, v24, v25
    v_rcp_f32 v10, v10
    v_mfma_f32_16x16x32_bf16 v[20:23], a[112:115], a[64:67], 0
    s_or_b64 s[40:41], s[40:41], vcc
    v_exp_f32 v26, v26
    v_mfma_f32_16x16x32_bf16 v[20:23], a[116:119], a[68:71], v[20:23]
    v_accvgpr_read_b32 v11, a228
    v_mul_f32 v64, v10, v64
    v_mul_f32 v65, v10, v65
    v_mfma_f32_16x16x32_bf16 v[20:23], a[120:123], a[72:75], v[20:23]
    v_exp_f32 v27, v27
    v_mfma_f32_16x16x32_bf16 v[20:23], a[124:127], a[76:79], v[20:23]
    v_cvt_pk_bf16_f32 v37, v26, v27
    v_mul_f32 v66, v10, v66
    v_mul_f32 v67, v10, v67
    v_mfma_f32_16x16x32_bf16 v[128:131], a[128:131], v[32:35], v[128:131]
    v_exp_f32 v28, v28
    v_mul_f32 v68, v10, v68
    v_mfma_f32_16x16x32_bf16 v[132:135], a[132:135], v[32:35], v[132:135]
    v_mul_f32 v69, v10, v69
    v_mul_f32 v70, v10, v70
    v_mfma_f32_16x16x32_bf16 v[136:139], a[136:139], v[32:35], v[136:139]
    v_exp_f32 v29, v29
    v_mul_f32 v71, v10, v71
    v_mfma_f32_16x16x32_bf16 v[140:143], a[140:143], v[32:35], v[140:143]
    v_cvt_pk_bf16_f32 v38, v28, v29
    v_cvt_pk_bf16_f32 v64, v64, v65
    v_mfma_f32_16x16x32_bf16 v[144:147], a[144:147], v[32:35], v[144:147]
    v_exp_f32 v30, v30
    v_cvt_pk_bf16_f32 v65, v66, v67
    v_mfma_f32_16x16x32_bf16 v[148:151], a[148:151], v[32:35], v[148:151]
    v_cvt_pk_bf16_f32 v66, v68, v69
    v_cvt_pk_bf16_f32 v67, v70, v71
    v_mfma_f32_16x16x32_bf16 v[152:155], a[152:155], v[32:35], v[152:155]
    v_exp_f32 v31, v31
    v_mfma_f32_16x16x32_bf16 v[156:159], a[156:159], v[32:35], v[156:159]
    buffer_store_dwordx4 v[64:67], v1, s[28:31], s44 offen offset:0 sc1
    v_cvt_pk_bf16_f32 v39, v30, v31
    v_mfma_f32_16x16x32_bf16 a[232:235], a[248:251], v[32:35], a[232:235]
    v_mul_f32 v72, v10, v72
    v_mul_f32 v73, v10, v73
    v_mfma_f32_16x16x32_bf16 v[24:27], a[96:99], a[80:83], 0
    v_exp_f32 v16, v16
    v_mul_f32 v74, v10, v74
    v_mfma_f32_16x16x32_bf16 v[24:27], a[100:103], a[84:87], v[24:27]
    ds_read_b128 a[96:99], v5 offset:32768
    ds_read_b128 a[100:103], v5 offset:33024
    v_mfma_f32_16x16x32_bf16 v[24:27], a[104:107], a[88:91], v[24:27]
    v_exp_f32 v17, v17
    v_mul_f32 v75, v10, v75
    v_mfma_f32_16x16x32_bf16 v[24:27], a[108:111], a[92:95], v[24:27]
    ds_read_b128 a[104:107], v5 offset:33280
    v_cvt_pk_bf16_f32 v32, v16, v17
    v_mul_f32 v76, v10, v76
    v_mfma_f32_16x16x32_bf16 v[28:31], a[112:115], a[80:83], 0
    v_exp_f32 v18, v18
    v_mfma_f32_16x16x32_bf16 v[28:31], a[116:119], a[84:87], v[28:31]
    ds_read_b128 a[108:111], v5 offset:33536
    ds_read_b128 a[112:115], v5 offset:40960
    v_mul_f32 v77, v10, v77
    v_mfma_f32_16x16x32_bf16 v[28:31], a[120:123], a[88:91], v[28:31]
    v_exp_f32 v19, v19
    v_mfma_f32_16x16x32_bf16 v[28:31], a[124:127], a[92:95], v[28:31]
    ds_read_b128 a[116:119], v5 offset:41216
    v_cvt_pk_bf16_f32 v33, v18, v19
    v_mul_f32 v78, v10, v78
    v_mfma_f32_16x16x32_bf16 v[160:163], a[128:131], v[36:39], v[160:163]
    v_exp_f32 v20, v20
    v_mul_f32 v79, v10, v79
    v_mfma_f32_16x16x32_bf16 v[164:167], a[132:135], v[36:39], v[164:167]
    ds_read_b128 a[120:123], v5 offset:41472
    ds_read_b128 a[124:127], v5 offset:41728
    v_mfma_f32_16x16x32_bf16 v[168:171], a[136:139], v[36:39], v[168:171]
    v_exp_f32 v21, v21
    v_cvt_pk_bf16_f32 v72, v72, v73
    v_mfma_f32_16x16x32_bf16 v[172:175], a[140:143], v[36:39], v[172:175]
    v_cvt_pk_bf16_f32 v34, v20, v21
    v_accvgpr_read_b32 v12, a232
    v_mfma_f32_16x16x32_bf16 v[176:179], a[144:147], v[36:39], v[176:179]
    v_exp_f32 v22, v22
    v_cvt_pk_bf16_f32 v73, v74, v75
    v_mfma_f32_16x16x32_bf16 v[180:183], a[148:151], v[36:39], v[180:183]
    v_cvt_pk_bf16_f32 v74, v76, v77
    v_cvt_pk_bf16_f32 v75, v78, v79
    v_mfma_f32_16x16x32_bf16 v[184:187], a[152:155], v[36:39], v[184:187]
    v_exp_f32 v23, v23
    v_mfma_f32_16x16x32_bf16 v[188:191], a[156:159], v[36:39], v[188:191]
    buffer_store_dwordx4 v[72:75], v1, s[28:31], s44 offen offset:64 sc1
    v_cvt_pk_bf16_f32 v35, v22, v23
    v_mfma_f32_16x16x32_bf16 a[236:239], a[248:251], v[36:39], a[236:239]
    s_waitcnt lgkmcnt(7)
    v_mul_f32 v80, v10, v80
    v_mul_f32 v81, v10, v81
    v_mfma_f32_16x16x32_bf16 v[16:19], a[96:99], a[160:163], 0
    s_waitcnt lgkmcnt(6)
    v_exp_f32 v24, v24
    v_mul_f32 v82, v10, v82
    v_mfma_f32_16x16x32_bf16 v[16:19], a[100:103], a[164:167], v[16:19]
    s_waitcnt lgkmcnt(5)
    v_mul_f32 v83, v10, v83
    v_mul_f32 v84, v10, v84
    v_mfma_f32_16x16x32_bf16 v[16:19], a[104:107], a[168:171], v[16:19]
    s_waitcnt lgkmcnt(4)
    v_exp_f32 v25, v25
    v_mul_f32 v85, v10, v85
    v_mfma_f32_16x16x32_bf16 v[16:19], a[108:111], a[172:175], v[16:19]
    s_waitcnt lgkmcnt(3)
    v_cvt_pk_bf16_f32 v36, v24, v25
    v_mul_f32 v86, v10, v86
    v_mul_f32 v87, v10, v87
    v_mfma_f32_16x16x32_bf16 v[20:23], a[112:115], a[160:163], 0
    s_waitcnt lgkmcnt(2)
    v_exp_f32 v26, v26
    v_mfma_f32_16x16x32_bf16 v[20:23], a[116:119], a[164:167], v[20:23]
    s_waitcnt lgkmcnt(1)
    v_accvgpr_read_b32 v13, a236
    v_cvt_pk_bf16_f32 v80, v80, v81
    v_cvt_pk_bf16_f32 v81, v82, v83
    v_mfma_f32_16x16x32_bf16 v[20:23], a[120:123], a[168:171], v[20:23]
    s_waitcnt lgkmcnt(0)
    v_exp_f32 v27, v27
    v_mfma_f32_16x16x32_bf16 v[20:23], a[124:127], a[172:175], v[20:23]
    v_cvt_pk_bf16_f32 v37, v26, v27
    v_cvt_pk_bf16_f32 v82, v84, v85
    v_cvt_pk_bf16_f32 v83, v86, v87
    v_mfma_f32_16x16x32_bf16 v[192:195], a[128:131], v[32:35], v[192:195]
    v_exp_f32 v28, v28
    v_mfma_f32_16x16x32_bf16 v[196:199], a[132:135], v[32:35], v[196:199]
    buffer_store_dwordx4 v[80:83], v1, s[28:31], s44 offen offset:128 sc1
    v_mul_f32 v88, v10, v88
    v_mfma_f32_16x16x32_bf16 v[200:203], a[136:139], v[32:35], v[200:203]
    v_exp_f32 v29, v29
    v_mul_f32 v89, v10, v89
    v_mfma_f32_16x16x32_bf16 v[204:207], a[140:143], v[32:35], v[204:207]
    v_cvt_pk_bf16_f32 v38, v28, v29
    v_mul_f32 v90, v10, v90
    v_mfma_f32_16x16x32_bf16 v[208:211], a[144:147], v[32:35], v[208:211]
    v_exp_f32 v30, v30
    v_mul_f32 v91, v10, v91
    v_mfma_f32_16x16x32_bf16 v[212:215], a[148:151], v[32:35], v[212:215]
    v_mul_f32 v92, v10, v92
    v_mul_f32 v93, v10, v93
    v_mfma_f32_16x16x32_bf16 v[216:219], a[152:155], v[32:35], v[216:219]
    v_exp_f32 v31, v31
    v_mul_f32 v94, v10, v94
    v_mfma_f32_16x16x32_bf16 v[220:223], a[156:159], v[32:35], v[220:223]
    v_cvt_pk_bf16_f32 v39, v30, v31
    v_mul_f32 v95, v10, v95
    v_cvt_pk_bf16_f32 v88, v88, v89
    v_mfma_f32_16x16x32_bf16 a[240:243], a[248:251], v[32:35], a[240:243]
    v_cvt_pk_bf16_f32 v89, v90, v91
    v_cvt_pk_bf16_f32 v90, v92, v93
    v_mfma_f32_16x16x32_bf16 v[24:27], a[96:99], a[176:179], 0
    v_exp_f32 v16, v16
    v_cvt_pk_bf16_f32 v91, v94, v95
    v_mfma_f32_16x16x32_bf16 v[24:27], a[100:103], a[180:183], v[24:27]
    buffer_store_dwordx4 v[88:91], v1, s[28:31], s44 offen offset:192 sc1
    v_mfma_f32_16x16x32_bf16 v[24:27], a[104:107], a[184:187], v[24:27]
    v_exp_f32 v17, v17
    v_subrev_u32 v42, s38, v11
    v_mfma_f32_16x16x32_bf16 v[24:27], a[108:111], a[188:191], v[24:27]
    v_cvt_pk_bf16_f32 v32, v16, v17
    v_cmp_lt_u32 vcc, s39, v42
    v_mfma_f32_16x16x32_bf16 v[28:31], a[112:115], a[176:179], 0
    v_exp_f32 v18, v18
    v_mfma_f32_16x16x32_bf16 v[28:31], a[116:119], a[180:183], v[28:31]
    v_accvgpr_read_b32 v14, a240
    v_rcp_f32 v11, v11
    v_mfma_f32_16x16x32_bf16 v[28:31], a[120:123], a[184:187], v[28:31]
    s_or_b64 s[40:41], s[40:41], vcc
    v_exp_f32 v19, v19
    v_mfma_f32_16x16x32_bf16 v[28:31], a[124:127], a[188:191], v[28:31]
    v_cvt_pk_bf16_f32 v33, v18, v19
    v_mul_f32 v96, v11, v96
    v_mul_f32 v97, v11, v97
    v_mfma_f32_16x16x32_bf16 v[224:227], a[128:131], v[36:39], v[224:227]
    v_exp_f32 v20, v20
    v_mfma_f32_16x16x32_bf16 v[228:231], a[132:135], v[36:39], v[228:231]
    ds_read_b64_tr_b16 a[128:129], v8 offset:32768
    ds_read_b64_tr_b16 a[130:131], v8 offset:40960
    v_mul_f32 v98, v11, v98
    v_mfma_f32_16x16x32_bf16 v[232:235], a[136:139], v[36:39], v[232:235]
    v_exp_f32 v21, v21
    v_mul_f32 v99, v11, v99
    v_mfma_f32_16x16x32_bf16 v[236:239], a[140:143], v[36:39], v[236:239]
    ds_read_b64_tr_b16 a[132:133], v8 offset:32776
    v_cvt_pk_bf16_f32 v34, v20, v21
    v_mfma_f32_16x16x32_bf16 v[240:243], a[144:147], v[36:39], v[240:243]
    v_exp_f32 v22, v22
    v_mul_f32 v100, v11, v100
    v_mfma_f32_16x16x32_bf16 v[244:247], a[148:151], v[36:39], v[244:247]
    ds_read_b64_tr_b16 a[134:135], v8 offset:40968
    ds_read_b64_tr_b16 a[136:137], v8 offset:33024
    v_mfma_f32_16x16x32_bf16 v[248:251], a[152:155], v[36:39], v[248:251]
    v_exp_f32 v23, v23
    v_mul_f32 v101, v11, v101
    v_mfma_f32_16x16x32_bf16 v[252:255], a[156:159], v[36:39], v[252:255]
    ds_read_b64_tr_b16 a[138:139], v8 offset:41216
    v_cvt_pk_bf16_f32 v35, v22, v23
    v_mfma_f32_16x16x32_bf16 a[244:247], a[248:251], v[36:39], a[244:247]
    ds_read_b64_tr_b16 a[140:141], v8 offset:33032
    ds_read_b64_tr_b16 a[142:143], v8 offset:41224
    v_mul_f32 v102, v11, v102
    v_mfma_f32_16x16x32_bf16 v[16:19], a[96:99], a[192:195], 0
    v_exp_f32 v24, v24
    v_mul_f32 v103, v11, v103
    v_mfma_f32_16x16x32_bf16 v[16:19], a[100:103], a[196:199], v[16:19]
    ds_read_b64_tr_b16 a[144:145], v8 offset:33280
    ds_read_b64_tr_b16 a[146:147], v8 offset:41472
    v_mfma_f32_16x16x32_bf16 v[16:19], a[104:107], a[200:203], v[16:19]
    v_exp_f32 v25, v25
    v_cvt_pk_bf16_f32 v96, v96, v97
    v_mfma_f32_16x16x32_bf16 v[16:19], a[108:111], a[204:207], v[16:19]
    ds_read_b64_tr_b16 a[148:149], v8 offset:33288
    v_cvt_pk_bf16_f32 v36, v24, v25
    v_mfma_f32_16x16x32_bf16 v[20:23], a[112:115], a[192:195], 0
    v_exp_f32 v26, v26
    v_cvt_pk_bf16_f32 v97, v98, v99
    v_mfma_f32_16x16x32_bf16 v[20:23], a[116:119], a[196:199], v[20:23]
    ds_read_b64_tr_b16 a[150:151], v8 offset:41480
    ds_read_b64_tr_b16 a[152:153], v8 offset:33536
    v_cvt_pk_bf16_f32 v98, v100, v101
    v_mfma_f32_16x16x32_bf16 v[20:23], a[120:123], a[200:203], v[20:23]
    v_exp_f32 v27, v27
    v_mfma_f32_16x16x32_bf16 v[20:23], a[124:127], a[204:207], v[20:23]
    s_waitcnt lgkmcnt(11)
    ds_read_b64_tr_b16 a[154:155], v8 offset:41728
    v_cvt_pk_bf16_f32 v37, v26, v27
    v_cvt_pk_bf16_f32 v99, v102, v103
    v_mfma_f32_16x16x32_bf16 a[0:3], a[128:131], v[32:35], 0
    s_waitcnt lgkmcnt(10)
    v_exp_f32 v28, v28
    v_mfma_f32_16x16x32_bf16 a[4:7], a[132:135], v[32:35], 0
    s_waitcnt lgkmcnt(8)
    ds_read_b64_tr_b16 a[156:157], v8 offset:33544
    ds_read_b64_tr_b16 a[158:159], v8 offset:41736
    v_mfma_f32_16x16x32_bf16 a[8:11], a[136:139], v[32:35], 0
    s_waitcnt lgkmcnt(8)
    v_exp_f32 v29, v29
    v_mfma_f32_16x16x32_bf16 a[12:15], a[140:143], v[32:35], 0
    s_waitcnt lgkmcnt(6)
    v_cvt_pk_bf16_f32 v38, v28, v29
    v_accvgpr_read_b32 v15, a244
    v_mfma_f32_16x16x32_bf16 a[16:19], a[144:147], v[32:35], 0
    s_waitcnt lgkmcnt(4)
    v_exp_f32 v30, v30
    v_mfma_f32_16x16x32_bf16 a[20:23], a[148:151], v[32:35], 0
    s_waitcnt lgkmcnt(2)
    buffer_store_dwordx4 v[96:99], v1, s[28:31], s45 offen offset:0 sc1
    v_mfma_f32_16x16x32_bf16 a[24:27], a[152:155], v[32:35], 0
    s_waitcnt lgkmcnt(0)
    v_exp_f32 v31, v31
    v_mul_f32 v104, v11, v104
    v_mfma_f32_16x16x32_bf16 a[28:31], a[156:159], v[32:35], 0
    v_cvt_pk_bf16_f32 v39, v30, v31
    v_mul_f32 v105, v11, v105
    v_mfma_f32_16x16x32_bf16 a[224:227], a[248:251], v[32:35], 0
    v_mul_f32 v106, v11, v106
    v_mul_f32 v107, v11, v107
    v_mul_f32 v108, v11, v108
    v_mfma_f32_16x16x32_bf16 v[24:27], a[96:99], a[208:211], 0
    v_exp_f32 v16, v16
    v_mul_f32 v109, v11, v109
    v_mfma_f32_16x16x32_bf16 v[24:27], a[100:103], a[212:215], v[24:27]
    ds_read_b128 a[96:99], v44 offset:32768
    ds_read_b128 a[100:103], v44 offset:33024
    v_mfma_f32_16x16x32_bf16 v[24:27], a[104:107], a[216:219], v[24:27]
    v_exp_f32 v17, v17
    v_mul_f32 v110, v11, v110
    v_mfma_f32_16x16x32_bf16 v[24:27], a[108:111], a[220:223], v[24:27]
    ds_read_b128 a[104:107], v44 offset:33280
    v_cvt_pk_bf16_f32 v32, v16, v17
    v_mfma_f32_16x16x32_bf16 v[28:31], a[112:115], a[208:211], 0
    v_exp_f32 v18, v18
    v_mul_f32 v111, v11, v111
    v_mfma_f32_16x16x32_bf16 v[28:31], a[116:119], a[212:215], v[28:31]
    ds_read_b128 a[108:111], v44 offset:33536
    ds_read_b128 a[112:115], v44 offset:40960
    v_mfma_f32_16x16x32_bf16 v[28:31], a[120:123], a[216:219], v[28:31]
    v_exp_f32 v19, v19
    v_cvt_pk_bf16_f32 v104, v104, v105
    v_mfma_f32_16x16x32_bf16 v[28:31], a[124:127], a[220:223], v[28:31]
    ds_read_b128 a[116:119], v44 offset:41216
    v_cvt_pk_bf16_f32 v33, v18, v19
    v_cvt_pk_bf16_f32 v105, v106, v107
    v_mfma_f32_16x16x32_bf16 a[32:35], a[128:131], v[36:39], 0
    v_exp_f32 v20, v20
    v_mfma_f32_16x16x32_bf16 a[36:39], a[132:135], v[36:39], 0
    ds_read_b128 a[120:123], v44 offset:41472
    ds_read_b128 a[124:127], v44 offset:41728
    v_cvt_pk_bf16_f32 v106, v108, v109
    v_mfma_f32_16x16x32_bf16 a[40:43], a[136:139], v[36:39], 0
    v_exp_f32 v21, v21
    v_mfma_f32_16x16x32_bf16 a[44:47], a[140:143], v[36:39], 0
    v_cvt_pk_bf16_f32 v34, v20, v21
    v_cvt_pk_bf16_f32 v107, v110, v111
    v_mfma_f32_16x16x32_bf16 a[48:51], a[144:147], v[36:39], 0
    v_exp_f32 v22, v22
    v_mfma_f32_16x16x32_bf16 a[52:55], a[148:151], v[36:39], 0
    buffer_store_dwordx4 v[104:107], v1, s[28:31], s45 offen offset:64 sc1
    v_mfma_f32_16x16x32_bf16 a[56:59], a[152:155], v[36:39], 0
    v_exp_f32 v23, v23
    v_mul_f32 v112, v11, v112
    v_mfma_f32_16x16x32_bf16 a[60:63], a[156:159], v[36:39], 0
    v_cvt_pk_bf16_f32 v35, v22, v23
    v_mul_f32 v113, v11, v113
    v_mfma_f32_16x16x32_bf16 a[228:231], a[248:251], v[36:39], 0
    s_waitcnt lgkmcnt(7)
    v_mul_f32 v114, v11, v114
    v_mul_f32 v115, v11, v115
    v_mul_f32 v116, v11, v116
    v_mfma_f32_16x16x32_bf16 v[16:19], a[96:99], a[160:163], 0
    s_waitcnt lgkmcnt(6)
    v_exp_f32 v24, v24
    v_mfma_f32_16x16x32_bf16 v[16:19], a[100:103], a[164:167], v[16:19]
    s_waitcnt lgkmcnt(5)
    v_mul_f32 v117, v11, v117
    v_mul_f32 v118, v11, v118
    v_mul_f32 v119, v11, v119
    v_mfma_f32_16x16x32_bf16 v[16:19], a[104:107], a[168:171], v[16:19]
    s_waitcnt lgkmcnt(4)
    v_exp_f32 v25, v25
    v_cvt_pk_bf16_f32 v112, v112, v113
    v_mfma_f32_16x16x32_bf16 v[16:19], a[108:111], a[172:175], v[16:19]
    s_waitcnt lgkmcnt(3)
    v_cvt_pk_bf16_f32 v36, v24, v25
    v_cvt_pk_bf16_f32 v113, v114, v115
    v_mfma_f32_16x16x32_bf16 v[20:23], a[112:115], a[160:163], 0
    s_waitcnt lgkmcnt(2)
    v_exp_f32 v26, v26
    v_cvt_pk_bf16_f32 v114, v116, v117
    v_mfma_f32_16x16x32_bf16 v[20:23], a[116:119], a[164:167], v[20:23]
    s_waitcnt lgkmcnt(1)
    v_cvt_pk_bf16_f32 v115, v118, v119
    v_mfma_f32_16x16x32_bf16 v[20:23], a[120:123], a[168:171], v[20:23]
    s_waitcnt lgkmcnt(0)
    v_exp_f32 v27, v27
    v_mfma_f32_16x16x32_bf16 v[20:23], a[124:127], a[172:175], v[20:23]
    buffer_store_dwordx4 v[112:115], v1, s[28:31], s45 offen offset:128 sc1
    v_cvt_pk_bf16_f32 v37, v26, v27
    v_mfma_f32_16x16x32_bf16 v[64:67], a[128:131], v[32:35], 0
    v_exp_f32 v28, v28
    v_mfma_f32_16x16x32_bf16 v[68:71], a[132:135], v[32:35], 0
    v_mul_f32 v120, v11, v120
    v_mul_f32 v121, v11, v121
    v_mul_f32 v122, v11, v122
    v_mfma_f32_16x16x32_bf16 v[72:75], a[136:139], v[32:35], 0
    v_exp_f32 v29, v29
    v_mfma_f32_16x16x32_bf16 v[76:79], a[140:143], v[32:35], 0
    v_cvt_pk_bf16_f32 v38, v28, v29
    v_mul_f32 v123, v11, v123
    v_mul_f32 v124, v11, v124
    v_mfma_f32_16x16x32_bf16 v[80:83], a[144:147], v[32:35], 0
    v_exp_f32 v30, v30
    v_mfma_f32_16x16x32_bf16 v[84:87], a[148:151], v[32:35], 0
    v_mul_f32 v125, v11, v125
    v_mul_f32 v126, v11, v126
    v_mul_f32 v127, v11, v127
    v_mfma_f32_16x16x32_bf16 v[88:91], a[152:155], v[32:35], 0
    v_exp_f32 v31, v31
    v_cvt_pk_bf16_f32 v120, v120, v121
    v_mfma_f32_16x16x32_bf16 v[92:95], a[156:159], v[32:35], 0
    v_cvt_pk_bf16_f32 v39, v30, v31
    v_cvt_pk_bf16_f32 v121, v122, v123
    v_mfma_f32_16x16x32_bf16 a[232:235], a[248:251], v[32:35], 0
    v_cvt_pk_bf16_f32 v122, v124, v125
    v_cvt_pk_bf16_f32 v123, v126, v127
    v_mfma_f32_16x16x32_bf16 v[24:27], a[96:99], a[176:179], 0
    v_exp_f32 v16, v16
    v_mfma_f32_16x16x32_bf16 v[24:27], a[100:103], a[180:183], v[24:27]
    buffer_store_dwordx4 v[120:123], v1, s[28:31], s45 offen offset:192 sc1
    v_subrev_u32 v42, s38, v12
    v_mfma_f32_16x16x32_bf16 v[24:27], a[104:107], a[184:187], v[24:27]
    v_exp_f32 v17, v17
    v_cmp_lt_u32 vcc, s39, v42
    v_mfma_f32_16x16x32_bf16 v[24:27], a[108:111], a[188:191], v[24:27]
    v_cvt_pk_bf16_f32 v32, v16, v17
    v_mfma_f32_16x16x32_bf16 v[28:31], a[112:115], a[176:179], 0
    v_exp_f32 v18, v18
    v_mfma_f32_16x16x32_bf16 v[28:31], a[116:119], a[180:183], v[28:31]
    v_rcp_f32 v12, v12
    v_mfma_f32_16x16x32_bf16 v[28:31], a[120:123], a[184:187], v[28:31]
    s_or_b64 s[40:41], s[40:41], vcc
    v_exp_f32 v19, v19
    v_mul_f32 v128, v12, v128
    v_mfma_f32_16x16x32_bf16 v[28:31], a[124:127], a[188:191], v[28:31]
    v_cvt_pk_bf16_f32 v33, v18, v19
    v_mul_f32 v129, v12, v129
    v_mfma_f32_16x16x32_bf16 v[96:99], a[128:131], v[36:39], 0
    v_exp_f32 v20, v20
    v_mul_f32 v130, v12, v130
    v_mfma_f32_16x16x32_bf16 v[100:103], a[132:135], v[36:39], 0
    ds_read_b64_tr_b16 a[128:129], v47 offset:32768
    ds_read_b64_tr_b16 a[130:131], v47 offset:40960
    v_mfma_f32_16x16x32_bf16 v[104:107], a[136:139], v[36:39], 0
    v_exp_f32 v21, v21
    v_mfma_f32_16x16x32_bf16 v[108:111], a[140:143], v[36:39], 0
    ds_read_b64_tr_b16 a[132:133], v47 offset:32776
    v_cvt_pk_bf16_f32 v34, v20, v21
    v_mfma_f32_16x16x32_bf16 v[112:115], a[144:147], v[36:39], 0
    v_exp_f32 v22, v22
    v_mfma_f32_16x16x32_bf16 v[116:119], a[148:151], v[36:39], 0
    ds_read_b64_tr_b16 a[134:135], v47 offset:40968
    ds_read_b64_tr_b16 a[136:137], v47 offset:33024
    v_mfma_f32_16x16x32_bf16 v[120:123], a[152:155], v[36:39], 0
    v_exp_f32 v23, v23
    v_mfma_f32_16x16x32_bf16 v[124:127], a[156:159], v[36:39], 0
    ds_read_b64_tr_b16 a[138:139], v47 offset:41216
    v_cvt_pk_bf16_f32 v35, v22, v23
    v_mfma_f32_16x16x32_bf16 a[236:239], a[248:251], v[36:39], 0
    ds_read_b64_tr_b16 a[140:141], v47 offset:33032
    ds_read_b64_tr_b16 a[142:143], v47 offset:41224
    v_mfma_f32_16x16x32_bf16 v[16:19], a[96:99], a[192:195], 0
    v_exp_f32 v24, v24
    v_mfma_f32_16x16x32_bf16 v[16:19], a[100:103], a[196:199], v[16:19]
    ds_read_b64_tr_b16 a[144:145], v47 offset:33280
    ds_read_b64_tr_b16 a[146:147], v47 offset:41472
    v_mfma_f32_16x16x32_bf16 v[16:19], a[104:107], a[200:203], v[16:19]
    v_exp_f32 v25, v25
    v_mfma_f32_16x16x32_bf16 v[16:19], a[108:111], a[204:207], v[16:19]
    ds_read_b64_tr_b16 a[148:149], v47 offset:33288
    v_cvt_pk_bf16_f32 v36, v24, v25
    v_mfma_f32_16x16x32_bf16 v[20:23], a[112:115], a[192:195], 0
    v_exp_f32 v26, v26
    v_mfma_f32_16x16x32_bf16 v[20:23], a[116:119], a[196:199], v[20:23]
    ds_read_b64_tr_b16 a[150:151], v47 offset:41480
    ds_read_b64_tr_b16 a[152:153], v47 offset:33536
    v_mfma_f32_16x16x32_bf16 v[20:23], a[120:123], a[200:203], v[20:23]
    v_exp_f32 v27, v27
    v_mfma_f32_16x16x32_bf16 v[20:23], a[124:127], a[204:207], v[20:23]
    s_waitcnt lgkmcnt(11)
    ds_read_b64_tr_b16 a[154:155], v47 offset:41728
    v_cvt_pk_bf16_f32 v37, v26, v27
    v_mfma_f32_16x16x32_bf16 a[0:3], a[128:131], v[32:35], a[0:3]
    s_waitcnt lgkmcnt(10)
    v_exp_f32 v28, v28
    v_mfma_f32_16x16x32_bf16 a[4:7], a[132:135], v[32:35], a[4:7]
    s_waitcnt lgkmcnt(8)
    ds_read_b64_tr_b16 a[156:157], v47 offset:33544
    ds_read_b64_tr_b16 a[158:159], v47 offset:41736
    v_mfma_f32_16x16x32_bf16 a[8:11], a[136:139], v[32:35], a[8:11]
    s_waitcnt lgkmcnt(8)
    v_exp_f32 v29, v29
    v_mfma_f32_16x16x32_bf16 a[12:15], a[140:143], v[32:35], a[12:15]
    s_waitcnt lgkmcnt(6)
    ds_read_b128 a[96:99], v6 offset:0
    v_cvt_pk_bf16_f32 v38, v28, v29
    v_mfma_f32_16x16x32_bf16 a[16:19], a[144:147], v[32:35], a[16:19]
    s_waitcnt lgkmcnt(5)
    v_exp_f32 v30, v30
    v_mfma_f32_16x16x32_bf16 a[20:23], a[148:151], v[32:35], a[20:23]
    s_waitcnt lgkmcnt(3)
    ds_read_b128 a[100:103], v6 offset:256
    ds_read_b128 a[104:107], v6 offset:512
    v_mfma_f32_16x16x32_bf16 a[24:27], a[152:155], v[32:35], a[24:27]
    s_waitcnt lgkmcnt(3)
    v_exp_f32 v31, v31
    v_mfma_f32_16x16x32_bf16 a[28:31], a[156:159], v[32:35], a[28:31]
    ds_read_b128 a[108:111], v6 offset:768
    v_cvt_pk_bf16_f32 v39, v30, v31
    v_mfma_f32_16x16x32_bf16 a[224:227], a[248:251], v[32:35], a[224:227]
    s_waitcnt lgkmcnt(3)
    ds_read_b128 a[112:115], v6 offset:8192
    ds_read_b128 a[116:119], v6 offset:8448
    v_mfma_f32_16x16x32_bf16 v[24:27], a[96:99], a[160:163], 0
    s_waitcnt lgkmcnt(4)
    v_exp_f32 v16, v16
    v_mfma_f32_16x16x32_bf16 v[24:27], a[100:103], a[164:167], v[24:27]
    s_waitcnt lgkmcnt(3)
    ds_read_b128 a[120:123], v6 offset:8704
    ds_read_b128 a[124:127], v6 offset:8960
    v_mfma_f32_16x16x32_bf16 v[24:27], a[104:107], a[168:171], v[24:27]
    s_waitcnt lgkmcnt(4)
    v_exp_f32 v17, v17
    v_mfma_f32_16x16x32_bf16 v[24:27], a[108:111], a[172:175], v[24:27]
    s_waitcnt lgkmcnt(3)
    v_cvt_pk_bf16_f32 v32, v16, v17
    v_mul_f32 v131, v12, v131
L_m7:
    s_cbranch_execz L_m8
    v_mfma_f32_16x16x32_bf16 v[28:31], a[112:115], a[160:163], 0
    s_waitcnt lgkmcnt(2)
    v_exp_f32 v18, v18
    v_mul_f32 v132, v12, v132
    v_mfma_f32_16x16x32_bf16 v[28:31], a[116:119], a[164:167], v[28:31]
    s_waitcnt lgkmcnt(1)
    v_mul_f32 v133, v12, v133
    v_mul_f32 v134, v12, v134
    v_mfma_f32_16x16x32_bf16 v[28:31], a[120:123], a[168:171], v[28:31]
    s_waitcnt lgkmcnt(0)
    v_exp_f32 v19, v19
    v_mfma_f32_16x16x32_bf16 v[28:31], a[124:127], a[172:175], v[28:31]
    v_cvt_pk_bf16_f32 v33, v18, v19
    v_mul_f32 v135, v12, v135
    v_mfma_f32_16x16x32_bf16 a[32:35], a[128:131], v[36:39], a[32:35]
    v_exp_f32 v20, v20
    v_mfma_f32_16x16x32_bf16 a[36:39], a[132:135], v[36:39], a[36:39]
    v_cvt_pk_bf16_f32 v128, v128, v129
    v_cvt_pk_bf16_f32 v129, v130, v131
    v_mfma_f32_16x16x32_bf16 a[40:43], a[136:139], v[36:39], a[40:43]
    v_exp_f32 v21, v21
    v_mfma_f32_16x16x32_bf16 a[44:47], a[140:143], v[36:39], a[44:47]
    v_cvt_pk_bf16_f32 v34, v20, v21
    v_cvt_pk_bf16_f32 v130, v132, v133
    v_mfma_f32_16x16x32_bf16 a[48:51], a[144:147], v[36:39], a[48:51]
    v_exp_f32 v22, v22
    v_mfma_f32_16x16x32_bf16 a[52:55], a[148:151], v[36:39], a[52:55]
    v_cvt_pk_bf16_f32 v131, v134, v135
    v_mfma_f32_16x16x32_bf16 a[56:59], a[152:155], v[36:39], a[56:59]
    v_exp_f32 v23, v23
    v_mfma_f32_16x16x32_bf16 a[60:63], a[156:159], v[36:39], a[60:63]
    v_cvt_pk_bf16_f32 v35, v22, v23
    v_mfma_f32_16x16x32_bf16 a[228:231], a[248:251], v[36:39], a[228:231]
    buffer_store_dwordx4 v[128:131], v1, s[28:31], s46 offen offset:0 sc1
    v_mfma_f32_16x16x32_bf16 v[16:19], a[96:99], a[176:179], 0
    v_exp_f32 v24, v24
    v_mfma_f32_16x16x32_bf16 v[16:19], a[100:103], a[180:183], v[16:19]
    v_mul_f32 v136, v12, v136
    v_mul_f32 v137, v12, v137
    v_mfma_f32_16x16x32_bf16 v[16:19], a[104:107], a[184:187], v[16:19]
    v_exp_f32 v25, v25
    v_mfma_f32_16x16x32_bf16 v[16:19], a[108:111], a[188:191], v[16:19]
    v_cvt_pk_bf16_f32 v36, v24, v25
    v_mul_f32 v138, v12, v138
    v_mfma_f32_16x16x32_bf16 v[20:23], a[112:115], a[176:179], 0
    v_exp_f32 v26, v26
    v_mfma_f32_16x16x32_bf16 v[20:23], a[116:119], a[180:183], v[20:23]
    v_mul_f32 v139, v12, v139
    v_mul_f32 v140, v12, v140
    v_mfma_f32_16x16x32_bf16 v[20:23], a[120:123], a[184:187], v[20:23]
    v_exp_f32 v27, v27
    v_mfma_f32_16x16x32_bf16 v[20:23], a[124:127], a[188:191], v[20:23]
    v_cvt_pk_bf16_f32 v37, v26, v27
    v_mul_f32 v141, v12, v141
    v_mfma_f32_16x16x32_bf16 v[64:67], a[128:131], v[32:35], v[64:67]
    v_exp_f32 v28, v28
    v_mfma_f32_16x16x32_bf16 v[68:71], a[132:135], v[32:35], v[68:71]
    ds_read_b64_tr_b16 a[128:129], v9 offset:0
    ds_read_b64_tr_b16 a[130:131], v9 offset:8192
    v_mfma_f32_16x16x32_bf16 v[72:75], a[136:139], v[32:35], v[72:75]
    v_exp_f32 v29, v29
    v_mfma_f32_16x16x32_bf16 v[76:79], a[140:143], v[32:35], v[76:79]
    ds_read_b64_tr_b16 a[132:133], v9 offset:8
    v_cvt_pk_bf16_f32 v38, v28, v29
    v_mfma_f32_16x16x32_bf16 v[80:83], a[144:147], v[32:35], v[80:83]
    v_exp_f32 v30, v30
    v_mfma_f32_16x16x32_bf16 v[84:87], a[148:151], v[32:35], v[84:87]
    ds_read_b64_tr_b16 a[134:135], v9 offset:8200
    ds_read_b64_tr_b16 a[136:137], v9 offset:256
    v_mfma_f32_16x16x32_bf16 v[88:91], a[152:155], v[32:35], v[88:91]
    v_exp_f32 v31, v31
    v_mfma_f32_16x16x32_bf16 v[92:95], a[156:159], v[32:35], v[92:95]
    ds_read_b64_tr_b16 a[138:139], v9 offset:8448
    v_cvt_pk_bf16_f32 v39, v30, v31
    v_mfma_f32_16x16x32_bf16 a[232:235], a[248:251], v[32:35], a[232:235]
    ds_read_b64_tr_b16 a[140:141], v9 offset:264
    ds_read_b64_tr_b16 a[142:143], v9 offset:8456
    v_mfma_f32_16x16x32_bf16 v[24:27], a[96:99], a[192:195], 0
    v_exp_f32 v16, v16
    v_mfma_f32_16x16x32_bf16 v[24:27], a[100:103], a[196:199], v[24:27]
    ds_read_b64_tr_b16 a[144:145], v9 offset:512
    ds_read_b64_tr_b16 a[146:147], v9 offset:8704
    v_mul_f32 v142, v12, v142
    v_mfma_f32_16x16x32_bf16 v[24:27], a[104:107], a[200:203], v[24:27]
    v_exp_f32 v17, v17
    v_mfma_f32_16x16x32_bf16 v[24:27], a[108:111], a[204:207], v[24:27]
    ds_read_b64_tr_b16 a[148:149], v9 offset:520
    v_cvt_pk_bf16_f32 v32, v16, v17
    v_mfma_f32_16x16x32_bf16 v[28:31], a[112:115], a[192:195], 0
    v_exp_f32 v18, v18
    v_mfma_f32_16x16x32_bf16 v[28:31], a[116:119], a[196:199], v[28:31]
    ds_read_b64_tr_b16 a[150:151], v9 offset:8712
    ds_read_b64_tr_b16 a[152:153], v9 offset:768
    v_mfma_f32_16x16x32_bf16 v[28:31], a[120:123], a[200:203], v[28:31]
    v_exp_f32 v19, v19
    v_mfma_f32_16x16x32_bf16 v[28:31], a[124:127], a[204:207], v[28:31]
    s_waitcnt lgkmcnt(11)
    ds_read_b64_tr_b16 a[154:155], v9 offset:8960
    v_cvt_pk_bf16_f32 v33, v18, v19
    v_mfma_f32_16x16x32_bf16 a[0:3], a[128:131], v[36:39], a[0:3]
    s_waitcnt lgkmcnt(10)
    v_exp_f32 v20, v20
    v_mfma_f32_16x16x32_bf16 a[4:7], a[132:135], v[36:39], a[4:7]
    s_waitcnt lgkmcnt(8)
    ds_read_b64_tr_b16 a[156:157], v9 offset:776
    ds_read_b64_tr_b16 a[158:159], v9 offset:8968
    v_mfma_f32_16x16x32_bf16 a[8:11], a[136:139], v[36:39], a[8:11]
    s_waitcnt lgkmcnt(8)
    v_exp_f32 v21, v21
    v_mfma_f32_16x16x32_bf16 a[12:15], a[140:143], v[36:39], a[12:15]
    s_waitcnt lgkmcnt(6)
    v_cvt_pk_bf16_f32 v34, v20, v21
    v_mul_f32 v143, v12, v143
    v_mfma_f32_16x16x32_bf16 a[16:19], a[144:147], v[36:39], a[16:19]
    s_waitcnt lgkmcnt(4)
    v_exp_f32 v22, v22
    v_mfma_f32_16x16x32_bf16 a[20:23], a[148:151], v[36:39], a[20:23]
    s_waitcnt lgkmcnt(2)
    v_cvt_pk_bf16_f32 v136, v136, v137
    v_cvt_pk_bf16_f32 v137, v138, v139
    v_mfma_f32_16x16x32_bf16 a[24:27], a[152:155], v[36:39], a[24:27]
    s_waitcnt lgkmcnt(0)
    v_exp_f32 v23, v23
    v_mfma_f32_16x16x32_bf16 a[28:31], a[156:159], v[36:39], a[28:31]
    v_cvt_pk_bf16_f32 v35, v22, v23
    v_cvt_pk_bf16_f32 v138, v140, v141
    v_mfma_f32_16x16x32_bf16 a[224:227], a[248:251], v[36:39], a[224:227]
    v_cvt_pk_bf16_f32 v139, v142, v143
    v_mfma_f32_16x16x32_bf16 v[16:19], a[96:99], a[208:211], 0
    v_exp_f32 v24, v24
    v_mfma_f32_16x16x32_bf16 v[16:19], a[100:103], a[212:215], v[16:19]
    ds_read_b128 a[96:99], v45 offset:0
    ds_read_b128 a[100:103], v45 offset:256
    v_mfma_f32_16x16x32_bf16 v[16:19], a[104:107], a[216:219], v[16:19]
    v_exp_f32 v25, v25
    v_mfma_f32_16x16x32_bf16 v[16:19], a[108:111], a[220:223], v[16:19]
    ds_read_b128 a[104:107], v45 offset:512
    v_cvt_pk_bf16_f32 v36, v24, v25
    v_mfma_f32_16x16x32_bf16 v[20:23], a[112:115], a[208:211], 0
    v_exp_f32 v26, v26
    v_mfma_f32_16x16x32_bf16 v[20:23], a[116:119], a[212:215], v[20:23]
    ds_read_b128 a[108:111], v45 offset:768
    ds_read_b128 a[112:115], v45 offset:8192
    v_mfma_f32_16x16x32_bf16 v[20:23], a[120:123], a[216:219], v[20:23]
    v_exp_f32 v27, v27
    v_mfma_f32_16x16x32_bf16 v[20:23], a[124:127], a[220:223], v[20:23]
    ds_read_b128 a[116:119], v45 offset:8448
    v_cvt_pk_bf16_f32 v37, v26, v27
    v_mfma_f32_16x16x32_bf16 a[32:35], a[128:131], v[32:35], a[32:35]
    v_exp_f32 v28, v28
    v_mfma_f32_16x16x32_bf16 a[36:39], a[132:135], v[32:35], a[36:39]
    ds_read_b128 a[120:123], v45 offset:8704
    ds_read_b128 a[124:127], v45 offset:8960
    v_mfma_f32_16x16x32_bf16 a[40:43], a[136:139], v[32:35], a[40:43]
    v_exp_f32 v29, v29
    v_mfma_f32_16x16x32_bf16 a[44:47], a[140:143], v[32:35], a[44:47]
    v_cvt_pk_bf16_f32 v38, v28, v29
    v_mfma_f32_16x16x32_bf16 a[48:51], a[144:147], v[32:35], a[48:51]
    v_exp_f32 v30, v30
    v_mfma_f32_16x16x32_bf16 a[52:55], a[148:151], v[32:35], a[52:55]
    buffer_store_dwordx4 v[136:139], v1, s[28:31], s46 offen offset:64 sc1
    v_mfma_f32_16x16x32_bf16 a[56:59], a[152:155], v[32:35], a[56:59]
    v_exp_f32 v31, v31
    v_mfma_f32_16x16x32_bf16 a[60:63], a[156:159], v[32:35], a[60:63]
    v_cvt_pk_bf16_f32 v39, v30, v31
    v_mul_f32 v144, v12, v144
    v_mul_f32 v145, v12, v145
    v_mfma_f32_16x16x32_bf16 a[228:231], a[248:251], v[32:35], a[228:231]
    s_waitcnt lgkmcnt(7)
    v_mul_f32 v146, v12, v146
    v_mul_f32 v147, v12, v147
    v_mfma_f32_16x16x32_bf16 v[24:27], a[96:99], a[160:163], 0
    s_waitcnt lgkmcnt(6)
    v_exp_f32 v16, v16
    v_mfma_f32_16x16x32_bf16 v[24:27], a[100:103], a[164:167], v[24:27]
    s_waitcnt lgkmcnt(5)
    v_mul_f32 v148, v12, v148
    v_mul_f32 v149, v12, v149
    v_mfma_f32_16x16x32_bf16 v[24:27], a[104:107], a[168:171], v[24:27]
    s_waitcnt lgkmcnt(4)
    v_exp_f32 v17, v17
    v_mfma_f32_16x16x32_bf16 v[24:27], a[108:111], a[172:175], v[24:27]
    s_waitcnt lgkmcnt(3)
    v_cvt_pk_bf16_f32 v32, v16, v17
    v_mul_f32 v150, v12, v150
    v_mfma_f32_16x16x32_bf16 v[28:31], a[112:115], a[160:163], 0
    s_waitcnt lgkmcnt(2)
    v_exp_f32 v18, v18
    v_mfma_f32_16x16x32_bf16 v[28:31], a[116:119], a[164:167], v[28:31]
    s_waitcnt lgkmcnt(1)
    v_mul_f32 v151, v12, v151
    v_cvt_pk_bf16_f32 v144, v144, v145
    v_mfma_f32_16x16x32_bf16 v[28:31], a[120:123], a[168:171], v[28:31]
    s_waitcnt lgkmcnt(0)
    v_exp_f32 v19, v19
    v_mfma_f32_16x16x32_bf16 v[28:31], a[124:127], a[172:175], v[28:31]
    v_cvt_pk_bf16_f32 v33, v18, v19
    v_cvt_pk_bf16_f32 v145, v146, v147
    v_mfma_f32_16x16x32_bf16 v[64:67], a[128:131], v[36:39], v[64:67]
    v_exp_f32 v20, v20
    v_mfma_f32_16x16x32_bf16 v[68:71], a[132:135], v[36:39], v[68:71]
    v_cvt_pk_bf16_f32 v146, v148, v149
    v_cvt_pk_bf16_f32 v147, v150, v151
    v_mfma_f32_16x16x32_bf16 v[72:75], a[136:139], v[36:39], v[72:75]
    v_exp_f32 v21, v21
    v_mfma_f32_16x16x32_bf16 v[76:79], a[140:143], v[36:39], v[76:79]
    v_cvt_pk_bf16_f32 v34, v20, v21
    v_mfma_f32_16x16x32_bf16 v[80:83], a[144:147], v[36:39], v[80:83]
    v_exp_f32 v22, v22
    v_mfma_f32_16x16x32_bf16 v[84:87], a[148:151], v[36:39], v[84:87]
    buffer_store_dwordx4 v[144:147], v1, s[28:31], s46 offen offset:128 sc1
    v_mfma_f32_16x16x32_bf16 v[88:91], a[152:155], v[36:39], v[88:91]
    v_exp_f32 v23, v23
    v_mfma_f32_16x16x32_bf16 v[92:95], a[156:159], v[36:39], v[92:95]
    v_cvt_pk_bf16_f32 v35, v22, v23
    v_mul_f32 v152, v12, v152
    v_mfma_f32_16x16x32_bf16 a[232:235], a[248:251], v[36:39], a[232:235]
    v_mul_f32 v153, v12, v153
    v_mul_f32 v154, v12, v154
    v_mfma_f32_16x16x32_bf16 v[16:19], a[96:99], a[176:179], 0
    v_exp_f32 v24, v24
    v_mfma_f32_16x16x32_bf16 v[16:19], a[100:103], a[180:183], v[16:19]
    v_mul_f32 v155, v12, v155
    v_mul_f32 v156, v12, v156
    v_mfma_f32_16x16x32_bf16 v[16:19], a[104:107], a[184:187], v[16:19]
    v_exp_f32 v25, v25
    v_mfma_f32_16x16x32_bf16 v[16:19], a[108:111], a[188:191], v[16:19]
    v_cvt_pk_bf16_f32 v36, v24, v25
    v_mul_f32 v157, v12, v157
    v_mfma_f32_16x16x32_bf16 v[20:23], a[112:115], a[176:179], 0
    v_exp_f32 v26, v26
    v_mfma_f32_16x16x32_bf16 v[20:23], a[116:119], a[180:183], v[20:23]
    v_mul_f32 v158, v12, v158
    v_mul_f32 v159, v12, v159
    v_mfma_f32_16x16x32_bf16 v[20:23], a[120:123], a[184:187], v[20:23]
    v_exp_f32 v27, v27
    v_mfma_f32_16x16x32_bf16 v[20:23], a[124:127], a[188:191], v[20:23]
    v_cvt_pk_bf16_f32 v37, v26, v27
    v_cvt_pk_bf16_f32 v152, v152, v153
    v_mfma_f32_16x16x32_bf16 v[96:99], a[128:131], v[32:35], v[96:99]
    v_exp_f32 v28, v28
    v_mfma_f32_16x16x32_bf16 v[100:103], a[132:135], v[32:35], v[100:103]
    ds_read_b64_tr_b16 a[128:129], v56 offset:0
    ds_read_b64_tr_b16 a[130:131], v56 offset:8192
    v_mfma_f32_16x16x32_bf16 v[104:107], a[136:139], v[32:35], v[104:107]
    v_exp_f32 v29, v29
    v_mfma_f32_16x16x32_bf16 v[108:111], a[140:143], v[32:35], v[108:111]
    ds_read_b64_tr_b16 a[132:133], v56 offset:8
    v_cvt_pk_bf16_f32 v38, v28, v29
    v_cvt_pk_bf16_f32 v153, v154, v155
    v_mfma_f32_16x16x32_bf16 v[112:115], a[144:147], v[32:35], v[112:115]
    v_exp_f32 v30, v30
    v_mfma_f32_16x16x32_bf16 v[116:119], a[148:151], v[32:35], v[116:119]
    ds_read_b64_tr_b16 a[134:135], v56 offset:8200
    ds_read_b64_tr_b16 a[136:137], v56 offset:256
    v_mfma_f32_16x16x32_bf16 v[120:123], a[152:155], v[32:35], v[120:123]
    v_exp_f32 v31, v31
    v_mfma_f32_16x16x32_bf16 v[124:127], a[156:159], v[32:35], v[124:127]
    ds_read_b64_tr_b16 a[138:139], v56 offset:8448
    v_cvt_pk_bf16_f32 v39, v30, v31
    v_mfma_f32_16x16x32_bf16 a[236:239], a[248:251], v[32:35], a[236:239]
    ds_read_b64_tr_b16 a[140:141], v56 offset:264
    ds_read_b64_tr_b16 a[142:143], v56 offset:8456
    v_mfma_f32_16x16x32_bf16 v[24:27], a[96:99], a[192:195], 0
    v_exp_f32 v16, v16
    v_mfma_f32_16x16x32_bf16 v[24:27], a[100:103], a[196:199], v[24:27]
    ds_read_b64_tr_b16 a[144:145], v56 offset:512
    ds_read_b64_tr_b16 a[146:147], v56 offset:8704
    v_mfma_f32_16x16x32_bf16 v[24:27], a[104:107], a[200:203], v[24:27]
    v_exp_f32 v17, v17
    v_mfma_f32_16x16x32_bf16 v[24:27], a[108:111], a[204:207], v[24:27]
    ds_read_b64_tr_b16 a[148:149], v56 offset:520
    v_cvt_pk_bf16_f32 v32, v16, v17
    v_mfma_f32_16x16x32_bf16 v[28:31], a[112:115], a[192:195], 0
    v_exp_f32 v18, v18
    v_mfma_f32_16x16x32_bf16 v[28:31], a[116:119], a[196:199], v[28:31]
    ds_read_b64_tr_b16 a[150:151], v56 offset:8712
    ds_read_b64_tr_b16 a[152:153], v56 offset:768
    v_mfma_f32_16x16x32_bf16 v[28:31], a[120:123], a[200:203], v[28:31]
    v_exp_f32 v19, v19
    v_mfma_f32_16x16x32_bf16 v[28:31], a[124:127], a[204:207], v[28:31]
    s_waitcnt lgkmcnt(11)
    ds_read_b64_tr_b16 a[154:155], v56 offset:8960
    v_cvt_pk_bf16_f32 v33, v18, v19
    v_mfma_f32_16x16x32_bf16 a[0:3], a[128:131], v[36:39], a[0:3]
    s_waitcnt lgkmcnt(10)
    v_exp_f32 v20, v20
    v_mfma_f32_16x16x32_bf16 a[4:7], a[132:135], v[36:39], a[4:7]
    s_waitcnt lgkmcnt(8)
    ds_read_b64_tr_b16 a[156:157], v56 offset:776
    ds_read_b64_tr_b16 a[158:159], v56 offset:8968
    v_mfma_f32_16x16x32_bf16 a[8:11], a[136:139], v[36:39], a[8:11]
    s_waitcnt lgkmcnt(8)
    v_exp_f32 v21, v21
    v_mfma_f32_16x16x32_bf16 a[12:15], a[140:143], v[36:39], a[12:15]
    s_waitcnt lgkmcnt(6)
    ds_read_b128 a[96:99], v4 offset:0
    v_cvt_pk_bf16_f32 v34, v20, v21
    v_mfma_f32_16x16x32_bf16 a[16:19], a[144:147], v[36:39], a[16:19]
    s_waitcnt lgkmcnt(5)
    v_exp_f32 v22, v22
    v_mfma_f32_16x16x32_bf16 a[20:23], a[148:151], v[36:39], a[20:23]
    s_waitcnt lgkmcnt(3)
    ds_read_b128 a[100:103], v4 offset:256
    ds_read_b128 a[104:107], v4 offset:512
    v_mfma_f32_16x16x32_bf16 a[24:27], a[152:155], v[36:39], a[24:27]
    s_waitcnt lgkmcnt(3)
    v_exp_f32 v23, v23
    v_mfma_f32_16x16x32_bf16 a[28:31], a[156:159], v[36:39], a[28:31]
    ds_read_b128 a[108:111], v4 offset:768
    v_cvt_pk_bf16_f32 v35, v22, v23
    v_mfma_f32_16x16x32_bf16 a[224:227], a[248:251], v[36:39], a[224:227]
    s_waitcnt lgkmcnt(3)
    ds_read_b128 a[112:115], v4 offset:8192
    ds_read_b128 a[116:119], v4 offset:8448
    v_mfma_f32_16x16x32_bf16 v[16:19], a[96:99], a[160:163], 0
    s_waitcnt lgkmcnt(4)
    v_exp_f32 v24, v24
    v_mfma_f32_16x16x32_bf16 v[16:19], a[100:103], a[164:167], v[16:19]
    s_waitcnt lgkmcnt(3)
    ds_read_b128 a[120:123], v4 offset:8704
    ds_read_b128 a[124:127], v4 offset:8960
    v_mfma_f32_16x16x32_bf16 v[16:19], a[104:107], a[168:171], v[16:19]
    s_waitcnt lgkmcnt(4)
    v_exp_f32 v25, v25
    v_mfma_f32_16x16x32_bf16 v[16:19], a[108:111], a[172:175], v[16:19]
    s_waitcnt lgkmcnt(3)
    v_cvt_pk_bf16_f32 v36, v24, v25
    v_cvt_pk_bf16_f32 v154, v156, v157
    v_mfma_f32_16x16x32_bf16 v[20:23], a[112:115], a[160:163], 0
    s_waitcnt lgkmcnt(2)
    v_exp_f32 v26, v26
    v_mfma_f32_16x16x32_bf16 v[20:23], a[116:119], a[164:167], v[20:23]
    s_waitcnt lgkmcnt(1)
    v_cvt_pk_bf16_f32 v155, v158, v159
    v_mfma_f32_16x16x32_bf16 v[20:23], a[120:123], a[168:171], v[20:23]
    s_waitcnt lgkmcnt(0)
    v_exp_f32 v27, v27
    v_mfma_f32_16x16x32_bf16 v[20:23], a[124:127], a[172:175], v[20:23]
    v_cvt_pk_bf16_f32 v37, v26, v27
    v_mfma_f32_16x16x32_bf16 a[32:35], a[128:131], v[32:35], a[32:35]
    v_exp_f32 v28, v28
    v_mfma_f32_16x16x32_bf16 a[36:39], a[132:135], v[32:35], a[36:39]
    buffer_store_dwordx4 v[152:155], v1, s[28:31], s46 offen offset:192 sc1
    v_mfma_f32_16x16x32_bf16 a[40:43], a[136:139], v[32:35], a[40:43]
    v_exp_f32 v29, v29
    v_mfma_f32_16x16x32_bf16 a[44:47], a[140:143], v[32:35], a[44:47]
    v_cvt_pk_bf16_f32 v38, v28, v29
    v_subrev_u32 v42, s38, v13
    v_mfma_f32_16x16x32_bf16 a[48:51], a[144:147], v[32:35], a[48:51]
    v_exp_f32 v30, v30
    v_mfma_f32_16x16x32_bf16 a[52:55], a[148:151], v[32:35], a[52:55]
    v_cmp_lt_u32 vcc, s39, v42
    v_mfma_f32_16x16x32_bf16 a[56:59], a[152:155], v[32:35], a[56:59]
    v_exp_f32 v31, v31
    v_mfma_f32_16x16x32_bf16 a[60:63], a[156:159], v[32:35], a[60:63]
    v_cvt_pk_bf16_f32 v39, v30, v31
    v_mfma_f32_16x16x32_bf16 a[228:231], a[248:251], v[32:35], a[228:231]
    s_barrier
    v_mfma_f32_16x16x32_bf16 v[24:27], a[96:99], a[176:179], 0
    s_add_u32 m0, s32, 98304
    v_exp_f32 v16, v16
    v_mfma_f32_16x16x32_bf16 v[24:27], a[100:103], a[180:183], v[24:27]
    buffer_load_dwordx4 v2, s[20:23], s56 offen offset:0  lds
    v_mfma_f32_16x16x32_bf16 v[24:27], a[104:107], a[184:187], v[24:27]
    v_exp_f32 v17, v17
    v_mfma_f32_16x16x32_bf16 v[24:27], a[108:111], a[188:191], v[24:27]
    v_cvt_pk_bf16_f32 v32, v16, v17
    v_mfma_f32_16x16x32_bf16 v[28:31], a[112:115], a[176:179], 0
    v_exp_f32 v18, v18
    v_mfma_f32_16x16x32_bf16 v[28:31], a[116:119], a[180:183], v[28:31]
    v_rcp_f32 v13, v13
    v_mfma_f32_16x16x32_bf16 v[28:31], a[120:123], a[184:187], v[28:31]
    s_or_b64 s[40:41], s[40:41], vcc
    v_exp_f32 v19, v19
    v_mfma_f32_16x16x32_bf16 v[28:31], a[124:127], a[188:191], v[28:31]
    v_cvt_pk_bf16_f32 v33, v18, v19
    v_mul_f32 v160, v13, v160
    v_mfma_f32_16x16x32_bf16 v[64:67], a[128:131], v[36:39], v[64:67]
    v_exp_f32 v20, v20
    v_mfma_f32_16x16x32_bf16 v[68:71], a[132:135], v[36:39], v[68:71]
    ds_read_b64_tr_b16 a[128:129], v7 offset:0
    ds_read_b64_tr_b16 a[130:131], v7 offset:8192
    v_mfma_f32_16x16x32_bf16 v[72:75], a[136:139], v[36:39], v[72:75]
    v_exp_f32 v21, v21
    v_mfma_f32_16x16x32_bf16 v[76:79], a[140:143], v[36:39], v[76:79]
    ds_read_b64_tr_b16 a[132:133], v7 offset:8
    v_cvt_pk_bf16_f32 v34, v20, v21
    v_mfma_f32_16x16x32_bf16 v[80:83], a[144:147], v[36:39], v[80:83]
    v_exp_f32 v22, v22
    v_mfma_f32_16x16x32_bf16 v[84:87], a[148:151], v[36:39], v[84:87]
    ds_read_b64_tr_b16 a[134:135], v7 offset:8200
    ds_read_b64_tr_b16 a[136:137], v7 offset:256
    v_mfma_f32_16x16x32_bf16 v[88:91], a[152:155], v[36:39], v[88:91]
    v_exp_f32 v23, v23
    v_mfma_f32_16x16x32_bf16 v[92:95], a[156:159], v[36:39], v[92:95]
    ds_read_b64_tr_b16 a[138:139], v7 offset:8448
    v_cvt_pk_bf16_f32 v35, v22, v23
    v_mfma_f32_16x16x32_bf16 a[232:235], a[248:251], v[36:39], a[232:235]
    ds_read_b64_tr_b16 a[140:141], v7 offset:264
    ds_read_b64_tr_b16 a[142:143], v7 offset:8456
    v_mfma_f32_16x16x32_bf16 v[16:19], a[96:99], a[192:195], 0
    v_exp_f32 v24, v24
    v_mfma_f32_16x16x32_bf16 v[16:19], a[100:103], a[196:199], v[16:19]
    ds_read_b64_tr_b16 a[144:145], v7 offset:512
    ds_read_b64_tr_b16 a[146:147], v7 offset:8704
    v_mfma_f32_16x16x32_bf16 v[16:19], a[104:107], a[200:203], v[16:19]
    v_exp_f32 v25, v25
    v_mfma_f32_16x16x32_bf16 v[16:19], a[108:111], a[204:207], v[16:19]
    ds_read_b64_tr_b16 a[148:149], v7 offset:520
    v_cvt_pk_bf16_f32 v36, v24, v25
    v_mfma_f32_16x16x32_bf16 v[20:23], a[112:115], a[192:195], 0
    v_exp_f32 v26, v26
    v_mfma_f32_16x16x32_bf16 v[20:23], a[116:119], a[196:199], v[20:23]
    ds_read_b64_tr_b16 a[150:151], v7 offset:8712
    ds_read_b64_tr_b16 a[152:153], v7 offset:768
    v_mfma_f32_16x16x32_bf16 v[20:23], a[120:123], a[200:203], v[20:23]
    v_exp_f32 v27, v27
    v_mul_f32 v161, v13, v161
    v_mfma_f32_16x16x32_bf16 v[20:23], a[124:127], a[204:207], v[20:23]
    s_waitcnt lgkmcnt(11)
    ds_read_b64_tr_b16 a[154:155], v7 offset:8960
    v_cvt_pk_bf16_f32 v37, v26, v27
    v_mfma_f32_16x16x32_bf16 a[0:3], a[128:131], v[32:35], a[0:3]
    s_waitcnt lgkmcnt(10)
    v_exp_f32 v28, v28
    v_mfma_f32_16x16x32_bf16 a[4:7], a[132:135], v[32:35], a[4:7]
    s_waitcnt lgkmcnt(8)
    ds_read_b64_tr_b16 a[156:157], v7 offset:776
    ds_read_b64_tr_b16 a[158:159], v7 offset:8968
    v_mfma_f32_16x16x32_bf16 a[8:11], a[136:139], v[32:35], a[8:11]
    s_waitcnt lgkmcnt(8)
    v_exp_f32 v29, v29
    v_mfma_f32_16x16x32_bf16 a[12:15], a[140:143], v[32:35], a[12:15]
    s_waitcnt lgkmcnt(6)
    v_cvt_pk_bf16_f32 v38, v28, v29
    v_mul_f32 v162, v13, v162
    v_mfma_f32_16x16x32_bf16 a[16:19], a[144:147], v[32:35], a[16:19]
    s_waitcnt lgkmcnt(4)
    v_exp_f32 v30, v30
    v_mfma_f32_16x16x32_bf16 a[20:23], a[148:151], v[32:35], a[20:23]
    s_waitcnt lgkmcnt(2)
    buffer_load_dwordx4 v2, s[20:23], s56 offen offset:1024  lds
    v_mfma_f32_16x16x32_bf16 a[24:27], a[152:155], v[32:35], a[24:27]
    s_waitcnt lgkmcnt(0)
    v_exp_f32 v31, v31
    v_mfma_f32_16x16x32_bf16 a[28:31], a[156:159], v[32:35], a[28:31]
    v_cvt_pk_bf16_f32 v39, v30, v31
    v_mul_f32 v163, v13, v163
    v_mfma_f32_16x16x32_bf16 a[224:227], a[248:251], v[32:35], a[224:227]
    v_mul_f32 v164, v13, v164
    v_mul_f32 v165, v13, v165
    v_mfma_f32_16x16x32_bf16 v[24:27], a[96:99], a[208:211], 0
    v_exp_f32 v16, v16
    v_mfma_f32_16x16x32_bf16 v[24:27], a[100:103], a[212:215], v[24:27]
    ds_read_b128 a[96:99], v43 offset:0
    ds_read_b128 a[100:103], v43 offset:256
    v_mfma_f32_16x16x32_bf16 v[24:27], a[104:107], a[216:219], v[24:27]
    v_exp_f32 v17, v17
    v_mfma_f32_16x16x32_bf16 v[24:27], a[108:111], a[220:223], v[24:27]
    ds_read_b128 a[104:107], v43 offset:512
    v_cvt_pk_bf16_f32 v32, v16, v17
    v_mfma_f32_16x16x32_bf16 v[28:31], a[112:115], a[208:211], 0
    v_exp_f32 v18, v18
    v_mfma_f32_16x16x32_bf16 v[28:31], a[116:119], a[212:215], v[28:31]
    ds_read_b128 a[108:111], v43 offset:768
    ds_read_b128 a[112:115], v43 offset:8192
    v_mfma_f32_16x16x32_bf16 v[28:31], a[120:123], a[216:219], v[28:31]
    v_exp_f32 v19, v19
    v_mfma_f32_16x16x32_bf16 v[28:31], a[124:127], a[220:223], v[28:31]
    ds_read_b128 a[116:119], v43 offset:8448
    v_cvt_pk_bf16_f32 v33, v18, v19
    v_mfma_f32_16x16x32_bf16 a[32:35], a[128:131], v[36:39], a[32:35]
    v_exp_f32 v20, v20
    v_mfma_f32_16x16x32_bf16 a[36:39], a[132:135], v[36:39], a[36:39]
    ds_read_b128 a[120:123], v43 offset:8704
    ds_read_b128 a[124:127], v43 offset:8960
    v_mfma_f32_16x16x32_bf16 a[40:43], a[136:139], v[36:39], a[40:43]
    v_exp_f32 v21, v21
    v_mfma_f32_16x16x32_bf16 a[44:47], a[140:143], v[36:39], a[44:47]
    v_cvt_pk_bf16_f32 v34, v20, v21
    v_mul_f32 v166, v13, v166
    v_mfma_f32_16x16x32_bf16 a[48:51], a[144:147], v[36:39], a[48:51]
    v_exp_f32 v22, v22
    v_mfma_f32_16x16x32_bf16 a[52:55], a[148:151], v[36:39], a[52:55]
    buffer_load_dwordx4 v3, s[24:27], s56 offen offset:2048  lds
    v_mfma_f32_16x16x32_bf16 a[56:59], a[152:155], v[36:39], a[56:59]
    v_exp_f32 v23, v23
    v_mfma_f32_16x16x32_bf16 a[60:63], a[156:159], v[36:39], a[60:63]
    v_cvt_pk_bf16_f32 v35, v22, v23
    v_mul_f32 v167, v13, v167
    v_mfma_f32_16x16x32_bf16 a[228:231], a[248:251], v[36:39], a[228:231]
    s_waitcnt lgkmcnt(7)
    v_cvt_pk_bf16_f32 v160, v160, v161
    v_cvt_pk_bf16_f32 v161, v162, v163
    v_mfma_f32_16x16x32_bf16 v[16:19], a[96:99], a[160:163], 0
    s_waitcnt lgkmcnt(6)
    v_exp_f32 v24, v24
    v_mfma_f32_16x16x32_bf16 v[16:19], a[100:103], a[164:167], v[16:19]
    s_waitcnt lgkmcnt(5)
    v_cvt_pk_bf16_f32 v162, v164, v165
    v_cvt_pk_bf16_f32 v163, v166, v167
    v_mfma_f32_16x16x32_bf16 v[16:19], a[104:107], a[168:171], v[16:19]
    s_waitcnt lgkmcnt(4)
    v_exp_f32 v25, v25
    v_mfma_f32_16x16x32_bf16 v[16:19], a[108:111], a[172:175], v[16:19]
    s_waitcnt lgkmcnt(3)
    v_cvt_pk_bf16_f32 v36, v24, v25
    v_mfma_f32_16x16x32_bf16 v[20:23], a[112:115], a[160:163], 0
    s_waitcnt lgkmcnt(2)
    v_exp_f32 v26, v26
    v_mfma_f32_16x16x32_bf16 v[20:23], a[116:119], a[164:167], v[20:23]
    s_waitcnt lgkmcnt(1)
    buffer_load_dwordx4 v3, s[24:27], s56 offen offset:3072  lds
    v_mfma_f32_16x16x32_bf16 v[20:23], a[120:123], a[168:171], v[20:23]
    s_waitcnt lgkmcnt(0)
    v_exp_f32 v27, v27
    v_mfma_f32_16x16x32_bf16 v[20:23], a[124:127], a[172:175], v[20:23]
    s_add_u32 m0, s32, 114688
    v_cvt_pk_bf16_f32 v37, v26, v27
    v_mfma_f32_16x16x32_bf16 v[64:67], a[128:131], v[32:35], v[64:67]
    v_exp_f32 v28, v28
    v_mfma_f32_16x16x32_bf16 v[68:71], a[132:135], v[32:35], v[68:71]
    buffer_load_dwordx4 v2, s[20:23], s57 offen offset:0  lds
    v_mfma_f32_16x16x32_bf16 v[72:75], a[136:139], v[32:35], v[72:75]
    v_exp_f32 v29, v29
    v_mfma_f32_16x16x32_bf16 v[76:79], a[140:143], v[32:35], v[76:79]
    v_cvt_pk_bf16_f32 v38, v28, v29
    v_mfma_f32_16x16x32_bf16 v[80:83], a[144:147], v[32:35], v[80:83]
    v_exp_f32 v30, v30
    v_mfma_f32_16x16x32_bf16 v[84:87], a[148:151], v[32:35], v[84:87]
    buffer_store_dwordx4 v[160:163], v1, s[28:31], s47 offen offset:0 sc1
    v_mfma_f32_16x16x32_bf16 v[88:91], a[152:155], v[32:35], v[88:91]
    v_exp_f32 v31, v31
    v_mfma_f32_16x16x32_bf16 v[92:95], a[156:159], v[32:35], v[92:95]
    v_cvt_pk_bf16_f32 v39, v30, v31
    v_mul_f32 v168, v13, v168
    v_mfma_f32_16x16x32_bf16 a[232:235], a[248:251], v[32:35], a[232:235]
    buffer_load_dwordx4 v2, s[20:23], s57 offen offset:1024  lds
    v_mfma_f32_16x16x32_bf16 v[24:27], a[96:99], a[176:179], 0
    v_exp_f32 v16, v16
    v_mfma_f32_16x16x32_bf16 v[24:27], a[100:103], a[180:183], v[24:27]
    v_mul_f32 v169, v13, v169
    v_mul_f32 v170, v13, v170
    v_mfma_f32_16x16x32_bf16 v[24:27], a[104:107], a[184:187], v[24:27]
    v_exp_f32 v17, v17
    v_mfma_f32_16x16x32_bf16 v[24:27], a[108:111], a[188:191], v[24:27]
    v_cvt_pk_bf16_f32 v32, v16, v17
    v_mul_f32 v171, v13, v171
    v_mfma_f32_16x16x32_bf16 v[28:31], a[112:115], a[176:179], 0
    v_exp_f32 v18, v18
    v_mfma_f32_16x16x32_bf16 v[28:31], a[116:119], a[180:183], v[28:31]
    buffer_load_dwordx4 v3, s[24:27], s57 offen offset:2048  lds
    v_mfma_f32_16x16x32_bf16 v[28:31], a[120:123], a[184:187], v[28:31]
    v_exp_f32 v19, v19
    v_mfma_f32_16x16x32_bf16 v[28:31], a[124:127], a[188:191], v[28:31]
    v_cvt_pk_bf16_f32 v33, v18, v19
    v_mul_f32 v172, v13, v172
    v_mfma_f32_16x16x32_bf16 v[96:99], a[128:131], v[36:39], v[96:99]
    v_exp_f32 v20, v20
    v_mfma_f32_16x16x32_bf16 v[100:103], a[132:135], v[36:39], v[100:103]
    ds_read_b64_tr_b16 a[128:129], v46 offset:0
    ds_read_b64_tr_b16 a[130:131], v46 offset:8192
    v_mfma_f32_16x16x32_bf16 v[104:107], a[136:139], v[36:39], v[104:107]
    v_exp_f32 v21, v21
    v_mfma_f32_16x16x32_bf16 v[108:111], a[140:143], v[36:39], v[108:111]
    ds_read_b64_tr_b16 a[132:133], v46 offset:8
    v_cvt_pk_bf16_f32 v34, v20, v21
    v_mfma_f32_16x16x32_bf16 v[112:115], a[144:147], v[36:39], v[112:115]
    v_exp_f32 v22, v22
    v_mfma_f32_16x16x32_bf16 v[116:119], a[148:151], v[36:39], v[116:119]
    ds_read_b64_tr_b16 a[134:135], v46 offset:8200
    ds_read_b64_tr_b16 a[136:137], v46 offset:256
    v_mfma_f32_16x16x32_bf16 v[120:123], a[152:155], v[36:39], v[120:123]
    v_exp_f32 v23, v23
    v_mfma_f32_16x16x32_bf16 v[124:127], a[156:159], v[36:39], v[124:127]
    ds_read_b64_tr_b16 a[138:139], v46 offset:8448
    v_cvt_pk_bf16_f32 v35, v22, v23
    v_mfma_f32_16x16x32_bf16 a[236:239], a[248:251], v[36:39], a[236:239]
    ds_read_b64_tr_b16 a[140:141], v46 offset:264
    ds_read_b64_tr_b16 a[142:143], v46 offset:8456
    v_mul_f32 v173, v13, v173
    v_mfma_f32_16x16x32_bf16 v[16:19], a[96:99], a[192:195], 0
    v_exp_f32 v24, v24
    v_mfma_f32_16x16x32_bf16 v[16:19], a[100:103], a[196:199], v[16:19]
    ds_read_b64_tr_b16 a[144:145], v46 offset:512
    ds_read_b64_tr_b16 a[146:147], v46 offset:8704
    v_mfma_f32_16x16x32_bf16 v[16:19], a[104:107], a[200:203], v[16:19]
    v_exp_f32 v25, v25
    v_mfma_f32_16x16x32_bf16 v[16:19], a[108:111], a[204:207], v[16:19]
    ds_read_b64_tr_b16 a[148:149], v46 offset:520
    v_cvt_pk_bf16_f32 v36, v24, v25
    v_mfma_f32_16x16x32_bf16 v[20:23], a[112:115], a[192:195], 0
    v_exp_f32 v26, v26
    v_mfma_f32_16x16x32_bf16 v[20:23], a[116:119], a[196:199], v[20:23]
    ds_read_b64_tr_b16 a[150:151], v46 offset:8712
    ds_read_b64_tr_b16 a[152:153], v46 offset:768
    v_mfma_f32_16x16x32_bf16 v[20:23], a[120:123], a[200:203], v[20:23]
    v_exp_f32 v27, v27
    v_mfma_f32_16x16x32_bf16 v[20:23], a[124:127], a[204:207], v[20:23]
    s_waitcnt lgkmcnt(11)
    ds_read_b64_tr_b16 a[154:155], v46 offset:8960
    v_cvt_pk_bf16_f32 v37, v26, v27
    v_mfma_f32_16x16x32_bf16 a[0:3], a[128:131], v[32:35], a[0:3]
    s_waitcnt lgkmcnt(10)
    v_exp_f32 v28, v28
    v_mfma_f32_16x16x32_bf16 a[4:7], a[132:135], v[32:35], a[4:7]
    s_waitcnt lgkmcnt(8)
    ds_read_b64_tr_b16 a[156:157], v46 offset:776
    ds_read_b64_tr_b16 a[158:159], v46 offset:8968
    v_mfma_f32_16x16x32_bf16 a[8:11], a[136:139], v[32:35], a[8:11]
    s_waitcnt lgkmcnt(8)
    v_exp_f32 v29, v29
    v_mfma_f32_16x16x32_bf16 a[12:15], a[140:143], v[32:35], a[12:15]
    s_waitcnt lgkmcnt(6)
    ds_read_b128 a[96:99], v4 offset:32768
    v_cvt_pk_bf16_f32 v38, v28, v29
L_m8:
    s_cbranch_execz L_back
    v_mfma_f32_16x16x32_bf16 a[16:19], a[144:147], v[32:35], a[16:19]
    s_waitcnt lgkmcnt(5)
    v_exp_f32 v30, v30
    v_mfma_f32_16x16x32_bf16 a[20:23], a[148:151], v[32:35], a[20:23]
    s_waitcnt lgkmcnt(3)
    ds_read_b128 a[100:103], v4 offset:33024
    ds_read_b128 a[104:107], v4 offset:33280
    v_mfma_f32_16x16x32_bf16 a[24:27], a[152:155], v[32:35], a[24:27]
    s_waitcnt lgkmcnt(3)
    v_exp_f32 v31, v31
    v_mfma_f32_16x16x32_bf16 a[28:31], a[156:159], v[32:35], a[28:31]
    ds_read_b128 a[108:111], v4 offset:33536
    v_cvt_pk_bf16_f32 v39, v30, v31
    v_mfma_f32_16x16x32_bf16 a[224:227], a[248:251], v[32:35], a[224:227]
    s_waitcnt lgkmcnt(3)
    ds_read_b128 a[112:115], v4 offset:40960
    ds_read_b128 a[116:119], v4 offset:41216
    v_mfma_f32_16x16x32_bf16 v[24:27], a[96:99], a[160:163], 0
    s_waitcnt lgkmcnt(4)
    v_exp_f32 v16, v16
    v_mfma_f32_16x16x32_bf16 v[24:27], a[100:103], a[164:167], v[24:27]
    s_waitcnt lgkmcnt(3)
    ds_read_b128 a[120:123], v4 offset:41472
    ds_read_b128 a[124:127], v4 offset:41728
    v_mfma_f32_16x16x32_bf16 v[24:27], a[104:107], a[168:171], v[24:27]
    s_waitcnt lgkmcnt(4)
    v_exp_f32 v17, v17
    v_mfma_f32_16x16x32_bf16 v[24:27], a[108:111], a[172:175], v[24:27]
    s_waitcnt lgkmcnt(3)
    v_cvt_pk_bf16_f32 v32, v16, v17
    v_mul_f32 v174, v13, v174
    v_mfma_f32_16x16x32_bf16 v[28:31], a[112:115], a[160:163], 0
    s_waitcnt lgkmcnt(2)
    v_exp_f32 v18, v18
    v_mfma_f32_16x16x32_bf16 v[28:31], a[116:119], a[164:167], v[28:31]
    s_waitcnt lgkmcnt(1)
    buffer_load_dwordx4 v3, s[24:27], s57 offen offset:3072  lds
    v_mfma_f32_16x16x32_bf16 v[28:31], a[120:123], a[168:171], v[28:31]
    s_waitcnt lgkmcnt(0)
    v_exp_f32 v19, v19
    v_mfma_f32_16x16x32_bf16 v[28:31], a[124:127], a[172:175], v[28:31]
    s_add_u32 m0, s32, 131072
    v_cvt_pk_bf16_f32 v33, v18, v19
    v_mul_f32 v175, v13, v175
    v_mfma_f32_16x16x32_bf16 a[32:35], a[128:131], v[36:39], a[32:35]
    v_exp_f32 v20, v20
    v_mfma_f32_16x16x32_bf16 a[36:39], a[132:135], v[36:39], a[36:39]
    buffer_load_dwordx4 v2, s[20:23], s58 offen offset:0  lds
    v_mfma_f32_16x16x32_bf16 a[40:43], a[136:139], v[36:39], a[40:43]
    v_exp_f32 v21, v21
    v_mfma_f32_16x16x32_bf16 a[44:47], a[140:143], v[36:39], a[44:47]
    v_cvt_pk_bf16_f32 v34, v20, v21
    v_cvt_pk_bf16_f32 v168, v168, v169
    v_mfma_f32_16x16x32_bf16 a[48:51], a[144:147], v[36:39], a[48:51]
    v_exp_f32 v22, v22
    v_mfma_f32_16x16x32_bf16 a[52:55], a[148:151], v[36:39], a[52:55]
    v_cvt_pk_bf16_f32 v169, v170, v171
    v_cvt_pk_bf16_f32 v170, v172, v173
    v_cvt_pk_bf16_f32 v171, v174, v175
    v_mfma_f32_16x16x32_bf16 a[56:59], a[152:155], v[36:39], a[56:59]
    v_exp_f32 v23, v23
    v_mfma_f32_16x16x32_bf16 a[60:63], a[156:159], v[36:39], a[60:63]
    v_cvt_pk_bf16_f32 v35, v22, v23
    v_mfma_f32_16x16x32_bf16 a[228:231], a[248:251], v[36:39], a[228:231]
    buffer_store_dwordx4 v[168:171], v1, s[28:31], s47 offen offset:64 sc1
    v_mfma_f32_16x16x32_bf16 v[16:19], a[96:99], a[176:179], 0
    v_exp_f32 v24, v24
    v_mfma_f32_16x16x32_bf16 v[16:19], a[100:103], a[180:183], v[16:19]
    v_mul_f32 v176, v13, v176
    v_mul_f32 v177, v13, v177
    v_mfma_f32_16x16x32_bf16 v[16:19], a[104:107], a[184:187], v[16:19]
    v_exp_f32 v25, v25
    v_mfma_f32_16x16x32_bf16 v[16:19], a[108:111], a[188:191], v[16:19]
    v_cvt_pk_bf16_f32 v36, v24, v25
    v_mul_f32 v178, v13, v178
    v_mfma_f32_16x16x32_bf16 v[20:23], a[112:115], a[176:179], 0
    v_exp_f32 v26, v26
    v_mfma_f32_16x16x32_bf16 v[20:23], a[116:119], a[180:183], v[20:23]
    buffer_load_dwordx4 v2, s[20:23], s58 offen offset:1024  lds
    v_mfma_f32_16x16x32_bf16 v[20:23], a[120:123], a[184:187], v[20:23]
    v_exp_f32 v27, v27
    v_mfma_f32_16x16x32_bf16 v[20:23], a[124:127], a[188:191], v[20:23]
    v_cvt_pk_bf16_f32 v37, v26, v27
    v_mul_f32 v179, v13, v179
    v_mfma_f32_16x16x32_bf16 v[64:67], a[128:131], v[32:35], v[64:67]
    v_exp_f32 v28, v28
    v_mfma_f32_16x16x32_bf16 v[68:71], a[132:135], v[32:35], v[68:71]
    ds_read_b64_tr_b16 a[128:129], v7 offset:32768
    ds_read_b64_tr_b16 a[130:131], v7 offset:40960
    v_mfma_f32_16x16x32_bf16 v[72:75], a[136:139], v[32:35], v[72:75]
    v_exp_f32 v29, v29
    v_mfma_f32_16x16x32_bf16 v[76:79], a[140:143], v[32:35], v[76:79]
    ds_read_b64_tr_b16 a[132:133], v7 offset:32776
    v_cvt_pk_bf16_f32 v38, v28, v29
    v_mfma_f32_16x16x32_bf16 v[80:83], a[144:147], v[32:35], v[80:83]
    v_exp_f32 v30, v30
    v_mfma_f32_16x16x32_bf16 v[84:87], a[148:151], v[32:35], v[84:87]
    ds_read_b64_tr_b16 a[134:135], v7 offset:40968
    ds_read_b64_tr_b16 a[136:137], v7 offset:33024
    v_mfma_f32_16x16x32_bf16 v[88:91], a[152:155], v[32:35], v[88:91]
    v_exp_f32 v31, v31
    v_mfma_f32_16x16x32_bf16 v[92:95], a[156:159], v[32:35], v[92:95]
    ds_read_b64_tr_b16 a[138:139], v7 offset:41216
    v_cvt_pk_bf16_f32 v39, v30, v31
    v_mfma_f32_16x16x32_bf16 a[232:235], a[248:251], v[32:35], a[232:235]
    ds_read_b64_tr_b16 a[140:141], v7 offset:33032
    ds_read_b64_tr_b16 a[142:143], v7 offset:41224
    v_mfma_f32_16x16x32_bf16 v[24:27], a[96:99], a[192:195], 0
    v_exp_f32 v16, v16
    v_mfma_f32_16x16x32_bf16 v[24:27], a[100:103], a[196:199], v[24:27]
    ds_read_b64_tr_b16 a[144:145], v7 offset:33280
    ds_read_b64_tr_b16 a[146:147], v7 offset:41472
    v_mfma_f32_16x16x32_bf16 v[24:27], a[104:107], a[200:203], v[24:27]
    v_exp_f32 v17, v17
    v_mfma_f32_16x16x32_bf16 v[24:27], a[108:111], a[204:207], v[24:27]
    ds_read_b64_tr_b16 a[148:149], v7 offset:33288
    v_cvt_pk_bf16_f32 v32, v16, v17
    v_mfma_f32_16x16x32_bf16 v[28:31], a[112:115], a[192:195], 0
    v_exp_f32 v18, v18
    v_mfma_f32_16x16x32_bf16 v[28:31], a[116:119], a[196:199], v[28:31]
    ds_read_b64_tr_b16 a[150:151], v7 offset:41480
    ds_read_b64_tr_b16 a[152:153], v7 offset:33536
    v_mfma_f32_16x16x32_bf16 v[28:31], a[120:123], a[200:203], v[28:31]
    v_exp_f32 v19, v19
    v_mfma_f32_16x16x32_bf16 v[28:31], a[124:127], a[204:207], v[28:31]
    s_waitcnt lgkmcnt(11)
    ds_read_b64_tr_b16 a[154:155], v7 offset:41728
    v_cvt_pk_bf16_f32 v33, v18, v19
    v_mfma_f32_16x16x32_bf16 a[0:3], a[128:131], v[36:39], a[0:3]
    s_waitcnt lgkmcnt(10)
    v_exp_f32 v20, v20
    v_mfma_f32_16x16x32_bf16 a[4:7], a[132:135], v[36:39], a[4:7]
    s_waitcnt lgkmcnt(8)
    ds_read_b64_tr_b16 a[156:157], v7 offset:33544
    ds_read_b64_tr_b16 a[158:159], v7 offset:41736
    v_mul_f32 v180, v13, v180
    v_mfma_f32_16x16x32_bf16 a[8:11], a[136:139], v[36:39], a[8:11]
    s_waitcnt lgkmcnt(8)
    v_exp_f32 v21, v21
    v_mfma_f32_16x16x32_bf16 a[12:15], a[140:143], v[36:39], a[12:15]
    s_waitcnt lgkmcnt(6)
    v_cvt_pk_bf16_f32 v34, v20, v21
    v_mul_f32 v181, v13, v181
    v_mfma_f32_16x16x32_bf16 a[16:19], a[144:147], v[36:39], a[16:19]
    s_waitcnt lgkmcnt(4)
    v_exp_f32 v22, v22
    v_mfma_f32_16x16x32_bf16 a[20:23], a[148:151], v[36:39], a[20:23]
    s_waitcnt lgkmcnt(2)
    buffer_load_dwordx4 v3, s[24:27], s58 offen offset:2048  lds
    v_mfma_f32_16x16x32_bf16 a[24:27], a[152:155], v[36:39], a[24:27]
    s_waitcnt lgkmcnt(0)
    v_exp_f32 v23, v23
    v_mfma_f32_16x16x32_bf16 a[28:31], a[156:159], v[36:39], a[28:31]
    v_cvt_pk_bf16_f32 v35, v22, v23
    v_mul_f32 v182, v13, v182
    v_mfma_f32_16x16x32_bf16 a[224:227], a[248:251], v[36:39], a[224:227]
    v_mul_f32 v183, v13, v183
    v_cvt_pk_bf16_f32 v176, v176, v177
    v_mfma_f32_16x16x32_bf16 v[16:19], a[96:99], a[208:211], 0
    v_exp_f32 v24, v24
    v_mfma_f32_16x16x32_bf16 v[16:19], a[100:103], a[212:215], v[16:19]
    ds_read_b128 a[96:99], v43 offset:32768
    ds_read_b128 a[100:103], v43 offset:33024
    v_mfma_f32_16x16x32_bf16 v[16:19], a[104:107], a[216:219], v[16:19]
    v_exp_f32 v25, v25
    v_mfma_f32_16x16x32_bf16 v[16:19], a[108:111], a[220:223], v[16:19]
    ds_read_b128 a[104:107], v43 offset:33280
    v_cvt_pk_bf16_f32 v36, v24, v25
    v_mfma_f32_16x16x32_bf16 v[20:23], a[112:115], a[208:211], 0
    v_exp_f32 v26, v26
    v_mfma_f32_16x16x32_bf16 v[20:23], a[116:119], a[212:215], v[20:23]
    ds_read_b128 a[108:111], v43 offset:33536
    ds_read_b128 a[112:115], v43 offset:40960
    v_mfma_f32_16x16x32_bf16 v[20:23], a[120:123], a[216:219], v[20:23]
    v_exp_f32 v27, v27
    v_mfma_f32_16x16x32_bf16 v[20:23], a[124:127], a[220:223], v[20:23]
    ds_read_b128 a[116:119], v43 offset:41216
    v_cvt_pk_bf16_f32 v37, v26, v27
    v_mfma_f32_16x16x32_bf16 a[32:35], a[128:131], v[32:35], a[32:35]
    v_exp_f32 v28, v28
    v_mfma_f32_16x16x32_bf16 a[36:39], a[132:135], v[32:35], a[36:39]
    ds_read_b128 a[120:123], v43 offset:41472
    ds_read_b128 a[124:127], v43 offset:41728
    v_mfma_f32_16x16x32_bf16 a[40:43], a[136:139], v[32:35], a[40:43]
    v_exp_f32 v29, v29
    v_mfma_f32_16x16x32_bf16 a[44:47], a[140:143], v[32:35], a[44:47]
    v_cvt_pk_bf16_f32 v38, v28, v29
    v_cvt_pk_bf16_f32 v177, v178, v179
    v_mfma_f32_16x16x32_bf16 a[48:51], a[144:147], v[32:35], a[48:51]
    v_exp_f32 v30, v30
    v_mfma_f32_16x16x32_bf16 a[52:55], a[148:151], v[32:35], a[52:55]
    buffer_load_dwordx4 v3, s[24:27], s58 offen offset:3072  lds
    v_mfma_f32_16x16x32_bf16 a[56:59], a[152:155], v[32:35], a[56:59]
    s_add_u32 m0, s32, 147456
    v_exp_f32 v31, v31
    v_mfma_f32_16x16x32_bf16 a[60:63], a[156:159], v[32:35], a[60:63]
    v_cvt_pk_bf16_f32 v39, v30, v31
    v_cvt_pk_bf16_f32 v178, v180, v181
    v_mfma_f32_16x16x32_bf16 a[228:231], a[248:251], v[32:35], a[228:231]
    s_waitcnt lgkmcnt(7)
    buffer_load_dwordx4 v2, s[20:23], s59 offen offset:0  lds
    v_mfma_f32_16x16x32_bf16 v[24:27], a[96:99], a[160:163], 0
    s_waitcnt lgkmcnt(6)
    v_exp_f32 v16, v16
    v_mfma_f32_16x16x32_bf16 v[24:27], a[100:103], a[164:167], v[24:27]
    s_waitcnt lgkmcnt(5)
    v_cvt_pk_bf16_f32 v179, v182, v183
    v_mfma_f32_16x16x32_bf16 v[24:27], a[104:107], a[168:171], v[24:27]
    s_waitcnt lgkmcnt(4)
    v_exp_f32 v17, v17
    v_mfma_f32_16x16x32_bf16 v[24:27], a[108:111], a[172:175], v[24:27]
    s_waitcnt lgkmcnt(3)
    v_cvt_pk_bf16_f32 v32, v16, v17
    v_mfma_f32_16x16x32_bf16 v[28:31], a[112:115], a[160:163], 0
    s_waitcnt lgkmcnt(2)
    v_exp_f32 v18, v18
    v_mfma_f32_16x16x32_bf16 v[28:31], a[116:119], a[164:167], v[28:31]
    s_waitcnt lgkmcnt(1)
    buffer_store_dwordx4 v[176:179], v1, s[28:31], s47 offen offset:128 sc1
    v_mfma_f32_16x16x32_bf16 v[28:31], a[120:123], a[168:171], v[28:31]
    s_waitcnt lgkmcnt(0)
    v_exp_f32 v19, v19
    v_mul_f32 v184, v13, v184
    v_mfma_f32_16x16x32_bf16 v[28:31], a[124:127], a[172:175], v[28:31]
    v_cvt_pk_bf16_f32 v33, v18, v19
    v_mul_f32 v185, v13, v185
    v_mfma_f32_16x16x32_bf16 v[64:67], a[128:131], v[36:39], v[64:67]
    v_exp_f32 v20, v20
    v_mfma_f32_16x16x32_bf16 v[68:71], a[132:135], v[36:39], v[68:71]
    buffer_load_dwordx4 v2, s[20:23], s59 offen offset:1024  lds
    v_mfma_f32_16x16x32_bf16 v[72:75], a[136:139], v[36:39], v[72:75]
    v_exp_f32 v21, v21
    v_mfma_f32_16x16x32_bf16 v[76:79], a[140:143], v[36:39], v[76:79]
    v_cvt_pk_bf16_f32 v34, v20, v21
    v_mul_f32 v186, v13, v186
    v_mfma_f32_16x16x32_bf16 v[80:83], a[144:147], v[36:39], v[80:83]
    v_exp_f32 v22, v22
    v_mfma_f32_16x16x32_bf16 v[84:87], a[148:151], v[36:39], v[84:87]
    v_mul_f32 v187, v13, v187
    v_mul_f32 v188, v13, v188
    v_mfma_f32_16x16x32_bf16 v[88:91], a[152:155], v[36:39], v[88:91]
    v_exp_f32 v23, v23
    v_mfma_f32_16x16x32_bf16 v[92:95], a[156:159], v[36:39], v[92:95]
    v_cvt_pk_bf16_f32 v35, v22, v23
    v_mul_f32 v189, v13, v189
    v_mfma_f32_16x16x32_bf16 a[232:235], a[248:251], v[36:39], a[232:235]
    v_mul_f32 v190, v13, v190
    v_mul_f32 v191, v13, v191
    v_mfma_f32_16x16x32_bf16 v[16:19], a[96:99], a[176:179], 0
    v_exp_f32 v24, v24
    v_mfma_f32_16x16x32_bf16 v[16:19], a[100:103], a[180:183], v[16:19]
    v_cvt_pk_bf16_f32 v184, v184, v185
    v_cvt_pk_bf16_f32 v185, v186, v187
    v_mfma_f32_16x16x32_bf16 v[16:19], a[104:107], a[184:187], v[16:19]
    v_exp_f32 v25, v25
    v_mfma_f32_16x16x32_bf16 v[16:19], a[108:111], a[188:191], v[16:19]
    v_cvt_pk_bf16_f32 v36, v24, v25
    v_cvt_pk_bf16_f32 v186, v188, v189
    v_mfma_f32_16x16x32_bf16 v[20:23], a[112:115], a[176:179], 0
    v_exp_f32 v26, v26
    v_mfma_f32_16x16x32_bf16 v[20:23], a[116:119], a[180:183], v[20:23]
    buffer_load_dwordx4 v3, s[24:27], s59 offen offset:2048  lds
    v_mfma_f32_16x16x32_bf16 v[20:23], a[120:123], a[184:187], v[20:23]
    v_exp_f32 v27, v27
    v_mfma_f32_16x16x32_bf16 v[20:23], a[124:127], a[188:191], v[20:23]
    v_cvt_pk_bf16_f32 v37, v26, v27
    v_cvt_pk_bf16_f32 v187, v190, v191
    v_mfma_f32_16x16x32_bf16 v[96:99], a[128:131], v[32:35], v[96:99]
    v_exp_f32 v28, v28
    v_mfma_f32_16x16x32_bf16 v[100:103], a[132:135], v[32:35], v[100:103]
    ds_read_b64_tr_b16 a[128:129], v46 offset:32768
    ds_read_b64_tr_b16 a[130:131], v46 offset:40960
    v_mfma_f32_16x16x32_bf16 v[104:107], a[136:139], v[32:35], v[104:107]
    v_exp_f32 v29, v29
    v_mfma_f32_16x16x32_bf16 v[108:111], a[140:143], v[32:35], v[108:111]
    ds_read_b64_tr_b16 a[132:133], v46 offset:32776
    v_cvt_pk_bf16_f32 v38, v28, v29
    v_mfma_f32_16x16x32_bf16 v[112:115], a[144:147], v[32:35], v[112:115]
    v_exp_f32 v30, v30
    v_mfma_f32_16x16x32_bf16 v[116:119], a[148:151], v[32:35], v[116:119]
    ds_read_b64_tr_b16 a[134:135], v46 offset:40968
    ds_read_b64_tr_b16 a[136:137], v46 offset:33024
    v_mfma_f32_16x16x32_bf16 v[120:123], a[152:155], v[32:35], v[120:123]
    v_exp_f32 v31, v31
    v_mfma_f32_16x16x32_bf16 v[124:127], a[156:159], v[32:35], v[124:127]
    ds_read_b64_tr_b16 a[138:139], v46 offset:41216
    v_cvt_pk_bf16_f32 v39, v30, v31
    v_mfma_f32_16x16x32_bf16 a[236:239], a[248:251], v[32:35], a[236:239]
    ds_read_b64_tr_b16 a[140:141], v46 offset:33032
    ds_read_b64_tr_b16 a[142:143], v46 offset:41224
    v_mfma_f32_16x16x32_bf16 v[24:27], a[96:99], a[192:195], 0
    v_exp_f32 v16, v16
    v_mfma_f32_16x16x32_bf16 v[24:27], a[100:103], a[196:199], v[24:27]
    ds_read_b64_tr_b16 a[144:145], v46 offset:33280
    ds_read_b64_tr_b16 a[146:147], v46 offset:41472
    v_mfma_f32_16x16x32_bf16 v[24:27], a[104:107], a[200:203], v[24:27]
    v_exp_f32 v17, v17
    v_mfma_f32_16x16x32_bf16 v[24:27], a[108:111], a[204:207], v[24:27]
    ds_read_b64_tr_b16 a[148:149], v46 offset:33288
    v_cvt_pk_bf16_f32 v32, v16, v17
    v_mfma_f32_16x16x32_bf16 v[28:31], a[112:115], a[192:195], 0
    v_exp_f32 v18, v18
    v_mfma_f32_16x16x32_bf16 v[28:31], a[116:119], a[196:199], v[28:31]
    ds_read_b64_tr_b16 a[150:151], v46 offset:41480
    ds_read_b64_tr_b16 a[152:153], v46 offset:33536
    v_mfma_f32_16x16x32_bf16 v[28:31], a[120:123], a[200:203], v[28:31]
    v_exp_f32 v19, v19
    v_mfma_f32_16x16x32_bf16 v[28:31], a[124:127], a[204:207], v[28:31]
    s_waitcnt lgkmcnt(11)
    ds_read_b64_tr_b16 a[154:155], v46 offset:41728
    v_cvt_pk_bf16_f32 v33, v18, v19
    v_mfma_f32_16x16x32_bf16 a[0:3], a[128:131], v[36:39], a[0:3]
    s_waitcnt lgkmcnt(10)
    v_exp_f32 v20, v20
    v_mfma_f32_16x16x32_bf16 a[4:7], a[132:135], v[36:39], a[4:7]
    s_waitcnt lgkmcnt(8)
    ds_read_b64_tr_b16 a[156:157], v46 offset:33544
    ds_read_b64_tr_b16 a[158:159], v46 offset:41736
    v_mfma_f32_16x16x32_bf16 a[8:11], a[136:139], v[36:39], a[8:11]
    s_waitcnt lgkmcnt(8)
    v_exp_f32 v21, v21
    v_mfma_f32_16x16x32_bf16 a[12:15], a[140:143], v[36:39], a[12:15]
    s_waitcnt lgkmcnt(6)
    ds_read_b128 a[96:99], v5 offset:0
    v_cvt_pk_bf16_f32 v34, v20, v21
    v_mfma_f32_16x16x32_bf16 a[16:19], a[144:147], v[36:39], a[16:19]
    s_waitcnt lgkmcnt(5)
    v_exp_f32 v22, v22
    v_mfma_f32_16x16x32_bf16 a[20:23], a[148:151], v[36:39], a[20:23]
    s_waitcnt lgkmcnt(3)
    ds_read_b128 a[100:103], v5 offset:256
    ds_read_b128 a[104:107], v5 offset:512
    v_mfma_f32_16x16x32_bf16 a[24:27], a[152:155], v[36:39], a[24:27]
    s_waitcnt lgkmcnt(3)
    v_exp_f32 v23, v23
    v_mfma_f32_16x16x32_bf16 a[28:31], a[156:159], v[36:39], a[28:31]
    ds_read_b128 a[108:111], v5 offset:768
    v_cvt_pk_bf16_f32 v35, v22, v23
    v_mfma_f32_16x16x32_bf16 a[224:227], a[248:251], v[36:39], a[224:227]
    s_waitcnt lgkmcnt(3)
    ds_read_b128 a[112:115], v5 offset:8192
    ds_read_b128 a[116:119], v5 offset:8448
    v_mfma_f32_16x16x32_bf16 v[16:19], a[96:99], a[160:163], 0
    s_waitcnt lgkmcnt(4)
    v_exp_f32 v24, v24
    v_mfma_f32_16x16x32_bf16 v[16:19], a[100:103], a[164:167], v[16:19]
    s_waitcnt lgkmcnt(3)
    ds_read_b128 a[120:123], v5 offset:8704
    ds_read_b128 a[124:127], v5 offset:8960
    v_mfma_f32_16x16x32_bf16 v[16:19], a[104:107], a[168:171], v[16:19]
    s_waitcnt lgkmcnt(4)
    v_exp_f32 v25, v25
    v_mfma_f32_16x16x32_bf16 v[16:19], a[108:111], a[172:175], v[16:19]
    s_waitcnt lgkmcnt(3)
    v_cvt_pk_bf16_f32 v36, v24, v25
    v_mfma_f32_16x16x32_bf16 v[20:23], a[112:115], a[160:163], 0
    s_waitcnt lgkmcnt(2)
    v_exp_f32 v26, v26
    v_mfma_f32_16x16x32_bf16 v[20:23], a[116:119], a[164:167], v[20:23]
    s_waitcnt lgkmcnt(1)
    buffer_load_dwordx4 v3, s[24:27], s59 offen offset:3072  lds
    v_mfma_f32_16x16x32_bf16 v[20:23], a[120:123], a[168:171], v[20:23]
    s_waitcnt lgkmcnt(0)
    v_exp_f32 v27, v27
    v_mfma_f32_16x16x32_bf16 v[20:23], a[124:127], a[172:175], v[20:23]
    v_cvt_pk_bf16_f32 v37, v26, v27
    v_mfma_f32_16x16x32_bf16 a[32:35], a[128:131], v[32:35], a[32:35]
    v_exp_f32 v28, v28
    v_mfma_f32_16x16x32_bf16 a[36:39], a[132:135], v[32:35], a[36:39]
    buffer_store_dwordx4 v[184:187], v1, s[28:31], s47 offen offset:192 sc1
    v_mfma_f32_16x16x32_bf16 a[40:43], a[136:139], v[32:35], a[40:43]
    v_exp_f32 v29, v29
    v_mfma_f32_16x16x32_bf16 a[44:47], a[140:143], v[32:35], a[44:47]
    v_cvt_pk_bf16_f32 v38, v28, v29
    v_subrev_u32 v42, s38, v14
    v_mfma_f32_16x16x32_bf16 a[48:51], a[144:147], v[32:35], a[48:51]
    v_exp_f32 v30, v30
    v_mfma_f32_16x16x32_bf16 a[52:55], a[148:151], v[32:35], a[52:55]
    v_cmp_lt_u32 vcc, s39, v42
    v_mfma_f32_16x16x32_bf16 a[56:59], a[152:155], v[32:35], a[56:59]
    v_exp_f32 v31, v31
    v_mfma_f32_16x16x32_bf16 a[60:63], a[156:159], v[32:35], a[60:63]
    s_waitcnt vmcnt(11)
    v_cvt_pk_bf16_f32 v39, v30, v31
    v_mfma_f32_16x16x32_bf16 a[228:231], a[248:251], v[32:35], a[228:231]
    s_barrier
    v_mfma_f32_16x16x32_bf16 v[24:27], a[96:99], a[176:179], 0
    s_add_u32 m0, s32, 0
    v_exp_f32 v16, v16
    v_mfma_f32_16x16x32_bf16 v[24:27], a[100:103], a[180:183], v[24:27]
    buffer_load_dwordx4 v2, s[20:23], s60 offen offset:0  lds
    v_mfma_f32_16x16x32_bf16 v[24:27], a[104:107], a[184:187], v[24:27]
    v_exp_f32 v17, v17
    v_mfma_f32_16x16x32_bf16 v[24:27], a[108:111], a[188:191], v[24:27]
    v_cvt_pk_bf16_f32 v32, v16, v17
    v_mfma_f32_16x16x32_bf16 v[28:31], a[112:115], a[176:179], 0
    v_exp_f32 v18, v18
    v_mfma_f32_16x16x32_bf16 v[28:31], a[116:119], a[180:183], v[28:31]
    v_rcp_f32 v14, v14
    v_mfma_f32_16x16x32_bf16 v[28:31], a[120:123], a[184:187], v[28:31]
    s_or_b64 s[40:41], s[40:41], vcc
    v_exp_f32 v19, v19
    v_mfma_f32_16x16x32_bf16 v[28:31], a[124:127], a[188:191], v[28:31]
    v_cvt_pk_bf16_f32 v33, v18, v19
    v_mul_f32 v192, v14, v192
    v_mfma_f32_16x16x32_bf16 v[64:67], a[128:131], v[36:39], v[64:67]
    v_exp_f32 v20, v20
    v_mfma_f32_16x16x32_bf16 v[68:71], a[132:135], v[36:39], v[68:71]
    ds_read_b64_tr_b16 a[128:129], v8 offset:0
    ds_read_b64_tr_b16 a[130:131], v8 offset:8192
    v_mfma_f32_16x16x32_bf16 v[72:75], a[136:139], v[36:39], v[72:75]
    v_exp_f32 v21, v21
    v_mfma_f32_16x16x32_bf16 v[76:79], a[140:143], v[36:39], v[76:79]
    ds_read_b64_tr_b16 a[132:133], v8 offset:8
    v_cvt_pk_bf16_f32 v34, v20, v21
    v_mfma_f32_16x16x32_bf16 v[80:83], a[144:147], v[36:39], v[80:83]
    v_exp_f32 v22, v22
    v_mfma_f32_16x16x32_bf16 v[84:87], a[148:151], v[36:39], v[84:87]
    ds_read_b64_tr_b16 a[134:135], v8 offset:8200
    ds_read_b64_tr_b16 a[136:137], v8 offset:256
    v_mfma_f32_16x16x32_bf16 v[88:91], a[152:155], v[36:39], v[88:91]
    v_exp_f32 v23, v23
    v_mfma_f32_16x16x32_bf16 v[92:95], a[156:159], v[36:39], v[92:95]
    ds_read_b64_tr_b16 a[138:139], v8 offset:8448
    v_cvt_pk_bf16_f32 v35, v22, v23
    v_mfma_f32_16x16x32_bf16 a[232:235], a[248:251], v[36:39], a[232:235]
    ds_read_b64_tr_b16 a[140:141], v8 offset:264
    ds_read_b64_tr_b16 a[142:143], v8 offset:8456
    v_mfma_f32_16x16x32_bf16 v[16:19], a[96:99], a[192:195], 0
    v_exp_f32 v24, v24
    v_mfma_f32_16x16x32_bf16 v[16:19], a[100:103], a[196:199], v[16:19]
    ds_read_b64_tr_b16 a[144:145], v8 offset:512
    ds_read_b64_tr_b16 a[146:147], v8 offset:8704
    v_mfma_f32_16x16x32_bf16 v[16:19], a[104:107], a[200:203], v[16:19]
    v_exp_f32 v25, v25
    v_mfma_f32_16x16x32_bf16 v[16:19], a[108:111], a[204:207], v[16:19]
    ds_read_b64_tr_b16 a[148:149], v8 offset:520
    v_cvt_pk_bf16_f32 v36, v24, v25
    v_mfma_f32_16x16x32_bf16 v[20:23], a[112:115], a[192:195], 0
    v_exp_f32 v26, v26
    v_mfma_f32_16x16x32_bf16 v[20:23], a[116:119], a[196:199], v[20:23]
    ds_read_b64_tr_b16 a[150:151], v8 offset:8712
    ds_read_b64_tr_b16 a[152:153], v8 offset:768
    v_mfma_f32_16x16x32_bf16 v[20:23], a[120:123], a[200:203], v[20:23]
    v_exp_f32 v27, v27
    v_mfma_f32_16x16x32_bf16 v[20:23], a[124:127], a[204:207], v[20:23]
    s_waitcnt lgkmcnt(11)
    ds_read_b64_tr_b16 a[154:155], v8 offset:8960
    v_cvt_pk_bf16_f32 v37, v26, v27
    v_mfma_f32_16x16x32_bf16 a[0:3], a[128:131], v[32:35], a[0:3]
    s_waitcnt lgkmcnt(10)
    v_exp_f32 v28, v28
    v_mfma_f32_16x16x32_bf16 a[4:7], a[132:135], v[32:35], a[4:7]
    s_waitcnt lgkmcnt(8)
    ds_read_b64_tr_b16 a[156:157], v8 offset:776
    ds_read_b64_tr_b16 a[158:159], v8 offset:8968
    v_mfma_f32_16x16x32_bf16 a[8:11], a[136:139], v[32:35], a[8:11]
    s_waitcnt lgkmcnt(8)
    v_exp_f32 v29, v29
    v_mfma_f32_16x16x32_bf16 a[12:15], a[140:143], v[32:35], a[12:15]
    s_waitcnt lgkmcnt(6)
    v_cvt_pk_bf16_f32 v38, v28, v29
    v_mul_f32 v193, v14, v193
    v_mfma_f32_16x16x32_bf16 a[16:19], a[144:147], v[32:35], a[16:19]
    s_waitcnt lgkmcnt(4)
    v_exp_f32 v30, v30
    v_mfma_f32_16x16x32_bf16 a[20:23], a[148:151], v[32:35], a[20:23]
    s_waitcnt lgkmcnt(2)
    buffer_load_dwordx4 v2, s[20:23], s60 offen offset:1024  lds
    v_mfma_f32_16x16x32_bf16 a[24:27], a[152:155], v[32:35], a[24:27]
    s_waitcnt lgkmcnt(0)
    v_exp_f32 v31, v31
    v_mul_f32 v194, v14, v194
    v_mfma_f32_16x16x32_bf16 a[28:31], a[156:159], v[32:35], a[28:31]
    v_cvt_pk_bf16_f32 v39, v30, v31
    v_mul_f32 v195, v14, v195
    v_mfma_f32_16x16x32_bf16 a[224:227], a[248:251], v[32:35], a[224:227]
    v_mul_f32 v196, v14, v196
    v_mul_f32 v197, v14, v197
    v_mfma_f32_16x16x32_bf16 v[24:27], a[96:99], a[208:211], 0
    v_exp_f32 v16, v16
    v_mfma_f32_16x16x32_bf16 v[24:27], a[100:103], a[212:215], v[24:27]
    ds_read_b128 a[96:99], v44 offset:0
    ds_read_b128 a[100:103], v44 offset:256
    v_mfma_f32_16x16x32_bf16 v[24:27], a[104:107], a[216:219], v[24:27]
    v_exp_f32 v17, v17
    v_mfma_f32_16x16x32_bf16 v[24:27], a[108:111], a[220:223], v[24:27]
    ds_read_b128 a[104:107], v44 offset:512
    v_cvt_pk_bf16_f32 v32, v16, v17
    v_mfma_f32_16x16x32_bf16 v[28:31], a[112:115], a[208:211], 0
    v_exp_f32 v18, v18
    v_mfma_f32_16x16x32_bf16 v[28:31], a[116:119], a[212:215], v[28:31]
    ds_read_b128 a[108:111], v44 offset:768
    ds_read_b128 a[112:115], v44 offset:8192
    v_mfma_f32_16x16x32_bf16 v[28:31], a[120:123], a[216:219], v[28:31]
    v_exp_f32 v19, v19
    v_mfma_f32_16x16x32_bf16 v[28:31], a[124:127], a[220:223], v[28:31]
    ds_read_b128 a[116:119], v44 offset:8448
    v_cvt_pk_bf16_f32 v33, v18, v19
    v_mfma_f32_16x16x32_bf16 a[32:35], a[128:131], v[36:39], a[32:35]
    v_exp_f32 v20, v20
    v_mfma_f32_16x16x32_bf16 a[36:39], a[132:135], v[36:39], a[36:39]
    ds_read_b128 a[120:123], v44 offset:8704
    ds_read_b128 a[124:127], v44 offset:8960
    v_mfma_f32_16x16x32_bf16 a[40:43], a[136:139], v[36:39], a[40:43]
    v_exp_f32 v21, v21
    v_mfma_f32_16x16x32_bf16 a[44:47], a[140:143], v[36:39], a[44:47]
    v_cvt_pk_bf16_f32 v34, v20, v21
    v_mul_f32 v198, v14, v198
    v_mfma_f32_16x16x32_bf16 a[48:51], a[144:147], v[36:39], a[48:51]
    v_exp_f32 v22, v22
    v_mfma_f32_16x16x32_bf16 a[52:55], a[148:151], v[36:39], a[52:55]
    buffer_load_dwordx4 v3, s[24:27], s60 offen offset:2048  lds
    v_mfma_f32_16x16x32_bf16 a[56:59], a[152:155], v[36:39], a[56:59]
    v_exp_f32 v23, v23
    v_mfma_f32_16x16x32_bf16 a[60:63], a[156:159], v[36:39], a[60:63]
    v_cvt_pk_bf16_f32 v35, v22, v23
    v_mul_f32 v199, v14, v199
    v_mfma_f32_16x16x32_bf16 a[228:231], a[248:251], v[36:39], a[228:231]
    s_waitcnt lgkmcnt(7)
    v_cvt_pk_bf16_f32 v192, v192, v193
    v_cvt_pk_bf16_f32 v193, v194, v195
    v_mfma_f32_16x16x32_bf16 v[16:19], a[96:99], a[160:163], 0
    s_waitcnt lgkmcnt(6)
    v_exp_f32 v24, v24
    v_mfma_f32_16x16x32_bf16 v[16:19], a[100:103], a[164:167], v[16:19]
    s_waitcnt lgkmcnt(5)
    v_cvt_pk_bf16_f32 v194, v196, v197
    v_cvt_pk_bf16_f32 v195, v198, v199
    v_mfma_f32_16x16x32_bf16 v[16:19], a[104:107], a[168:171], v[16:19]
    s_waitcnt lgkmcnt(4)
    v_exp_f32 v25, v25
    v_mfma_f32_16x16x32_bf16 v[16:19], a[108:111], a[172:175], v[16:19]
    s_waitcnt lgkmcnt(3)
    v_cvt_pk_bf16_f32 v36, v24, v25
    v_mfma_f32_16x16x32_bf16 v[20:23], a[112:115], a[160:163], 0
    s_waitcnt lgkmcnt(2)
    v_exp_f32 v26, v26
    v_mfma_f32_16x16x32_bf16 v[20:23], a[116:119], a[164:167], v[20:23]
    s_waitcnt lgkmcnt(1)
    buffer_load_dwordx4 v3, s[24:27], s60 offen offset:3072  lds
    v_mfma_f32_16x16x32_bf16 v[20:23], a[120:123], a[168:171], v[20:23]
    s_waitcnt lgkmcnt(0)
    v_exp_f32 v27, v27
    v_mfma_f32_16x16x32_bf16 v[20:23], a[124:127], a[172:175], v[20:23]
    s_add_u32 m0, s32, 16384
    v_cvt_pk_bf16_f32 v37, v26, v27
    v_mfma_f32_16x16x32_bf16 v[64:67], a[128:131], v[32:35], v[64:67]
    v_exp_f32 v28, v28
    v_mfma_f32_16x16x32_bf16 v[68:71], a[132:135], v[32:35], v[68:71]
    buffer_load_dwordx4 v2, s[20:23], s61 offen offset:0  lds
    v_mfma_f32_16x16x32_bf16 v[72:75], a[136:139], v[32:35], v[72:75]
    v_exp_f32 v29, v29
    v_mfma_f32_16x16x32_bf16 v[76:79], a[140:143], v[32:35], v[76:79]
    buffer_store_dwordx4 v[192:195], v1, s[28:31], s48 offen offset:0 sc1
    v_cvt_pk_bf16_f32 v38, v28, v29
    v_mfma_f32_16x16x32_bf16 v[80:83], a[144:147], v[32:35], v[80:83]
    v_exp_f32 v30, v30
    v_mfma_f32_16x16x32_bf16 v[84:87], a[148:151], v[32:35], v[84:87]
    v_mul_f32 v200, v14, v200
    v_mul_f32 v201, v14, v201
    v_mfma_f32_16x16x32_bf16 v[88:91], a[152:155], v[32:35], v[88:91]
    v_exp_f32 v31, v31
    v_mfma_f32_16x16x32_bf16 v[92:95], a[156:159], v[32:35], v[92:95]
    v_cvt_pk_bf16_f32 v39, v30, v31
    v_mul_f32 v202, v14, v202
    v_mfma_f32_16x16x32_bf16 a[232:235], a[248:251], v[32:35], a[232:235]
    v_mul_f32 v203, v14, v203
    v_mul_f32 v204, v14, v204
    v_mfma_f32_16x16x32_bf16 v[24:27], a[96:99], a[176:179], 0
    v_exp_f32 v16, v16
    v_mfma_f32_16x16x32_bf16 v[24:27], a[100:103], a[180:183], v[24:27]
    buffer_load_dwordx4 v2, s[20:23], s61 offen offset:1024  lds
    v_mfma_f32_16x16x32_bf16 v[24:27], a[104:107], a[184:187], v[24:27]
    v_exp_f32 v17, v17
    v_mfma_f32_16x16x32_bf16 v[24:27], a[108:111], a[188:191], v[24:27]
    v_cvt_pk_bf16_f32 v32, v16, v17
    v_mul_f32 v205, v14, v205
    v_mfma_f32_16x16x32_bf16 v[28:31], a[112:115], a[176:179], 0
    v_exp_f32 v18, v18
    v_mfma_f32_16x16x32_bf16 v[28:31], a[116:119], a[180:183], v[28:31]
    v_mul_f32 v206, v14, v206
    v_mul_f32 v207, v14, v207
    v_mfma_f32_16x16x32_bf16 v[28:31], a[120:123], a[184:187], v[28:31]
    v_exp_f32 v19, v19
    v_mfma_f32_16x16x32_bf16 v[28:31], a[124:127], a[188:191], v[28:31]
    v_cvt_pk_bf16_f32 v33, v18, v19
    v_cvt_pk_bf16_f32 v200, v200, v201
    v_mfma_f32_16x16x32_bf16 v[96:99], a[128:131], v[36:39], v[96:99]
    v_exp_f32 v20, v20
    v_mfma_f32_16x16x32_bf16 v[100:103], a[132:135], v[36:39], v[100:103]
    ds_read_b64_tr_b16 a[128:129], v47 offset:0
    ds_read_b64_tr_b16 a[130:131], v47 offset:8192
    v_mfma_f32_16x16x32_bf16 v[104:107], a[136:139], v[36:39], v[104:107]
    v_exp_f32 v21, v21
    v_mfma_f32_16x16x32_bf16 v[108:111], a[140:143], v[36:39], v[108:111]
    ds_read_b64_tr_b16 a[132:133], v47 offset:8
    v_cvt_pk_bf16_f32 v34, v20, v21
    v_mfma_f32_16x16x32_bf16 v[112:115], a[144:147], v[36:39], v[112:115]
    v_exp_f32 v22, v22
    v_mfma_f32_16x16x32_bf16 v[116:119], a[148:151], v[36:39], v[116:119]
    ds_read_b64_tr_b16 a[134:135], v47 offset:8200
    ds_read_b64_tr_b16 a[136:137], v47 offset:256
    v_mfma_f32_16x16x32_bf16 v[120:123], a[152:155], v[36:39], v[120:123]
    v_exp_f32 v23, v23
    v_mfma_f32_16x16x32_bf16 v[124:127], a[156:159], v[36:39], v[124:127]
    ds_read_b64_tr_b16 a[138:139], v47 offset:8448
    v_cvt_pk_bf16_f32 v35, v22, v23
    v_mfma_f32_16x16x32_bf16 a[236:239], a[248:251], v[36:39], a[236:239]
    ds_read_b64_tr_b16 a[140:141], v47 offset:264
    ds_read_b64_tr_b16 a[142:143], v47 offset:8456
    v_mfma_f32_16x16x32_bf16 v[16:19], a[96:99], a[192:195], 0
    v_exp_f32 v24, v24
    v_mfma_f32_16x16x32_bf16 v[16:19], a[100:103], a[196:199], v[16:19]
    ds_read_b64_tr_b16 a[144:145], v47 offset:512
    ds_read_b64_tr_b16 a[146:147], v47 offset:8704
    v_mfma_f32_16x16x32_bf16 v[16:19], a[104:107], a[200:203], v[16:19]
L_m9:
    s_cbranch_execz L_m10
    v_exp_f32 v25, v25
    v_mfma_f32_16x16x32_bf16 v[16:19], a[108:111], a[204:207], v[16:19]
    ds_read_b64_tr_b16 a[148:149], v47 offset:520
    v_cvt_pk_bf16_f32 v36, v24, v25
    v_mfma_f32_16x16x32_bf16 v[20:23], a[112:115], a[192:195], 0
    v_exp_f32 v26, v26
    v_mfma_f32_16x16x32_bf16 v[20:23], a[116:119], a[196:199], v[20:23]
    ds_read_b64_tr_b16 a[150:151], v47 offset:8712
    ds_read_b64_tr_b16 a[152:153], v47 offset:768
    v_mfma_f32_16x16x32_bf16 v[20:23], a[120:123], a[200:203], v[20:23]
    v_exp_f32 v27, v27
    v_mfma_f32_16x16x32_bf16 v[20:23], a[124:127], a[204:207], v[20:23]
    s_waitcnt lgkmcnt(11)
    ds_read_b64_tr_b16 a[154:155], v47 offset:8960
    v_cvt_pk_bf16_f32 v37, v26, v27
    v_cvt_pk_bf16_f32 v201, v202, v203
    v_mfma_f32_16x16x32_bf16 a[0:3], a[128:131], v[32:35], a[0:3]
    s_waitcnt lgkmcnt(10)
    v_exp_f32 v28, v28
    v_mfma_f32_16x16x32_bf16 a[4:7], a[132:135], v[32:35], a[4:7]
    s_waitcnt lgkmcnt(8)
    ds_read_b64_tr_b16 a[156:157], v47 offset:776
    ds_read_b64_tr_b16 a[158:159], v47 offset:8968
    v_mfma_f32_16x16x32_bf16 a[8:11], a[136:139], v[32:35], a[8:11]
    s_waitcnt lgkmcnt(8)
    v_exp_f32 v29, v29
    v_mfma_f32_16x16x32_bf16 a[12:15], a[140:143], v[32:35], a[12:15]
    s_waitcnt lgkmcnt(6)
    ds_read_b128 a[96:99], v5 offset:32768
    v_cvt_pk_bf16_f32 v38, v28, v29
    v_mfma_f32_16x16x32_bf16 a[16:19], a[144:147], v[32:35], a[16:19]
    s_waitcnt lgkmcnt(5)
    v_exp_f32 v30, v30
    v_mfma_f32_16x16x32_bf16 a[20:23], a[148:151], v[32:35], a[20:23]
    s_waitcnt lgkmcnt(3)
    ds_read_b128 a[100:103], v5 offset:33024
    ds_read_b128 a[104:107], v5 offset:33280
    v_mfma_f32_16x16x32_bf16 a[24:27], a[152:155], v[32:35], a[24:27]
    s_waitcnt lgkmcnt(3)
    v_exp_f32 v31, v31
    v_mfma_f32_16x16x32_bf16 a[28:31], a[156:159], v[32:35], a[28:31]
    ds_read_b128 a[108:111], v5 offset:33536
    v_cvt_pk_bf16_f32 v39, v30, v31
    v_mfma_f32_16x16x32_bf16 a[224:227], a[248:251], v[32:35], a[224:227]
    s_waitcnt lgkmcnt(3)
    ds_read_b128 a[112:115], v5 offset:40960
    ds_read_b128 a[116:119], v5 offset:41216
    v_mfma_f32_16x16x32_bf16 v[24:27], a[96:99], a[160:163], 0
    s_waitcnt lgkmcnt(4)
    v_exp_f32 v16, v16
    v_mfma_f32_16x16x32_bf16 v[24:27], a[100:103], a[164:167], v[24:27]
    s_waitcnt lgkmcnt(3)
    ds_read_b128 a[120:123], v5 offset:41472
    ds_read_b128 a[124:127], v5 offset:41728
    v_mfma_f32_16x16x32_bf16 v[24:27], a[104:107], a[168:171], v[24:27]
    s_waitcnt lgkmcnt(4)
    v_exp_f32 v17, v17
    v_mfma_f32_16x16x32_bf16 v[24:27], a[108:111], a[172:175], v[24:27]
    s_waitcnt lgkmcnt(3)
    v_cvt_pk_bf16_f32 v32, v16, v17
    v_cvt_pk_bf16_f32 v202, v204, v205
    v_mfma_f32_16x16x32_bf16 v[28:31], a[112:115], a[160:163], 0
    s_waitcnt lgkmcnt(2)
    v_exp_f32 v18, v18
    v_mfma_f32_16x16x32_bf16 v[28:31], a[116:119], a[164:167], v[28:31]
    s_waitcnt lgkmcnt(1)
    buffer_load_dwordx4 v3, s[24:27], s61 offen offset:2048  lds
    v_mfma_f32_16x16x32_bf16 v[28:31], a[120:123], a[168:171], v[28:31]
    s_waitcnt lgkmcnt(0)
    v_exp_f32 v19, v19
    v_mfma_f32_16x16x32_bf16 v[28:31], a[124:127], a[172:175], v[28:31]
    v_cvt_pk_bf16_f32 v33, v18, v19
    v_cvt_pk_bf16_f32 v203, v206, v207
    v_mfma_f32_16x16x32_bf16 a[32:35], a[128:131], v[36:39], a[32:35]
    v_exp_f32 v20, v20
    v_mfma_f32_16x16x32_bf16 a[36:39], a[132:135], v[36:39], a[36:39]
    buffer_store_dwordx4 v[200:203], v1, s[28:31], s48 offen offset:64 sc1
    v_mfma_f32_16x16x32_bf16 a[40:43], a[136:139], v[36:39], a[40:43]
    v_exp_f32 v21, v21
    v_mfma_f32_16x16x32_bf16 a[44:47], a[140:143], v[36:39], a[44:47]
    v_cvt_pk_bf16_f32 v34, v20, v21
    v_mul_f32 v208, v14, v208
    v_mfma_f32_16x16x32_bf16 a[48:51], a[144:147], v[36:39], a[48:51]
    v_exp_f32 v22, v22
    v_mfma_f32_16x16x32_bf16 a[52:55], a[148:151], v[36:39], a[52:55]
    buffer_load_dwordx4 v3, s[24:27], s61 offen offset:3072  lds
    v_mfma_f32_16x16x32_bf16 a[56:59], a[152:155], v[36:39], a[56:59]
    v_exp_f32 v23, v23
    v_mfma_f32_16x16x32_bf16 a[60:63], a[156:159], v[36:39], a[60:63]
    s_waitcnt vmcnt(11)
    v_cvt_pk_bf16_f32 v35, v22, v23
    v_mul_f32 v209, v14, v209
    v_mfma_f32_16x16x32_bf16 a[228:231], a[248:251], v[36:39], a[228:231]
    s_barrier
    v_mfma_f32_16x16x32_bf16 v[16:19], a[96:99], a[176:179], 0
    v_exp_f32 v24, v24
    v_mfma_f32_16x16x32_bf16 v[16:19], a[100:103], a[180:183], v[16:19]
    v_mul_f32 v210, v14, v210
    v_mul_f32 v211, v14, v211
    v_mfma_f32_16x16x32_bf16 v[16:19], a[104:107], a[184:187], v[16:19]
    v_exp_f32 v25, v25
    v_mfma_f32_16x16x32_bf16 v[16:19], a[108:111], a[188:191], v[16:19]
    v_cvt_pk_bf16_f32 v36, v24, v25
    v_mul_f32 v212, v14, v212
    v_mfma_f32_16x16x32_bf16 v[20:23], a[112:115], a[176:179], 0
    v_exp_f32 v26, v26
    v_mfma_f32_16x16x32_bf16 v[20:23], a[116:119], a[180:183], v[20:23]
    v_mul_f32 v213, v14, v213
    v_mul_f32 v214, v14, v214
    v_mul_f32 v215, v14, v215
    v_mfma_f32_16x16x32_bf16 v[20:23], a[120:123], a[184:187], v[20:23]
    v_exp_f32 v27, v27
    v_mfma_f32_16x16x32_bf16 v[20:23], a[124:127], a[188:191], v[20:23]
    v_cvt_pk_bf16_f32 v37, v26, v27
    v_cvt_pk_bf16_f32 v208, v208, v209
    v_mfma_f32_16x16x32_bf16 v[64:67], a[128:131], v[32:35], v[64:67]
    v_exp_f32 v28, v28
    v_mfma_f32_16x16x32_bf16 v[68:71], a[132:135], v[32:35], v[68:71]
    ds_read_b64_tr_b16 a[128:129], v8 offset:32768
    ds_read_b64_tr_b16 a[130:131], v8 offset:40960
    v_mfma_f32_16x16x32_bf16 v[72:75], a[136:139], v[32:35], v[72:75]
    v_exp_f32 v29, v29
    v_mfma_f32_16x16x32_bf16 v[76:79], a[140:143], v[32:35], v[76:79]
    ds_read_b64_tr_b16 a[132:133], v8 offset:32776
    v_cvt_pk_bf16_f32 v38, v28, v29
    v_mfma_f32_16x16x32_bf16 v[80:83], a[144:147], v[32:35], v[80:83]
    v_exp_f32 v30, v30
    v_mfma_f32_16x16x32_bf16 v[84:87], a[148:151], v[32:35], v[84:87]
    ds_read_b64_tr_b16 a[134:135], v8 offset:40968
    ds_read_b64_tr_b16 a[136:137], v8 offset:33024
    v_mfma_f32_16x16x32_bf16 v[88:91], a[152:155], v[32:35], v[88:91]
    v_exp_f32 v31, v31
    v_mfma_f32_16x16x32_bf16 v[92:95], a[156:159], v[32:35], v[92:95]
    ds_read_b64_tr_b16 a[138:139], v8 offset:41216
    v_cvt_pk_bf16_f32 v39, v30, v31
    v_mfma_f32_16x16x32_bf16 a[232:235], a[248:251], v[32:35], a[232:235]
    ds_read_b64_tr_b16 a[140:141], v8 offset:33032
    ds_read_b64_tr_b16 a[142:143], v8 offset:41224
    v_mfma_f32_16x16x32_bf16 v[24:27], a[96:99], a[192:195], 0
    v_exp_f32 v16, v16
    v_mfma_f32_16x16x32_bf16 v[24:27], a[100:103], a[196:199], v[24:27]
    ds_read_b64_tr_b16 a[144:145], v8 offset:33280
    ds_read_b64_tr_b16 a[146:147], v8 offset:41472
    v_mfma_f32_16x16x32_bf16 v[24:27], a[104:107], a[200:203], v[24:27]
    v_exp_f32 v17, v17
    v_mfma_f32_16x16x32_bf16 v[24:27], a[108:111], a[204:207], v[24:27]
    ds_read_b64_tr_b16 a[148:149], v8 offset:33288
    v_cvt_pk_bf16_f32 v32, v16, v17
    v_mfma_f32_16x16x32_bf16 v[28:31], a[112:115], a[192:195], 0
    v_exp_f32 v18, v18
    v_mfma_f32_16x16x32_bf16 v[28:31], a[116:119], a[196:199], v[28:31]
    ds_read_b64_tr_b16 a[150:151], v8 offset:41480
    ds_read_b64_tr_b16 a[152:153], v8 offset:33536
    v_mfma_f32_16x16x32_bf16 v[28:31], a[120:123], a[200:203], v[28:31]
    v_exp_f32 v19, v19
    v_mfma_f32_16x16x32_bf16 v[28:31], a[124:127], a[204:207], v[28:31]
    s_waitcnt lgkmcnt(11)
    ds_read_b64_tr_b16 a[154:155], v8 offset:41728
    v_cvt_pk_bf16_f32 v33, v18, v19
    v_mfma_f32_16x16x32_bf16 a[0:3], a[128:131], v[36:39], a[0:3]
    s_waitcnt lgkmcnt(10)
    v_exp_f32 v20, v20
    v_mfma_f32_16x16x32_bf16 a[4:7], a[132:135], v[36:39], a[4:7]
    s_waitcnt lgkmcnt(8)
    ds_read_b64_tr_b16 a[156:157], v8 offset:33544
    ds_read_b64_tr_b16 a[158:159], v8 offset:41736
    v_mfma_f32_16x16x32_bf16 a[8:11], a[136:139], v[36:39], a[8:11]
    s_waitcnt lgkmcnt(8)
    v_exp_f32 v21, v21
    v_mfma_f32_16x16x32_bf16 a[12:15], a[140:143], v[36:39], a[12:15]
    s_waitcnt lgkmcnt(6)
    v_cvt_pk_bf16_f32 v34, v20, v21
    v_cvt_pk_bf16_f32 v209, v210, v211
    v_mfma_f32_16x16x32_bf16 a[16:19], a[144:147], v[36:39], a[16:19]
    s_waitcnt lgkmcnt(4)
    v_exp_f32 v22, v22
    v_mfma_f32_16x16x32_bf16 a[20:23], a[148:151], v[36:39], a[20:23]
    s_waitcnt lgkmcnt(2)
    v_cvt_pk_bf16_f32 v210, v212, v213
    v_cvt_pk_bf16_f32 v211, v214, v215
    v_mfma_f32_16x16x32_bf16 a[24:27], a[152:155], v[36:39], a[24:27]
    s_waitcnt lgkmcnt(0)
    v_exp_f32 v23, v23
    v_mfma_f32_16x16x32_bf16 a[28:31], a[156:159], v[36:39], a[28:31]
    v_cvt_pk_bf16_f32 v35, v22, v23
    v_mfma_f32_16x16x32_bf16 a[224:227], a[248:251], v[36:39], a[224:227]
    buffer_store_dwordx4 v[208:211], v1, s[28:31], s48 offen offset:128 sc1
    v_mfma_f32_16x16x32_bf16 v[16:19], a[96:99], a[208:211], 0
    v_exp_f32 v24, v24
    v_mfma_f32_16x16x32_bf16 v[16:19], a[100:103], a[212:215], v[16:19]
    ds_read_b128 a[96:99], v44 offset:32768
    ds_read_b128 a[100:103], v44 offset:33024
    v_mfma_f32_16x16x32_bf16 v[16:19], a[104:107], a[216:219], v[16:19]
    v_exp_f32 v25, v25
    v_mul_f32 v216, v14, v216
    v_mfma_f32_16x16x32_bf16 v[16:19], a[108:111], a[220:223], v[16:19]
    ds_read_b128 a[104:107], v44 offset:33280
    v_cvt_pk_bf16_f32 v36, v24, v25
    v_mfma_f32_16x16x32_bf16 v[20:23], a[112:115], a[208:211], 0
    v_exp_f32 v26, v26
    v_mfma_f32_16x16x32_bf16 v[20:23], a[116:119], a[212:215], v[20:23]
    ds_read_b128 a[108:111], v44 offset:33536
    ds_read_b128 a[112:115], v44 offset:40960
    v_mfma_f32_16x16x32_bf16 v[20:23], a[120:123], a[216:219], v[20:23]
    v_exp_f32 v27, v27
    v_mfma_f32_16x16x32_bf16 v[20:23], a[124:127], a[220:223], v[20:23]
    ds_read_b128 a[116:119], v44 offset:41216
    v_cvt_pk_bf16_f32 v37, v26, v27
    v_mfma_f32_16x16x32_bf16 a[32:35], a[128:131], v[32:35], a[32:35]
    v_exp_f32 v28, v28
    v_mfma_f32_16x16x32_bf16 a[36:39], a[132:135], v[32:35], a[36:39]
    ds_read_b128 a[120:123], v44 offset:41472
    ds_read_b128 a[124:127], v44 offset:41728
    v_mfma_f32_16x16x32_bf16 a[40:43], a[136:139], v[32:35], a[40:43]
    v_exp_f32 v29, v29
    v_mfma_f32_16x16x32_bf16 a[44:47], a[140:143], v[32:35], a[44:47]
    v_cvt_pk_bf16_f32 v38, v28, v29
    v_mul_f32 v217, v14, v217
    v_mfma_f32_16x16x32_bf16 a[48:51], a[144:147], v[32:35], a[48:51]
    v_exp_f32 v30, v30
    v_mfma_f32_16x16x32_bf16 a[52:55], a[148:151], v[32:35], a[52:55]
    v_mul_f32 v218, v14, v218
    v_mul_f32 v219, v14, v219
    v_mfma_f32_16x16x32_bf16 a[56:59], a[152:155], v[32:35], a[56:59]
    v_exp_f32 v31, v31
    v_mfma_f32_16x16x32_bf16 a[60:63], a[156:159], v[32:35], a[60:63]
    v_cvt_pk_bf16_f32 v39, v30, v31
    v_mul_f32 v220, v14, v220
    v_mfma_f32_16x16x32_bf16 a[228:231], a[248:251], v[32:35], a[228:231]
    s_waitcnt lgkmcnt(7)
    v_mul_f32 v221, v14, v221
    v_mul_f32 v222, v14, v222
    v_mfma_f32_16x16x32_bf16 v[24:27], a[96:99], a[160:163], 0
    s_waitcnt lgkmcnt(6)
    v_exp_f32 v16, v16
    v_mfma_f32_16x16x32_bf16 v[24:27], a[100:103], a[164:167], v[24:27]
    s_waitcnt lgkmcnt(5)
    v_mul_f32 v223, v14, v223
    v_cvt_pk_bf16_f32 v216, v216, v217
    v_mfma_f32_16x16x32_bf16 v[24:27], a[104:107], a[168:171], v[24:27]
    s_waitcnt lgkmcnt(4)
    v_exp_f32 v17, v17
    v_mfma_f32_16x16x32_bf16 v[24:27], a[108:111], a[172:175], v[24:27]
    s_waitcnt lgkmcnt(3)
    v_cvt_pk_bf16_f32 v32, v16, v17
    v_cvt_pk_bf16_f32 v217, v218, v219
    v_mfma_f32_16x16x32_bf16 v[28:31], a[112:115], a[160:163], 0
    s_waitcnt lgkmcnt(2)
    v_exp_f32 v18, v18
    v_mfma_f32_16x16x32_bf16 v[28:31], a[116:119], a[164:167], v[28:31]
    s_waitcnt lgkmcnt(1)
    v_cvt_pk_bf16_f32 v218, v220, v221
    v_cvt_pk_bf16_f32 v219, v222, v223
    v_mfma_f32_16x16x32_bf16 v[28:31], a[120:123], a[168:171], v[28:31]
    s_waitcnt lgkmcnt(0)
    v_exp_f32 v19, v19
    v_mfma_f32_16x16x32_bf16 v[28:31], a[124:127], a[172:175], v[28:31]
    v_cvt_pk_bf16_f32 v33, v18, v19
    v_mfma_f32_16x16x32_bf16 v[64:67], a[128:131], v[36:39], v[64:67]
    v_exp_f32 v20, v20
    v_mfma_f32_16x16x32_bf16 v[68:71], a[132:135], v[36:39], v[68:71]
    buffer_store_dwordx4 v[216:219], v1, s[28:31], s48 offen offset:192 sc1
    v_mfma_f32_16x16x32_bf16 v[72:75], a[136:139], v[36:39], v[72:75]
    v_exp_f32 v21, v21
    v_mfma_f32_16x16x32_bf16 v[76:79], a[140:143], v[36:39], v[76:79]
    v_cvt_pk_bf16_f32 v34, v20, v21
    v_subrev_u32 v42, s38, v15
    v_mfma_f32_16x16x32_bf16 v[80:83], a[144:147], v[36:39], v[80:83]
    v_exp_f32 v22, v22
    v_mfma_f32_16x16x32_bf16 v[84:87], a[148:151], v[36:39], v[84:87]
    v_cmp_lt_u32 vcc, s39, v42
    v_mfma_f32_16x16x32_bf16 v[88:91], a[152:155], v[36:39], v[88:91]
    v_exp_f32 v23, v23
    v_mfma_f32_16x16x32_bf16 v[92:95], a[156:159], v[36:39], v[92:95]
    v_cvt_pk_bf16_f32 v35, v22, v23
    v_rcp_f32 v15, v15
    v_mfma_f32_16x16x32_bf16 a[232:235], a[248:251], v[36:39], a[232:235]
    s_or_b64 s[40:41], s[40:41], vcc
    v_mul_f32 v224, v15, v224
    v_mul_f32 v225, v15, v225
    v_mfma_f32_16x16x32_bf16 v[16:19], a[96:99], a[176:179], 0
    v_exp_f32 v24, v24
    v_mfma_f32_16x16x32_bf16 v[16:19], a[100:103], a[180:183], v[16:19]
    v_mul_f32 v226, v15, v226
    v_mul_f32 v227, v15, v227
    v_mfma_f32_16x16x32_bf16 v[16:19], a[104:107], a[184:187], v[16:19]
    v_exp_f32 v25, v25
    v_mfma_f32_16x16x32_bf16 v[16:19], a[108:111], a[188:191], v[16:19]
    v_cvt_pk_bf16_f32 v36, v24, v25
    v_mul_f32 v228, v15, v228
    v_mfma_f32_16x16x32_bf16 v[20:23], a[112:115], a[176:179], 0
    v_exp_f32 v26, v26
    v_mfma_f32_16x16x32_bf16 v[20:23], a[116:119], a[180:183], v[20:23]
    v_mul_f32 v229, v15, v229
    v_mul_f32 v230, v15, v230
    v_mfma_f32_16x16x32_bf16 v[20:23], a[120:123], a[184:187], v[20:23]
    v_exp_f32 v27, v27
    v_mfma_f32_16x16x32_bf16 v[20:23], a[124:127], a[188:191], v[20:23]
    v_cvt_pk_bf16_f32 v37, v26, v27
    v_mul_f32 v231, v15, v231
    v_mfma_f32_16x16x32_bf16 v[96:99], a[128:131], v[32:35], v[96:99]
    v_exp_f32 v28, v28
    v_mfma_f32_16x16x32_bf16 v[100:103], a[132:135], v[32:35], v[100:103]
    ds_read_b64_tr_b16 a[128:129], v47 offset:32768
    ds_read_b64_tr_b16 a[130:131], v47 offset:40960
    v_mfma_f32_16x16x32_bf16 v[104:107], a[136:139], v[32:35], v[104:107]
    v_exp_f32 v29, v29
    v_mfma_f32_16x16x32_bf16 v[108:111], a[140:143], v[32:35], v[108:111]
    ds_read_b64_tr_b16 a[132:133], v47 offset:32776
    v_cvt_pk_bf16_f32 v38, v28, v29
    v_mfma_f32_16x16x32_bf16 v[112:115], a[144:147], v[32:35], v[112:115]
    v_exp_f32 v30, v30
    v_mfma_f32_16x16x32_bf16 v[116:119], a[148:151], v[32:35], v[116:119]
    ds_read_b64_tr_b16 a[134:135], v47 offset:40968
    ds_read_b64_tr_b16 a[136:137], v47 offset:33024
    v_mfma_f32_16x16x32_bf16 v[120:123], a[152:155], v[32:35], v[120:123]
    v_exp_f32 v31, v31
    v_mfma_f32_16x16x32_bf16 v[124:127], a[156:159], v[32:35], v[124:127]
    ds_read_b64_tr_b16 a[138:139], v47 offset:41216
    v_cvt_pk_bf16_f32 v39, v30, v31
    v_mfma_f32_16x16x32_bf16 a[236:239], a[248:251], v[32:35], a[236:239]
    ds_read_b64_tr_b16 a[140:141], v47 offset:33032
    ds_read_b64_tr_b16 a[142:143], v47 offset:41224
    v_mfma_f32_16x16x32_bf16 v[24:27], a[96:99], a[192:195], 0
    v_exp_f32 v16, v16
    v_mfma_f32_16x16x32_bf16 v[24:27], a[100:103], a[196:199], v[24:27]
    ds_read_b64_tr_b16 a[144:145], v47 offset:33280
    ds_read_b64_tr_b16 a[146:147], v47 offset:41472
    v_mfma_f32_16x16x32_bf16 v[24:27], a[104:107], a[200:203], v[24:27]
    v_exp_f32 v17, v17
    v_mfma_f32_16x16x32_bf16 v[24:27], a[108:111], a[204:207], v[24:27]
    ds_read_b64_tr_b16 a[148:149], v47 offset:33288
    v_cvt_pk_bf16_f32 v32, v16, v17
    v_mfma_f32_16x16x32_bf16 v[28:31], a[112:115], a[192:195], 0
    v_exp_f32 v18, v18
    v_mfma_f32_16x16x32_bf16 v[28:31], a[116:119], a[196:199], v[28:31]
    ds_read_b64_tr_b16 a[150:151], v47 offset:41480
    ds_read_b64_tr_b16 a[152:153], v47 offset:33536
    v_mfma_f32_16x16x32_bf16 v[28:31], a[120:123], a[200:203], v[28:31]
    v_exp_f32 v19, v19
    v_mfma_f32_16x16x32_bf16 v[28:31], a[124:127], a[204:207], v[28:31]
    s_waitcnt lgkmcnt(11)
    ds_read_b64_tr_b16 a[154:155], v47 offset:41728
    v_cvt_pk_bf16_f32 v33, v18, v19
    v_mfma_f32_16x16x32_bf16 a[0:3], a[128:131], v[36:39], a[0:3]
    s_waitcnt lgkmcnt(10)
    v_exp_f32 v20, v20
    v_mfma_f32_16x16x32_bf16 a[4:7], a[132:135], v[36:39], a[4:7]
    s_waitcnt lgkmcnt(8)
    ds_read_b64_tr_b16 a[156:157], v47 offset:33544
    ds_read_b64_tr_b16 a[158:159], v47 offset:41736
    v_mfma_f32_16x16x32_bf16 a[8:11], a[136:139], v[36:39], a[8:11]
    s_waitcnt lgkmcnt(8)
    v_exp_f32 v21, v21
    v_mfma_f32_16x16x32_bf16 a[12:15], a[140:143], v[36:39], a[12:15]
    s_waitcnt lgkmcnt(6)
    ds_read_b128 a[96:99], v6 offset:0
    v_cvt_pk_bf16_f32 v34, v20, v21
    v_mfma_f32_16x16x32_bf16 a[16:19], a[144:147], v[36:39], a[16:19]
    s_waitcnt lgkmcnt(5)
    v_exp_f32 v22, v22
    v_cvt_pk_bf16_f32 v224, v224, v225
    v_mfma_f32_16x16x32_bf16 a[20:23], a[148:151], v[36:39], a[20:23]
    s_waitcnt lgkmcnt(3)
    ds_read_b128 a[100:103], v6 offset:256
    ds_read_b128 a[104:107], v6 offset:512
    v_mfma_f32_16x16x32_bf16 a[24:27], a[152:155], v[36:39], a[24:27]
    s_waitcnt lgkmcnt(3)
    v_exp_f32 v23, v23
    v_mfma_f32_16x16x32_bf16 a[28:31], a[156:159], v[36:39], a[28:31]
    ds_read_b128 a[108:111], v6 offset:768
    v_cvt_pk_bf16_f32 v35, v22, v23
    v_mfma_f32_16x16x32_bf16 a[224:227], a[248:251], v[36:39], a[224:227]
    s_waitcnt lgkmcnt(3)
    ds_read_b128 a[112:115], v6 offset:8192
    ds_read_b128 a[116:119], v6 offset:8448
    v_mfma_f32_16x16x32_bf16 v[16:19], a[96:99], a[160:163], 0
    s_waitcnt lgkmcnt(4)
    v_exp_f32 v24, v24
    v_mfma_f32_16x16x32_bf16 v[16:19], a[100:103], a[164:167], v[16:19]
    s_waitcnt lgkmcnt(3)
    ds_read_b128 a[120:123], v6 offset:8704
    ds_read_b128 a[124:127], v6 offset:8960
    v_mfma_f32_16x16x32_bf16 v[16:19], a[104:107], a[168:171], v[16:19]
    s_waitcnt lgkmcnt(4)
    v_exp_f32 v25, v25
    v_mfma_f32_16x16x32_bf16 v[16:19], a[108:111], a[172:175], v[16:19]
    s_waitcnt lgkmcnt(3)
    v_cvt_pk_bf16_f32 v36, v24, v25
    v_cvt_pk_bf16_f32 v225, v226, v227
    v_mfma_f32_16x16x32_bf16 v[20:23], a[112:115], a[160:163], 0
    s_waitcnt lgkmcnt(2)
    v_exp_f32 v26, v26
    v_mfma_f32_16x16x32_bf16 v[20:23], a[116:119], a[164:167], v[20:23]
    s_waitcnt lgkmcnt(1)
    v_cvt_pk_bf16_f32 v226, v228, v229
    v_cvt_pk_bf16_f32 v227, v230, v231
    v_mfma_f32_16x16x32_bf16 v[20:23], a[120:123], a[168:171], v[20:23]
    s_waitcnt lgkmcnt(0)
    v_exp_f32 v27, v27
    v_mfma_f32_16x16x32_bf16 v[20:23], a[124:127], a[172:175], v[20:23]
    v_cvt_pk_bf16_f32 v37, v26, v27
    v_mfma_f32_16x16x32_bf16 a[32:35], a[128:131], v[32:35], a[32:35]
    v_exp_f32 v28, v28
    v_mfma_f32_16x16x32_bf16 a[36:39], a[132:135], v[32:35], a[36:39]
    buffer_store_dwordx4 v[224:227], v1, s[28:31], s49 offen offset:0 sc1
    v_mfma_f32_16x16x32_bf16 a[40:43], a[136:139], v[32:35], a[40:43]
    v_exp_f32 v29, v29
    v_mfma_f32_16x16x32_bf16 a[44:47], a[140:143], v[32:35], a[44:47]
    v_cvt_pk_bf16_f32 v38, v28, v29
    v_mul_f32 v232, v15, v232
    v_mfma_f32_16x16x32_bf16 a[48:51], a[144:147], v[32:35], a[48:51]
    v_exp_f32 v30, v30
    v_mfma_f32_16x16x32_bf16 a[52:55], a[148:151], v[32:35], a[52:55]
    v_mul_f32 v233, v15, v233
    v_mul_f32 v234, v15, v234
    v_mfma_f32_16x16x32_bf16 a[56:59], a[152:155], v[32:35], a[56:59]
    v_exp_f32 v31, v31
    v_mfma_f32_16x16x32_bf16 a[60:63], a[156:159], v[32:35], a[60:63]
    s_waitcnt vmcnt(3)
    v_cvt_pk_bf16_f32 v39, v30, v31
    v_mul_f32 v235, v15, v235
    v_mfma_f32_16x16x32_bf16 a[228:231], a[248:251], v[32:35], a[228:231]
    s_barrier
    v_mfma_f32_16x16x32_bf16 v[24:27], a[96:99], a[176:179], 0
    v_exp_f32 v16, v16
    v_mfma_f32_16x16x32_bf16 v[24:27], a[100:103], a[180:183], v[24:27]
    v_mul_f32 v236, v15, v236
    v_mul_f32 v237, v15, v237
    v_mfma_f32_16x16x32_bf16 v[24:27], a[104:107], a[184:187], v[24:27]
    v_exp_f32 v17, v17
    v_mfma_f32_16x16x32_bf16 v[24:27], a[108:111], a[188:191], v[24:27]
    v_cvt_pk_bf16_f32 v32, v16, v17
    v_mul_f32 v238, v15, v238
    v_mfma_f32_16x16x32_bf16 v[28:31], a[112:115], a[176:179], 0
    v_exp_f32 v18, v18
    v_mfma_f32_16x16x32_bf16 v[28:31], a[116:119], a[180:183], v[28:31]
    v_mul_f32 v239, v15, v239
    v_cvt_pk_bf16_f32 v232, v232, v233
    v_mfma_f32_16x16x32_bf16 v[28:31], a[120:123], a[184:187], v[28:31]
    v_exp_f32 v19, v19
    v_mfma_f32_16x16x32_bf16 v[28:31], a[124:127], a[188:191], v[28:31]
    v_cvt_pk_bf16_f32 v33, v18, v19
    v_cvt_pk_bf16_f32 v233, v234, v235
    v_mfma_f32_16x16x32_bf16 v[64:67], a[128:131], v[36:39], v[64:67]
    v_exp_f32 v20, v20
    v_mfma_f32_16x16x32_bf16 v[68:71], a[132:135], v[36:39], v[68:71]
    ds_read_b64_tr_b16 a[128:129], v9 offset:0
    ds_read_b64_tr_b16 a[130:131], v9 offset:8192
    v_mfma_f32_16x16x32_bf16 v[72:75], a[136:139], v[36:39], v[72:75]
    v_exp_f32 v21, v21
    v_cvt_pk_bf16_f32 v234, v236, v237
    v_mfma_f32_16x16x32_bf16 v[76:79], a[140:143], v[36:39], v[76:79]
    ds_read_b64_tr_b16 a[132:133], v9 offset:8
    v_cvt_pk_bf16_f32 v34, v20, v21
    v_mfma_f32_16x16x32_bf16 v[80:83], a[144:147], v[36:39], v[80:83]
    v_exp_f32 v22, v22
    v_mfma_f32_16x16x32_bf16 v[84:87], a[148:151], v[36:39], v[84:87]
    ds_read_b64_tr_b16 a[134:135], v9 offset:8200
    ds_read_b64_tr_b16 a[136:137], v9 offset:256
    v_mfma_f32_16x16x32_bf16 v[88:91], a[152:155], v[36:39], v[88:91]
    v_exp_f32 v23, v23
    v_mfma_f32_16x16x32_bf16 v[92:95], a[156:159], v[36:39], v[92:95]
    ds_read_b64_tr_b16 a[138:139], v9 offset:8448
    v_cvt_pk_bf16_f32 v35, v22, v23
    v_mfma_f32_16x16x32_bf16 a[232:235], a[248:251], v[36:39], a[232:235]
    ds_read_b64_tr_b16 a[140:141], v9 offset:264
    ds_read_b64_tr_b16 a[142:143], v9 offset:8456
    v_mfma_f32_16x16x32_bf16 v[16:19], a[96:99], a[208:211], 0
    v_exp_f32 v24, v24
    v_mfma_f32_16x16x32_bf16 v[16:19], a[100:103], a[212:215], v[16:19]
    ds_read_b64_tr_b16 a[144:145], v9 offset:512
    ds_read_b64_tr_b16 a[146:147], v9 offset:8704
    v_mfma_f32_16x16x32_bf16 v[16:19], a[104:107], a[216:219], v[16:19]
    v_exp_f32 v25, v25
    v_mfma_f32_16x16x32_bf16 v[16:19], a[108:111], a[220:223], v[16:19]
    ds_read_b64_tr_b16 a[148:149], v9 offset:520
    v_cvt_pk_bf16_f32 v36, v24, v25
    v_mfma_f32_16x16x32_bf16 v[20:23], a[112:115], a[208:211], 0
    v_exp_f32 v26, v26
    v_mfma_f32_16x16x32_bf16 v[20:23], a[116:119], a[212:215], v[20:23]
    ds_read_b64_tr_b16 a[150:151], v9 offset:8712
    ds_read_b64_tr_b16 a[152:153], v9 offset:768
    v_mfma_f32_16x16x32_bf16 v[20:23], a[120:123], a[216:219], v[20:23]
    v_exp_f32 v27, v27
    v_mfma_f32_16x16x32_bf16 v[20:23], a[124:127], a[220:223], v[20:23]
    s_waitcnt lgkmcnt(11)
    ds_read_b64_tr_b16 a[154:155], v9 offset:8960
    v_cvt_pk_bf16_f32 v37, v26, v27
    v_mfma_f32_16x16x32_bf16 a[0:3], a[128:131], v[32:35], a[0:3]
    s_waitcnt lgkmcnt(10)
    v_exp_f32 v28, v28
    v_mfma_f32_16x16x32_bf16 a[4:7], a[132:135], v[32:35], a[4:7]
    s_waitcnt lgkmcnt(8)
    ds_read_b64_tr_b16 a[156:157], v9 offset:776
    ds_read_b64_tr_b16 a[158:159], v9 offset:8968
    v_mfma_f32_16x16x32_bf16 a[8:11], a[136:139], v[32:35], a[8:11]
    s_waitcnt lgkmcnt(8)
    v_exp_f32 v29, v29
    v_mfma_f32_16x16x32_bf16 a[12:15], a[140:143], v[32:35], a[12:15]
    s_waitcnt lgkmcnt(6)
    ds_read_b128 a[96:99], v4 offset:0
    v_cvt_pk_bf16_f32 v38, v28, v29
    v_mfma_f32_16x16x32_bf16 a[16:19], a[144:147], v[32:35], a[16:19]
    s_waitcnt lgkmcnt(5)
    v_exp_f32 v30, v30
    v_mfma_f32_16x16x32_bf16 a[20:23], a[148:151], v[32:35], a[20:23]
    s_waitcnt lgkmcnt(3)
    ds_read_b128 a[100:103], v4 offset:256
    ds_read_b128 a[104:107], v4 offset:512
    v_mfma_f32_16x16x32_bf16 a[24:27], a[152:155], v[32:35], a[24:27]
    s_waitcnt lgkmcnt(3)
    v_exp_f32 v31, v31
    v_mfma_f32_16x16x32_bf16 a[28:31], a[156:159], v[32:35], a[28:31]
    ds_read_b128 a[108:111], v4 offset:768
    v_cvt_pk_bf16_f32 v39, v30, v31
    v_mfma_f32_16x16x32_bf16 a[224:227], a[248:251], v[32:35], a[224:227]
    s_waitcnt lgkmcnt(3)
    ds_read_b128 a[112:115], v4 offset:8192
    ds_read_b128 a[116:119], v4 offset:8448
    v_mfma_f32_16x16x32_bf16 v[24:27], a[96:99], a[208:211], 0
    s_waitcnt lgkmcnt(4)
    v_exp_f32 v16, v16
    v_mfma_f32_16x16x32_bf16 v[24:27], a[100:103], a[212:215], v[24:27]
    s_waitcnt lgkmcnt(3)
    ds_read_b128 a[120:123], v4 offset:8704
    ds_read_b128 a[124:127], v4 offset:8960
    v_mfma_f32_16x16x32_bf16 v[24:27], a[104:107], a[216:219], v[24:27]
    s_waitcnt lgkmcnt(4)
    v_exp_f32 v17, v17
    v_mfma_f32_16x16x32_bf16 v[24:27], a[108:111], a[220:223], v[24:27]
    s_waitcnt lgkmcnt(3)
    v_cvt_pk_bf16_f32 v32, v16, v17
    v_cvt_pk_bf16_f32 v235, v238, v239
    v_mfma_f32_16x16x32_bf16 v[28:31], a[112:115], a[208:211], 0
    s_waitcnt lgkmcnt(2)
    v_exp_f32 v18, v18
    v_mfma_f32_16x16x32_bf16 v[28:31], a[116:119], a[212:215], v[28:31]
    s_waitcnt lgkmcnt(1)
    buffer_store_dwordx4 v[232:235], v1, s[28:31], s49 offen offset:64 sc1
    v_mfma_f32_16x16x32_bf16 v[28:31], a[120:123], a[216:219], v[28:31]
    s_waitcnt lgkmcnt(0)
    v_exp_f32 v19, v19
    v_mul_f32 v240, v15, v240
    v_mfma_f32_16x16x32_bf16 v[28:31], a[124:127], a[220:223], v[28:31]
    v_cvt_pk_bf16_f32 v33, v18, v19
    v_mul_f32 v241, v15, v241
    v_mfma_f32_16x16x32_bf16 a[32:35], a[128:131], v[36:39], a[32:35]
    v_exp_f32 v20, v20
    v_mfma_f32_16x16x32_bf16 a[36:39], a[132:135], v[36:39], a[36:39]
    v_mul_f32 v242, v15, v242
    v_mul_f32 v243, v15, v243
    v_mfma_f32_16x16x32_bf16 a[40:43], a[136:139], v[36:39], a[40:43]
    v_exp_f32 v21, v21
    v_mfma_f32_16x16x32_bf16 a[44:47], a[140:143], v[36:39], a[44:47]
    v_cvt_pk_bf16_f32 v34, v20, v21
    v_mul_f32 v244, v15, v244
    v_mfma_f32_16x16x32_bf16 a[48:51], a[144:147], v[36:39], a[48:51]
    v_exp_f32 v22, v22
    v_mfma_f32_16x16x32_bf16 a[52:55], a[148:151], v[36:39], a[52:55]
    v_mul_f32 v245, v15, v245
    v_mul_f32 v246, v15, v246
    v_mfma_f32_16x16x32_bf16 a[56:59], a[152:155], v[36:39], a[56:59]
    v_exp_f32 v23, v23
    v_mfma_f32_16x16x32_bf16 a[60:63], a[156:159], v[36:39], a[60:63]
    v_cvt_pk_bf16_f32 v35, v22, v23
    v_mul_f32 v247, v15, v247
    v_mfma_f32_16x16x32_bf16 a[228:231], a[248:251], v[36:39], a[228:231]
    v_cvt_pk_bf16_f32 v240, v240, v241
    v_cvt_pk_bf16_f32 v241, v242, v243
    v_mfma_f32_16x16x32_bf16 v[16:19], a[96:99], a[160:163], 0
    v_exp_f32 v24, v24
    v_mfma_f32_16x16x32_bf16 v[16:19], a[100:103], a[164:167], v[16:19]
    v_cvt_pk_bf16_f32 v242, v244, v245
    v_cvt_pk_bf16_f32 v243, v246, v247
    v_mfma_f32_16x16x32_bf16 v[16:19], a[104:107], a[168:171], v[16:19]
    v_exp_f32 v25, v25
    v_mfma_f32_16x16x32_bf16 v[16:19], a[108:111], a[172:175], v[16:19]
    v_cvt_pk_bf16_f32 v36, v24, v25
    v_mfma_f32_16x16x32_bf16 v[20:23], a[112:115], a[160:163], 0
    v_exp_f32 v26, v26
    v_mfma_f32_16x16x32_bf16 v[20:23], a[116:119], a[164:167], v[20:23]
    buffer_store_dwordx4 v[240:243], v1, s[28:31], s49 offen offset:128 sc1
    v_mfma_f32_16x16x32_bf16 v[20:23], a[120:123], a[168:171], v[20:23]
    v_exp_f32 v27, v27
    v_mfma_f32_16x16x32_bf16 v[20:23], a[124:127], a[172:175], v[20:23]
    v_cvt_pk_bf16_f32 v37, v26, v27
    v_mul_f32 v248, v15, v248
    v_mfma_f32_16x16x32_bf16 v[96:99], a[128:131], v[32:35], v[96:99]
    v_exp_f32 v28, v28
    v_mfma_f32_16x16x32_bf16 v[100:103], a[132:135], v[32:35], v[100:103]
    ds_read_b64_tr_b16 a[128:129], v7 offset:0
    ds_read_b64_tr_b16 a[130:131], v7 offset:8192
    v_mfma_f32_16x16x32_bf16 v[104:107], a[136:139], v[32:35], v[104:107]
    v_exp_f32 v29, v29
    v_mfma_f32_16x16x32_bf16 v[108:111], a[140:143], v[32:35], v[108:111]
    ds_read_b64_tr_b16 a[132:133], v7 offset:8
    v_cvt_pk_bf16_f32 v38, v28, v29
    v_mfma_f32_16x16x32_bf16 v[112:115], a[144:147], v[32:35], v[112:115]
    v_exp_f32 v30, v30
    v_mfma_f32_16x16x32_bf16 v[116:119], a[148:151], v[32:35], v[116:119]
    ds_read_b64_tr_b16 a[134:135], v7 offset:8200
    ds_read_b64_tr_b16 a[136:137], v7 offset:256
    v_mfma_f32_16x16x32_bf16 v[120:123], a[152:155], v[32:35], v[120:123]
    v_exp_f32 v31, v31
    v_mfma_f32_16x16x32_bf16 v[124:127], a[156:159], v[32:35], v[124:127]
    ds_read_b64_tr_b16 a[138:139], v7 offset:8448
    v_cvt_pk_bf16_f32 v39, v30, v31
    v_mfma_f32_16x16x32_bf16 a[236:239], a[248:251], v[32:35], a[236:239]
    ds_read_b64_tr_b16 a[140:141], v7 offset:264
    ds_read_b64_tr_b16 a[142:143], v7 offset:8456
    v_mfma_f32_16x16x32_bf16 v[24:27], a[96:99], a[176:179], 0
    v_exp_f32 v16, v16
    v_mfma_f32_16x16x32_bf16 v[24:27], a[100:103], a[180:183], v[24:27]
    ds_read_b64_tr_b16 a[144:145], v7 offset:512
    ds_read_b64_tr_b16 a[146:147], v7 offset:8704
    v_mfma_f32_16x16x32_bf16 v[24:27], a[104:107], a[184:187], v[24:27]
    v_exp_f32 v17, v17
    v_mfma_f32_16x16x32_bf16 v[24:27], a[108:111], a[188:191], v[24:27]
L_m10:
    s_cbranch_execz L_m11
    ds_read_b64_tr_b16 a[148:149], v7 offset:520
    v_cvt_pk_bf16_f32 v32, v16, v17
    v_mul_f32 v249, v15, v249
    v_mfma_f32_16x16x32_bf16 v[28:31], a[112:115], a[176:179], 0
    v_exp_f32 v18, v18
    v_mfma_f32_16x16x32_bf16 v[28:31], a[116:119], a[180:183], v[28:31]
    ds_read_b64_tr_b16 a[150:151], v7 offset:8712
    ds_read_b64_tr_b16 a[152:153], v7 offset:768
    v_mfma_f32_16x16x32_bf16 v[28:31], a[120:123], a[184:187], v[28:31]
    v_exp_f32 v19, v19
    v_mfma_f32_16x16x32_bf16 v[28:31], a[124:127], a[188:191], v[28:31]
    s_waitcnt lgkmcnt(11)
    ds_read_b64_tr_b16 a[154:155], v7 offset:8960
    v_cvt_pk_bf16_f32 v33, v18, v19
    v_mfma_f32_16x16x32_bf16 v[96:99], a[128:131], v[36:39], v[96:99]
    s_waitcnt lgkmcnt(10)
    v_exp_f32 v20, v20
    v_mfma_f32_16x16x32_bf16 v[100:103], a[132:135], v[36:39], v[100:103]
    s_waitcnt lgkmcnt(8)
    ds_read_b64_tr_b16 a[156:157], v7 offset:776
    ds_read_b64_tr_b16 a[158:159], v7 offset:8968
    v_mfma_f32_16x16x32_bf16 v[104:107], a[136:139], v[36:39], v[104:107]
    s_waitcnt lgkmcnt(8)
    v_exp_f32 v21, v21
    v_mfma_f32_16x16x32_bf16 v[108:111], a[140:143], v[36:39], v[108:111]
    s_waitcnt lgkmcnt(6)
    ds_read_b128 a[96:99], v45 offset:0
    v_cvt_pk_bf16_f32 v34, v20, v21
    v_mfma_f32_16x16x32_bf16 v[112:115], a[144:147], v[36:39], v[112:115]
    s_waitcnt lgkmcnt(5)
    v_exp_f32 v22, v22
    v_mfma_f32_16x16x32_bf16 v[116:119], a[148:151], v[36:39], v[116:119]
    s_waitcnt lgkmcnt(3)
    ds_read_b128 a[100:103], v45 offset:256
    ds_read_b128 a[104:107], v45 offset:512
    v_mfma_f32_16x16x32_bf16 v[120:123], a[152:155], v[36:39], v[120:123]
    s_waitcnt lgkmcnt(3)
    v_exp_f32 v23, v23
    v_mfma_f32_16x16x32_bf16 v[124:127], a[156:159], v[36:39], v[124:127]
    ds_read_b128 a[108:111], v45 offset:768
    v_cvt_pk_bf16_f32 v35, v22, v23
    v_mfma_f32_16x16x32_bf16 a[236:239], a[248:251], v[36:39], a[236:239]
    s_waitcnt lgkmcnt(3)
    ds_read_b128 a[112:115], v45 offset:8192
    ds_read_b128 a[116:119], v45 offset:8448
    v_mfma_f32_16x16x32_bf16 v[16:19], a[96:99], a[160:163], 0
    s_waitcnt lgkmcnt(4)
    v_exp_f32 v24, v24
    v_mfma_f32_16x16x32_bf16 v[16:19], a[100:103], a[164:167], v[16:19]
    s_waitcnt lgkmcnt(3)
    ds_read_b128 a[120:123], v45 offset:8704
    ds_read_b128 a[124:127], v45 offset:8960
    v_mfma_f32_16x16x32_bf16 v[16:19], a[104:107], a[168:171], v[16:19]
    s_waitcnt lgkmcnt(4)
    v_exp_f32 v25, v25
    v_mfma_f32_16x16x32_bf16 v[16:19], a[108:111], a[172:175], v[16:19]
    s_waitcnt lgkmcnt(3)
    v_cvt_pk_bf16_f32 v36, v24, v25
    v_mul_f32 v250, v15, v250
    ds_write_b128 v57, a[236:239] offset:4096
    s_cmp_lg_u32 s42, 0
    s_cbranch_scc1 L_snd_hi
    ds_write_b128 v57, v[112:115] offset:0
    ds_write_b128 v57, v[116:119] offset:1024
    ds_write_b128 v57, v[120:123] offset:2048
    ds_write_b128 v57, v[124:127] offset:3072
    s_branch L_snd_end
L_snd_hi:
    ds_write_b128 v57, v[96:99] offset:0
    ds_write_b128 v57, v[100:103] offset:1024
    ds_write_b128 v57, v[104:107] offset:2048
    ds_write_b128 v57, v[108:111] offset:3072
L_snd_end:
    v_mfma_f32_16x16x32_bf16 v[20:23], a[112:115], a[160:163], 0
    s_waitcnt lgkmcnt(7)
    v_exp_f32 v26, v26
    v_mfma_f32_16x16x32_bf16 v[20:23], a[116:119], a[164:167], v[20:23]
    s_waitcnt lgkmcnt(6)
    v_mul_f32 v251, v15, v251
    v_mul_f32 v252, v15, v252
    v_mfma_f32_16x16x32_bf16 v[20:23], a[120:123], a[168:171], v[20:23]
    s_waitcnt lgkmcnt(5)
    v_exp_f32 v27, v27
    v_mfma_f32_16x16x32_bf16 v[20:23], a[124:127], a[172:175], v[20:23]
    v_cvt_pk_bf16_f32 v37, v26, v27
    v_mul_f32 v253, v15, v253
    v_mfma_f32_16x16x32_bf16 a[0:3], a[128:131], v[32:35], a[0:3]
    v_exp_f32 v28, v28
    v_mfma_f32_16x16x32_bf16 a[4:7], a[132:135], v[32:35], a[4:7]
    v_mul_f32 v254, v15, v254
    v_mul_f32 v255, v15, v255
    v_mfma_f32_16x16x32_bf16 a[8:11], a[136:139], v[32:35], a[8:11]
    v_exp_f32 v29, v29
    v_mfma_f32_16x16x32_bf16 a[12:15], a[140:143], v[32:35], a[12:15]
    v_cvt_pk_bf16_f32 v38, v28, v29
    v_cvt_pk_bf16_f32 v248, v248, v249
    v_mfma_f32_16x16x32_bf16 a[16:19], a[144:147], v[32:35], a[16:19]
    v_exp_f32 v30, v30
    v_mfma_f32_16x16x32_bf16 a[20:23], a[148:151], v[32:35], a[20:23]
    v_cvt_pk_bf16_f32 v249, v250, v251
    v_cvt_pk_bf16_f32 v250, v252, v253
    v_mfma_f32_16x16x32_bf16 a[24:27], a[152:155], v[32:35], a[24:27]
    v_exp_f32 v31, v31
    v_mfma_f32_16x16x32_bf16 a[28:31], a[156:159], v[32:35], a[28:31]
    v_cvt_pk_bf16_f32 v39, v30, v31
    v_cvt_pk_bf16_f32 v251, v254, v255
    v_mfma_f32_16x16x32_bf16 a[224:227], a[248:251], v[32:35], a[224:227]
    buffer_store_dwordx4 v[248:251], v1, s[28:31], s49 offen offset:192 sc1
    v_mfma_f32_16x16x32_bf16 v[24:27], a[96:99], a[176:179], 0
    v_exp_f32 v16, v16
    v_mfma_f32_16x16x32_bf16 v[24:27], a[100:103], a[180:183], v[24:27]
    ds_read_b128 a[96:99], v43 offset:0
    ds_read_b128 a[100:103], v43 offset:256
    v_mfma_f32_16x16x32_bf16 v[24:27], a[104:107], a[184:187], v[24:27]
    v_exp_f32 v17, v17
    v_mfma_f32_16x16x32_bf16 v[24:27], a[108:111], a[188:191], v[24:27]
    ds_read_b128 a[104:107], v43 offset:512
    v_cvt_pk_bf16_f32 v32, v16, v17
    s_waitcnt lgkmcnt(3)
    s_barrier
    ds_read_b32 v41, v58 offset:4096
    s_cmp_lg_u32 s42, 0
    s_cbranch_scc1 L_rcv_hi
    ds_read_b128 v[112:115], v58 offset:0
    ds_read_b128 v[116:119], v58 offset:1024
    ds_read_b128 v[120:123], v58 offset:2048
    ds_read_b128 v[124:127], v58 offset:3072
    s_branch L_rcv_end
L_rcv_hi:
    ds_read_b128 v[96:99], v58 offset:0
    ds_read_b128 v[100:103], v58 offset:1024
    ds_read_b128 v[104:107], v58 offset:2048
    ds_read_b128 v[108:111], v58 offset:3072
L_rcv_end:
    v_mfma_f32_16x16x32_bf16 v[28:31], a[112:115], a[176:179], 0
    v_exp_f32 v18, v18
    v_mfma_f32_16x16x32_bf16 v[28:31], a[116:119], a[180:183], v[28:31]
    ds_read_b128 a[108:111], v43 offset:768
    ds_read_b128 a[112:115], v43 offset:8192
    v_mfma_f32_16x16x32_bf16 v[28:31], a[120:123], a[184:187], v[28:31]
    v_exp_f32 v19, v19
    v_mfma_f32_16x16x32_bf16 v[28:31], a[124:127], a[188:191], v[28:31]
    ds_read_b128 a[116:119], v43 offset:8448
    v_cvt_pk_bf16_f32 v33, v18, v19
    v_mfma_f32_16x16x32_bf16 a[32:35], a[128:131], v[36:39], a[32:35]
    v_exp_f32 v20, v20
    v_mfma_f32_16x16x32_bf16 a[36:39], a[132:135], v[36:39], a[36:39]
    ds_read_b128 a[120:123], v43 offset:8704
    ds_read_b128 a[124:127], v43 offset:8960
    v_mfma_f32_16x16x32_bf16 a[40:43], a[136:139], v[36:39], a[40:43]
    v_exp_f32 v21, v21
    v_mfma_f32_16x16x32_bf16 a[44:47], a[140:143], v[36:39], a[44:47]
    ds_read_b64_tr_b16 a[128:129], v56 offset:0
    v_cvt_pk_bf16_f32 v34, v20, v21
    v_mfma_f32_16x16x32_bf16 a[48:51], a[144:147], v[36:39], a[48:51]
    v_exp_f32 v22, v22
    v_mfma_f32_16x16x32_bf16 a[52:55], a[148:151], v[36:39], a[52:55]
    ds_read_b64_tr_b16 a[130:131], v56 offset:8192
    ds_read_b64_tr_b16 a[132:133], v56 offset:8
    v_mfma_f32_16x16x32_bf16 a[56:59], a[152:155], v[36:39], a[56:59]
    v_exp_f32 v23, v23
    v_mfma_f32_16x16x32_bf16 a[60:63], a[156:159], v[36:39], a[60:63]
    ds_read_b64_tr_b16 a[134:135], v56 offset:8200
    ds_read_b64_tr_b16 a[156:157], v56 offset:776
    v_cvt_pk_bf16_f32 v35, v22, v23
    v_mfma_f32_16x16x32_bf16 a[228:231], a[248:251], v[36:39], a[228:231]
    s_waitcnt lgkmcnt(15)
    ds_read_b64_tr_b16 a[136:137], v56 offset:256
    ds_read_b64_tr_b16 a[138:139], v56 offset:8448
    ds_read_b64_tr_b16 a[158:159], v56 offset:8968
    v_mfma_f32_16x16x32_bf16 v[16:19], a[96:99], a[160:163], 0
    v_exp_f32 v24, v24
    v_mfma_f32_16x16x32_bf16 v[16:19], a[100:103], a[164:167], v[16:19]
    ds_read_b64_tr_b16 a[140:141], v56 offset:264
    ds_read_b64_tr_b16 a[142:143], v56 offset:8456
    v_mfma_f32_16x16x32_bf16 v[16:19], a[104:107], a[168:171], v[16:19]
    s_waitcnt lgkmcnt(14)
    v_exp_f32 v25, v25
    v_mfma_f32_16x16x32_bf16 v[16:19], a[108:111], a[172:175], v[16:19]
    s_waitcnt lgkmcnt(13)
    ds_read_b64_tr_b16 a[144:145], v56 offset:512
    v_cvt_pk_bf16_f32 v36, v24, v25
    s_waitcnt lgkmcnt(15)
    v_accvgpr_read_b32 v13, a236
    v_add_f32 v13, v13, v41
    v_subrev_u32 v42, s38, v13
    v_cmp_lt_u32 vcc, s39, v42
    v_rcp_f32 v13, v13
    s_or_b64 s[40:41], s[40:41], vcc
    s_not_b64 s[54:55], vcc
    v_pk_add_f32 v[96:97], v[96:97], v[112:113]
    v_pk_add_f32 v[98:99], v[98:99], v[114:115]
    v_pk_add_f32 v[100:101], v[100:101], v[116:117]
    v_pk_add_f32 v[102:103], v[102:103], v[118:119]
    v_pk_add_f32 v[104:105], v[104:105], v[120:121]
    v_pk_add_f32 v[106:107], v[106:107], v[122:123]
    v_pk_add_f32 v[108:109], v[108:109], v[124:125]
    v_pk_add_f32 v[110:111], v[110:111], v[126:127]
    v_pk_mul_f32 v[96:97], v[96:97], v[12:13] op_sel:[0,1] op_sel_hi:[1,1]
    v_pk_mul_f32 v[98:99], v[98:99], v[12:13] op_sel:[0,1] op_sel_hi:[1,1]
    v_pk_mul_f32 v[100:101], v[100:101], v[12:13] op_sel:[0,1] op_sel_hi:[1,1]
    v_pk_mul_f32 v[102:103], v[102:103], v[12:13] op_sel:[0,1] op_sel_hi:[1,1]
    v_pk_mul_f32 v[104:105], v[104:105], v[12:13] op_sel:[0,1] op_sel_hi:[1,1]
    v_pk_mul_f32 v[106:107], v[106:107], v[12:13] op_sel:[0,1] op_sel_hi:[1,1]
    v_pk_mul_f32 v[108:109], v[108:109], v[12:13] op_sel:[0,1] op_sel_hi:[1,1]
    v_pk_mul_f32 v[110:111], v[110:111], v[12:13] op_sel:[0,1] op_sel_hi:[1,1]
    v_cvt_pk_bf16_f32 v96, v96, v97
    v_cvt_pk_bf16_f32 v97, v98, v99
    v_cvt_pk_bf16_f32 v98, v100, v101
    v_cvt_pk_bf16_f32 v99, v102, v103
    v_cvt_pk_bf16_f32 v100, v104, v105
    v_cvt_pk_bf16_f32 v101, v106, v107
    v_cvt_pk_bf16_f32 v102, v108, v109
    v_cvt_pk_bf16_f32 v103, v110, v111
    v_mfma_f32_16x16x32_bf16 v[20:23], a[112:115], a[160:163], 0
    s_waitcnt lgkmcnt(13)
    s_mov_b64 exec, s[54:55]
    buffer_store_dwordx4 v[96:99], v1, s[28:31], s43 offen offset:0 sc1
    s_mov_b64 exec, -1
    v_exp_f32 v26, v26
    v_mfma_f32_16x16x32_bf16 v[20:23], a[116:119], a[164:167], v[20:23]
    s_waitcnt lgkmcnt(12)
    ds_read_b64_tr_b16 a[146:147], v56 offset:8704
    ds_read_b64_tr_b16 a[148:149], v56 offset:520
    v_mfma_f32_16x16x32_bf16 v[20:23], a[120:123], a[168:171], v[20:23]
    s_waitcnt lgkmcnt(13)
    v_exp_f32 v27, v27
    v_mfma_f32_16x16x32_bf16 v[20:23], a[124:127], a[172:175], v[20:23]
    s_waitcnt lgkmcnt(11)
    ds_read_b64_tr_b16 a[150:151], v56 offset:8712
    v_cvt_pk_bf16_f32 v37, v26, v27
    v_mfma_f32_16x16x32_bf16 a[0:3], a[128:131], v[32:35], a[0:3]
    s_waitcnt lgkmcnt(10)
    v_exp_f32 v28, v28
    v_mfma_f32_16x16x32_bf16 a[4:7], a[132:135], v[32:35], a[4:7]
    s_waitcnt lgkmcnt(7)
    ds_read_b64_tr_b16 a[152:153], v56 offset:768
    ds_read_b64_tr_b16 a[154:155], v56 offset:8960
    v_mfma_f32_16x16x32_bf16 a[8:11], a[136:139], v[32:35], a[8:11]
    s_waitcnt lgkmcnt(6)
    v_exp_f32 v29, v29
    v_mfma_f32_16x16x32_bf16 a[12:15], a[140:143], v[32:35], a[12:15]
    s_waitcnt lgkmcnt(4)
    v_cvt_pk_bf16_f32 v38, v28, v29
    v_mfma_f32_16x16x32_bf16 a[16:19], a[144:147], v[32:35], a[16:19]
    s_waitcnt lgkmcnt(2)
    s_mov_b64 exec, s[54:55]
    buffer_store_dwordx4 v[100:103], v1, s[28:31], s43 offen offset:64 sc1
    s_mov_b64 exec, -1
    v_exp_f32 v30, v30
    v_mfma_f32_16x16x32_bf16 a[20:23], a[148:151], v[32:35], a[20:23]
    s_waitcnt lgkmcnt(0)
    v_mfma_f32_16x16x32_bf16 a[24:27], a[152:155], v[32:35], a[24:27]
    v_exp_f32 v31, v31
    v_mfma_f32_16x16x32_bf16 a[28:31], a[156:159], v[32:35], a[28:31]
    v_cvt_pk_bf16_f32 v39, v30, v31
    v_mfma_f32_16x16x32_bf16 a[224:227], a[248:251], v[32:35], a[224:227]
    v_mfma_f32_16x16x32_bf16 v[24:27], a[96:99], a[176:179], 0
    v_exp_f32 v16, v16
    v_mfma_f32_16x16x32_bf16 v[24:27], a[100:103], a[180:183], v[24:27]
    ds_read_b128 a[96:99], v6 offset:0
    ds_read_b128 a[100:103], v6 offset:256
    v_mfma_f32_16x16x32_bf16 v[24:27], a[104:107], a[184:187], v[24:27]
    v_exp_f32 v17, v17
    v_mfma_f32_16x16x32_bf16 v[24:27], a[108:111], a[188:191], v[24:27]
    ds_read_b128 a[104:107], v6 offset:512
    v_cvt_pk_bf16_f32 v32, v16, v17
    v_mfma_f32_16x16x32_bf16 v[28:31], a[112:115], a[176:179], 0
    v_exp_f32 v18, v18
    v_mfma_f32_16x16x32_bf16 v[28:31], a[116:119], a[180:183], v[28:31]
    ds_read_b128 a[108:111], v6 offset:768
    ds_read_b128 a[112:115], v6 offset:8192
    v_mfma_f32_16x16x32_bf16 v[28:31], a[120:123], a[184:187], v[28:31]
    v_exp_f32 v19, v19
    v_mfma_f32_16x16x32_bf16 v[28:31], a[124:127], a[188:191], v[28:31]
    ds_read_b128 a[116:119], v6 offset:8448
    v_cvt_pk_bf16_f32 v33, v18, v19
    v_mfma_f32_16x16x32_bf16 a[32:35], a[128:131], v[36:39], a[32:35]
    v_exp_f32 v20, v20
    v_mfma_f32_16x16x32_bf16 a[36:39], a[132:135], v[36:39], a[36:39]
    ds_read_b128 a[120:123], v6 offset:8704
    ds_read_b128 a[124:127], v6 offset:8960
    v_mfma_f32_16x16x32_bf16 a[40:43], a[136:139], v[36:39], a[40:43]
    v_exp_f32 v21, v21
    v_mfma_f32_16x16x32_bf16 a[44:47], a[140:143], v[36:39], a[44:47]
    ds_read_b64_tr_b16 a[128:129], v46 offset:0
    v_cvt_pk_bf16_f32 v34, v20, v21
    v_mfma_f32_16x16x32_bf16 a[48:51], a[144:147], v[36:39], a[48:51]
    v_exp_f32 v22, v22
    v_mfma_f32_16x16x32_bf16 a[52:55], a[148:151], v[36:39], a[52:55]
    ds_read_b64_tr_b16 a[130:131], v46 offset:8192
    ds_read_b64_tr_b16 a[132:133], v46 offset:8
    v_mfma_f32_16x16x32_bf16 a[56:59], a[152:155], v[36:39], a[56:59]
    v_exp_f32 v23, v23
    v_mfma_f32_16x16x32_bf16 a[60:63], a[156:159], v[36:39], a[60:63]
    ds_read_b64_tr_b16 a[134:135], v46 offset:8200
    ds_read_b64_tr_b16 a[156:157], v46 offset:776
    v_cvt_pk_bf16_f32 v35, v22, v23
    v_mfma_f32_16x16x32_bf16 a[228:231], a[248:251], v[36:39], a[228:231]
    s_waitcnt lgkmcnt(12)
    ds_read_b64_tr_b16 a[136:137], v46 offset:256
    ds_read_b64_tr_b16 a[138:139], v46 offset:8448
    ds_read_b64_tr_b16 a[158:159], v46 offset:8968
    v_mfma_f32_16x16x32_bf16 v[16:19], a[96:99], a[192:195], 0
    s_waitcnt lgkmcnt(14)
    v_exp_f32 v24, v24
    v_mfma_f32_16x16x32_bf16 v[16:19], a[100:103], a[196:199], v[16:19]
    s_waitcnt lgkmcnt(13)
    ds_read_b64_tr_b16 a[140:141], v46 offset:264
    ds_read_b64_tr_b16 a[142:143], v46 offset:8456
    v_mfma_f32_16x16x32_bf16 v[16:19], a[104:107], a[200:203], v[16:19]
    s_waitcnt lgkmcnt(14)
    v_exp_f32 v25, v25
    v_mfma_f32_16x16x32_bf16 v[16:19], a[108:111], a[204:207], v[16:19]
    s_waitcnt lgkmcnt(13)
    ds_read_b64_tr_b16 a[144:145], v46 offset:512
    v_cvt_pk_bf16_f32 v36, v24, v25
    v_mfma_f32_16x16x32_bf16 v[20:23], a[112:115], a[192:195], 0
    s_waitcnt lgkmcnt(13)
    v_exp_f32 v26, v26
    v_mfma_f32_16x16x32_bf16 v[20:23], a[116:119], a[196:199], v[20:23]
    s_waitcnt lgkmcnt(12)
    ds_read_b64_tr_b16 a[146:147], v46 offset:8704
    ds_read_b64_tr_b16 a[148:149], v46 offset:520
    v_mfma_f32_16x16x32_bf16 v[20:23], a[120:123], a[200:203], v[20:23]
    s_waitcnt lgkmcnt(13)
    v_exp_f32 v27, v27
    v_mfma_f32_16x16x32_bf16 v[20:23], a[124:127], a[204:207], v[20:23]
    s_waitcnt lgkmcnt(11)
    ds_read_b64_tr_b16 a[150:151], v46 offset:8712
    v_cvt_pk_bf16_f32 v37, v26, v27
    v_mfma_f32_16x16x32_bf16 a[0:3], a[128:131], v[32:35], a[0:3]
    s_waitcnt lgkmcnt(10)
    v_exp_f32 v28, v28
    v_mfma_f32_16x16x32_bf16 a[4:7], a[132:135], v[32:35], a[4:7]
    s_waitcnt lgkmcnt(7)
    ds_read_b64_tr_b16 a[152:153], v46 offset:768
    ds_read_b64_tr_b16 a[154:155], v46 offset:8960
    v_mfma_f32_16x16x32_bf16 a[8:11], a[136:139], v[32:35], a[8:11]
    s_waitcnt lgkmcnt(6)
    v_exp_f32 v29, v29
    v_mfma_f32_16x16x32_bf16 a[12:15], a[140:143], v[32:35], a[12:15]
    s_waitcnt lgkmcnt(4)
    ds_read_b128 a[96:99], v45 offset:0
    v_cvt_pk_bf16_f32 v38, v28, v29
    v_mfma_f32_16x16x32_bf16 a[16:19], a[144:147], v[32:35], a[16:19]
    s_waitcnt lgkmcnt(3)
    v_exp_f32 v30, v30
    v_mfma_f32_16x16x32_bf16 a[20:23], a[148:151], v[32:35], a[20:23]
    s_waitcnt lgkmcnt(1)
    ds_read_b128 a[100:103], v45 offset:256
    ds_read_b128 a[104:107], v45 offset:512
    v_mfma_f32_16x16x32_bf16 a[24:27], a[152:155], v[32:35], a[24:27]
    v_exp_f32 v31, v31
    v_mfma_f32_16x16x32_bf16 a[28:31], a[156:159], v[32:35], a[28:31]
    ds_read_b128 a[108:111], v45 offset:768
    v_cvt_pk_bf16_f32 v39, v30, v31
    v_mfma_f32_16x16x32_bf16 a[224:227], a[248:251], v[32:35], a[224:227]
    s_waitcnt lgkmcnt(3)
    ds_read_b128 a[112:115], v45 offset:8192
    ds_read_b128 a[116:119], v45 offset:8448
    v_mfma_f32_16x16x32_bf16 v[24:27], a[96:99], a[192:195], 0
    s_waitcnt lgkmcnt(4)
    v_exp_f32 v16, v16
    v_mfma_f32_16x16x32_bf16 v[24:27], a[100:103], a[196:199], v[24:27]
    s_waitcnt lgkmcnt(3)
    ds_read_b128 a[120:123], v45 offset:8704
    ds_read_b128 a[124:127], v45 offset:8960
    v_mfma_f32_16x16x32_bf16 v[24:27], a[104:107], a[200:203], v[24:27]
    s_waitcnt lgkmcnt(4)
    v_exp_f32 v17, v17
    v_mfma_f32_16x16x32_bf16 v[24:27], a[108:111], a[204:207], v[24:27]
    s_waitcnt lgkmcnt(3)
    ds_read_b128 a[96:99], v4 offset:0
    v_cvt_pk_bf16_f32 v32, v16, v17
    v_accvgpr_read_b32 v10, a224
    v_subrev_u32 v42, s38, v10
    v_cmp_lt_u32 vcc, s39, v42
    v_rcp_f32 v10, v10
    s_or_b64 s[40:41], s[40:41], vcc
    v_accvgpr_read_b32 v224, a0
    v_accvgpr_read_b32 v225, a1
    v_accvgpr_read_b32 v226, a2
    v_accvgpr_read_b32 v227, a3
    v_accvgpr_read_b32 v228, a4
    v_accvgpr_read_b32 v229, a5
    v_accvgpr_read_b32 v230, a6
    v_accvgpr_read_b32 v231, a7
    v_accvgpr_read_b32 v232, a8
    v_accvgpr_read_b32 v233, a9
    v_accvgpr_read_b32 v234, a10
    v_accvgpr_read_b32 v235, a11
    v_accvgpr_read_b32 v236, a12
    v_accvgpr_read_b32 v237, a13
    v_accvgpr_read_b32 v238, a14
    v_accvgpr_read_b32 v239, a15
    v_accvgpr_read_b32 v240, a16
    v_accvgpr_read_b32 v241, a17
    v_accvgpr_read_b32 v242, a18
    v_accvgpr_read_b32 v243, a19
    v_accvgpr_read_b32 v244, a20
    v_accvgpr_read_b32 v245, a21
    v_accvgpr_read_b32 v246, a22
    v_accvgpr_read_b32 v247, a23
    v_accvgpr_read_b32 v248, a24
    v_accvgpr_read_b32 v249, a25
    v_accvgpr_read_b32 v250, a26
    v_accvgpr_read_b32 v251, a27
    v_accvgpr_read_b32 v252, a28
    v_accvgpr_read_b32 v253, a29
    v_accvgpr_read_b32 v254, a30
    v_accvgpr_read_b32 v255, a31
    v_pk_mul_f32 v[224:225], v[224:225], v[10:11] op_sel:[0,0] op_sel_hi:[1,0]
    v_pk_mul_f32 v[226:227], v[226:227], v[10:11] op_sel:[0,0] op_sel_hi:[1,0]
    v_pk_mul_f32 v[228:229], v[228:229], v[10:11] op_sel:[0,0] op_sel_hi:[1,0]
    v_pk_mul_f32 v[230:231], v[230:231], v[10:11] op_sel:[0,0] op_sel_hi:[1,0]
    v_pk_mul_f32 v[232:233], v[232:233], v[10:11] op_sel:[0,0] op_sel_hi:[1,0]
    v_pk_mul_f32 v[234:235], v[234:235], v[10:11] op_sel:[0,0] op_sel_hi:[1,0]
    v_pk_mul_f32 v[236:237], v[236:237], v[10:11] op_sel:[0,0] op_sel_hi:[1,0]
    v_pk_mul_f32 v[238:239], v[238:239], v[10:11] op_sel:[0,0] op_sel_hi:[1,0]
    v_pk_mul_f32 v[240:241], v[240:241], v[10:11] op_sel:[0,0] op_sel_hi:[1,0]
    v_pk_mul_f32 v[242:243], v[242:243], v[10:11] op_sel:[0,0] op_sel_hi:[1,0]
    v_pk_mul_f32 v[244:245], v[244:245], v[10:11] op_sel:[0,0] op_sel_hi:[1,0]
    v_pk_mul_f32 v[246:247], v[246:247], v[10:11] op_sel:[0,0] op_sel_hi:[1,0]
    v_pk_mul_f32 v[248:249], v[248:249], v[10:11] op_sel:[0,0] op_sel_hi:[1,0]
    v_pk_mul_f32 v[250:251], v[250:251], v[10:11] op_sel:[0,0] op_sel_hi:[1,0]
    v_pk_mul_f32 v[252:253], v[252:253], v[10:11] op_sel:[0,0] op_sel_hi:[1,0]
    v_pk_mul_f32 v[254:255], v[254:255], v[10:11] op_sel:[0,0] op_sel_hi:[1,0]
    v_cvt_pk_bf16_f32 v224, v224, v225
    v_cvt_pk_bf16_f32 v225, v226, v227
    v_cvt_pk_bf16_f32 v226, v228, v229
    v_cvt_pk_bf16_f32 v227, v230, v231
    buffer_store_dwordx4 v[224:227], v1, s[28:31], s50 offen offset:0 sc1
    v_cvt_pk_bf16_f32 v232, v232, v233
    v_cvt_pk_bf16_f32 v233, v234, v235
    v_cvt_pk_bf16_f32 v234, v236, v237
    v_cvt_pk_bf16_f32 v235, v238, v239
    v_cvt_pk_bf16_f32 v240, v240, v241
    v_cvt_pk_bf16_f32 v241, v242, v243
    v_cvt_pk_bf16_f32 v242, v244, v245
    v_cvt_pk_bf16_f32 v243, v246, v247
    v_cvt_pk_bf16_f32 v248, v248, v249
    v_cvt_pk_bf16_f32 v249, v250, v251
    v_cvt_pk_bf16_f32 v250, v252, v253
    v_cvt_pk_bf16_f32 v251, v254, v255
    v_mfma_f32_16x16x32_bf16 v[28:31], a[112:115], a[192:195], 0
    s_waitcnt lgkmcnt(3)
    buffer_store_dwordx4 v[232:235], v1, s[28:31], s50 offen offset:64 sc1
    v_exp_f32 v18, v18
    v_mfma_f32_16x16x32_bf16 v[28:31], a[116:119], a[196:199], v[28:31]
    s_waitcnt lgkmcnt(2)
    ds_read_b128 a[100:103], v4 offset:256
    ds_read_b128 a[104:107], v4 offset:512
    v_mfma_f32_16x16x32_bf16 v[28:31], a[120:123], a[200:203], v[28:31]
    s_waitcnt lgkmcnt(3)
    v_exp_f32 v19, v19
    v_mfma_f32_16x16x32_bf16 v[28:31], a[124:127], a[204:207], v[28:31]
    ds_read_b128 a[108:111], v4 offset:768
    v_cvt_pk_bf16_f32 v33, v18, v19
    v_mfma_f32_16x16x32_bf16 a[32:35], a[128:131], v[36:39], a[32:35]
    v_exp_f32 v20, v20
    v_mfma_f32_16x16x32_bf16 a[36:39], a[132:135], v[36:39], a[36:39]
    ds_read_b128 a[112:115], v4 offset:8192
    ds_read_b128 a[116:119], v4 offset:8448
    v_mfma_f32_16x16x32_bf16 a[40:43], a[136:139], v[36:39], a[40:43]
    v_exp_f32 v21, v21
    v_mfma_f32_16x16x32_bf16 a[44:47], a[140:143], v[36:39], a[44:47]
    ds_read_b128 a[120:123], v4 offset:8704
    v_cvt_pk_bf16_f32 v34, v20, v21
    v_mfma_f32_16x16x32_bf16 a[48:51], a[144:147], v[36:39], a[48:51]
    buffer_store_dwordx4 v[240:243], v1, s[28:31], s50 offen offset:128 sc1
    v_exp_f32 v22, v22
    v_mfma_f32_16x16x32_bf16 a[52:55], a[148:151], v[36:39], a[52:55]
    ds_read_b128 a[124:127], v4 offset:8960
    ds_read_b64_tr_b16 a[128:129], v9 offset:0
    ds_read_b64_tr_b16 a[148:149], v9 offset:520
    v_mfma_f32_16x16x32_bf16 a[56:59], a[152:155], v[36:39], a[56:59]
    ds_read_b64_tr_b16 a[150:151], v9 offset:8712
    v_exp_f32 v23, v23
    v_mfma_f32_16x16x32_bf16 a[60:63], a[156:159], v[36:39], a[60:63]
    ds_read_b64_tr_b16 a[130:131], v9 offset:8192
    ds_read_b64_tr_b16 a[156:157], v9 offset:776
    v_cvt_pk_bf16_f32 v35, v22, v23
    v_mfma_f32_16x16x32_bf16 a[228:231], a[248:251], v[36:39], a[228:231]
    s_waitcnt lgkmcnt(12)
    ds_read_b64_tr_b16 a[132:133], v9 offset:8
    ds_read_b64_tr_b16 a[134:135], v9 offset:8200
    ds_read_b64_tr_b16 a[158:159], v9 offset:8968
    v_mfma_f32_16x16x32_bf16 v[16:19], a[96:99], a[192:195], 0
    s_waitcnt lgkmcnt(14)
    v_exp_f32 v24, v24
    v_mfma_f32_16x16x32_bf16 v[16:19], a[100:103], a[196:199], v[16:19]
    s_waitcnt lgkmcnt(13)
    ds_read_b64_tr_b16 a[136:137], v9 offset:256
    ds_read_b64_tr_b16 a[138:139], v9 offset:8448
    v_mfma_f32_16x16x32_bf16 v[16:19], a[104:107], a[200:203], v[16:19]
    s_waitcnt lgkmcnt(14)
    v_exp_f32 v25, v25
    v_mfma_f32_16x16x32_bf16 v[16:19], a[108:111], a[204:207], v[16:19]
    s_waitcnt lgkmcnt(13)
    ds_read_b64_tr_b16 a[140:141], v9 offset:264
    buffer_store_dwordx4 v[248:251], v1, s[28:31], s50 offen offset:192 sc1
    v_cvt_pk_bf16_f32 v36, v24, v25
    v_accvgpr_read_b32 v11, a228
    v_subrev_u32 v42, s38, v11
    v_cmp_lt_u32 vcc, s39, v42
    v_rcp_f32 v11, v11
    s_or_b64 s[40:41], s[40:41], vcc
    v_accvgpr_read_b32 v192, a32
    v_accvgpr_read_b32 v193, a33
    v_accvgpr_read_b32 v194, a34
    v_accvgpr_read_b32 v195, a35
    v_accvgpr_read_b32 v196, a36
    v_accvgpr_read_b32 v197, a37
    v_accvgpr_read_b32 v198, a38
    v_accvgpr_read_b32 v199, a39
    v_accvgpr_read_b32 v200, a40
    v_accvgpr_read_b32 v201, a41
    v_accvgpr_read_b32 v202, a42
    v_accvgpr_read_b32 v203, a43
    v_accvgpr_read_b32 v204, a44
    v_accvgpr_read_b32 v205, a45
    v_accvgpr_read_b32 v206, a46
    v_accvgpr_read_b32 v207, a47
    v_accvgpr_read_b32 v208, a48
    v_accvgpr_read_b32 v209, a49
    v_accvgpr_read_b32 v210, a50
    v_accvgpr_read_b32 v211, a51
    v_accvgpr_read_b32 v212, a52
    v_accvgpr_read_b32 v213, a53
    v_accvgpr_read_b32 v214, a54
    v_accvgpr_read_b32 v215, a55
    v_accvgpr_read_b32 v216, a56
    v_accvgpr_read_b32 v217, a57
    v_accvgpr_read_b32 v218, a58
    v_accvgpr_read_b32 v219, a59
    v_accvgpr_read_b32 v220, a60
    v_accvgpr_read_b32 v221, a61
    v_accvgpr_read_b32 v222, a62
    v_accvgpr_read_b32 v223, a63
    v_pk_mul_f32 v[192:193], v[192:193], v[10:11] op_sel:[0,1] op_sel_hi:[1,1]
    v_pk_mul_f32 v[194:195], v[194:195], v[10:11] op_sel:[0,1] op_sel_hi:[1,1]
    v_pk_mul_f32 v[196:197], v[196:197], v[10:11] op_sel:[0,1] op_sel_hi:[1,1]
    v_pk_mul_f32 v[198:199], v[198:199], v[10:11] op_sel:[0,1] op_sel_hi:[1,1]
    v_pk_mul_f32 v[200:201], v[200:201], v[10:11] op_sel:[0,1] op_sel_hi:[1,1]
    v_pk_mul_f32 v[202:203], v[202:203], v[10:11] op_sel:[0,1] op_sel_hi:[1,1]
    v_pk_mul_f32 v[204:205], v[204:205], v[10:11] op_sel:[0,1] op_sel_hi:[1,1]
    v_pk_mul_f32 v[206:207], v[206:207], v[10:11] op_sel:[0,1] op_sel_hi:[1,1]
    v_pk_mul_f32 v[208:209], v[208:209], v[10:11] op_sel:[0,1] op_sel_hi:[1,1]
    v_pk_mul_f32 v[210:211], v[210:211], v[10:11] op_sel:[0,1] op_sel_hi:[1,1]
    v_pk_mul_f32 v[212:213], v[212:213], v[10:11] op_sel:[0,1] op_sel_hi:[1,1]
    v_pk_mul_f32 v[214:215], v[214:215], v[10:11] op_sel:[0,1] op_sel_hi:[1,1]
    v_pk_mul_f32 v[216:217], v[216:217], v[10:11] op_sel:[0,1] op_sel_hi:[1,1]
    v_pk_mul_f32 v[218:219], v[218:219], v[10:11] op_sel:[0,1] op_sel_hi:[1,1]
    v_pk_mul_f32 v[220:221], v[220:221], v[10:11] op_sel:[0,1] op_sel_hi:[1,1]
    v_pk_mul_f32 v[222:223], v[222:223], v[10:11] op_sel:[0,1] op_sel_hi:[1,1]
    v_cvt_pk_bf16_f32 v192, v192, v193
    v_cvt_pk_bf16_f32 v193, v194, v195
    v_cvt_pk_bf16_f32 v194, v196, v197
    v_cvt_pk_bf16_f32 v195, v198, v199
    buffer_store_dwordx4 v[192:195], v1, s[28:31], s51 offen offset:0 sc1
    v_cvt_pk_bf16_f32 v200, v200, v201
    v_cvt_pk_bf16_f32 v201, v202, v203
    v_cvt_pk_bf16_f32 v202, v204, v205
    v_cvt_pk_bf16_f32 v203, v206, v207
    v_cvt_pk_bf16_f32 v208, v208, v209
    v_cvt_pk_bf16_f32 v209, v210, v211
    v_cvt_pk_bf16_f32 v210, v212, v213
    v_cvt_pk_bf16_f32 v211, v214, v215
    v_cvt_pk_bf16_f32 v216, v216, v217
    v_cvt_pk_bf16_f32 v217, v218, v219
    v_cvt_pk_bf16_f32 v218, v220, v221
    v_cvt_pk_bf16_f32 v219, v222, v223
    v_mfma_f32_16x16x32_bf16 v[20:23], a[112:115], a[192:195], 0
    s_waitcnt lgkmcnt(13)
    v_exp_f32 v26, v26
    v_mfma_f32_16x16x32_bf16 v[20:23], a[116:119], a[196:199], v[20:23]
    s_waitcnt lgkmcnt(12)
    ds_read_b64_tr_b16 a[142:143], v9 offset:8456
    ds_read_b64_tr_b16 a[144:145], v9 offset:512
    v_mfma_f32_16x16x32_bf16 v[20:23], a[120:123], a[200:203], v[20:23]
    s_waitcnt lgkmcnt(13)
    v_exp_f32 v27, v27
    v_mfma_f32_16x16x32_bf16 v[20:23], a[124:127], a[204:207], v[20:23]
    s_waitcnt lgkmcnt(9)
    ds_read_b64_tr_b16 a[146:147], v9 offset:8704
    v_cvt_pk_bf16_f32 v37, v26, v27
    v_mfma_f32_16x16x32_bf16 v[64:67], a[128:131], v[32:35], v[64:67]
    s_waitcnt lgkmcnt(7)
    ds_read_b64_tr_b16 a[130:131], v56 offset:8192
    v_exp_f32 v28, v28
    v_mfma_f32_16x16x32_bf16 v[68:71], a[132:135], v[32:35], v[68:71]
    s_waitcnt lgkmcnt(5)
L_m11:
    s_cbranch_execz L_back
    ds_read_b64_tr_b16 a[152:153], v9 offset:768
    ds_read_b64_tr_b16 a[154:155], v9 offset:8960
    ds_read_b64_tr_b16 a[132:133], v56 offset:8
    v_mfma_f32_16x16x32_bf16 v[72:75], a[136:139], v[32:35], v[72:75]
    s_waitcnt lgkmcnt(6)
    ds_read_b64_tr_b16 a[134:135], v56 offset:8200
    v_exp_f32 v29, v29
    v_mfma_f32_16x16x32_bf16 v[76:79], a[140:143], v[32:35], v[76:79]
    s_waitcnt lgkmcnt(5)
    ds_read_b128 a[96:99], v43 offset:0
    ds_read_b64_tr_b16 a[140:141], v56 offset:264
    buffer_store_dwordx4 v[200:203], v1, s[28:31], s51 offen offset:64 sc1
    v_cvt_pk_bf16_f32 v38, v28, v29
    v_mfma_f32_16x16x32_bf16 v[80:83], a[144:147], v[32:35], v[80:83]
    ds_read_b64_tr_b16 a[142:143], v56 offset:8456
    v_exp_f32 v30, v30
    v_mfma_f32_16x16x32_bf16 v[84:87], a[148:151], v[32:35], v[84:87]
    s_waitcnt lgkmcnt(5)
    ds_read_b128 a[100:103], v43 offset:256
    ds_read_b128 a[104:107], v43 offset:512
    ds_read_b64_tr_b16 a[146:147], v56 offset:8704
    v_mfma_f32_16x16x32_bf16 v[88:91], a[152:155], v[32:35], v[88:91]
    ds_read_b64_tr_b16 a[148:149], v56 offset:520
    v_exp_f32 v31, v31
    v_mfma_f32_16x16x32_bf16 v[92:95], a[156:159], v[32:35], v[92:95]
    ds_read_b128 a[108:111], v43 offset:768
    ds_read_b64_tr_b16 a[150:151], v56 offset:8712
    v_cvt_pk_bf16_f32 v39, v30, v31
    v_mfma_f32_16x16x32_bf16 a[232:235], a[248:251], v[32:35], a[232:235]
    s_waitcnt lgkmcnt(8)
    ds_read_b128 a[112:115], v43 offset:8192
    ds_read_b128 a[116:119], v43 offset:8448
    ds_read_b64_tr_b16 a[156:157], v56 offset:776
    v_mfma_f32_16x16x32_bf16 v[24:27], a[96:99], a[192:195], 0
    s_waitcnt lgkmcnt(8)
    ds_read_b64_tr_b16 a[158:159], v56 offset:8968
    v_exp_f32 v16, v16
    v_mfma_f32_16x16x32_bf16 v[24:27], a[100:103], a[196:199], v[24:27]
    s_waitcnt lgkmcnt(8)
    ds_read_b128 a[120:123], v43 offset:8704
    ds_read_b128 a[124:127], v43 offset:8960
    v_mfma_f32_16x16x32_bf16 v[24:27], a[104:107], a[200:203], v[24:27]
    s_waitcnt lgkmcnt(7)
    buffer_store_dwordx4 v[208:211], v1, s[28:31], s51 offen offset:128 sc1
    v_exp_f32 v17, v17
    v_mfma_f32_16x16x32_bf16 v[24:27], a[108:111], a[204:207], v[24:27]
    s_waitcnt lgkmcnt(5)
    ds_read_b64_tr_b16 a[128:129], v56 offset:0
    v_cvt_pk_bf16_f32 v32, v16, v17
    v_mfma_f32_16x16x32_bf16 v[28:31], a[112:115], a[192:195], 0
    s_waitcnt lgkmcnt(5)
    v_exp_f32 v18, v18
    v_mfma_f32_16x16x32_bf16 v[28:31], a[116:119], a[196:199], v[28:31]
    s_waitcnt lgkmcnt(2)
    ds_read_b64_tr_b16 a[136:137], v56 offset:256
    ds_read_b64_tr_b16 a[138:139], v56 offset:8448
    v_mfma_f32_16x16x32_bf16 v[28:31], a[120:123], a[200:203], v[28:31]
    s_waitcnt lgkmcnt(3)
    v_exp_f32 v19, v19
    v_mfma_f32_16x16x32_bf16 v[28:31], a[124:127], a[204:207], v[28:31]
    s_waitcnt lgkmcnt(2)
    ds_read_b64_tr_b16 a[144:145], v56 offset:512
    v_cvt_pk_bf16_f32 v33, v18, v19
    v_mfma_f32_16x16x32_bf16 v[64:67], a[128:131], v[36:39], v[64:67]
    ds_read_b64_tr_b16 a[130:131], v7 offset:8192
    v_exp_f32 v20, v20
    v_mfma_f32_16x16x32_bf16 v[68:71], a[132:135], v[36:39], v[68:71]
    s_waitcnt lgkmcnt(2)
    ds_read_b64_tr_b16 a[152:153], v56 offset:768
    ds_read_b64_tr_b16 a[154:155], v56 offset:8960
    v_mfma_f32_16x16x32_bf16 v[72:75], a[136:139], v[36:39], v[72:75]
    ds_read_b64_tr_b16 a[136:137], v7 offset:256
    buffer_store_dwordx4 v[216:219], v1, s[28:31], s51 offen offset:192 sc1
    v_exp_f32 v21, v21
    v_mfma_f32_16x16x32_bf16 v[76:79], a[140:143], v[36:39], v[76:79]
    s_waitcnt lgkmcnt(4)
    ds_read_b64_tr_b16 a[128:129], v7 offset:0
    ds_read_b64_tr_b16 a[138:139], v7 offset:8448
    v_cvt_pk_bf16_f32 v34, v20, v21
    v_mfma_f32_16x16x32_bf16 v[80:83], a[144:147], v[36:39], v[80:83]
    ds_read_b64_tr_b16 a[142:143], v7 offset:8456
    v_exp_f32 v22, v22
    v_mfma_f32_16x16x32_bf16 v[84:87], a[148:151], v[36:39], v[84:87]
    s_waitcnt lgkmcnt(4)
    ds_read_b64_tr_b16 a[132:133], v7 offset:8
    ds_read_b64_tr_b16 a[134:135], v7 offset:8200
    v_mfma_f32_16x16x32_bf16 v[88:91], a[152:155], v[36:39], v[88:91]
    v_exp_f32 v23, v23
    v_mfma_f32_16x16x32_bf16 v[92:95], a[156:159], v[36:39], v[92:95]
    ds_read_b64_tr_b16 a[140:141], v7 offset:264
    v_cvt_pk_bf16_f32 v35, v22, v23
    v_mfma_f32_16x16x32_bf16 a[232:235], a[248:251], v[36:39], a[232:235]
    s_waitcnt lgkmcnt(5)
    ds_read_b64_tr_b16 a[144:145], v7 offset:512
    ds_read_b64_tr_b16 a[146:147], v7 offset:8704
    v_mfma_f32_16x16x32_bf16 v[64:67], a[128:131], v[32:35], v[64:67]
    s_waitcnt lgkmcnt(3)
    ds_read_b64_tr_b16 a[148:149], v7 offset:520
    ds_read_b64_tr_b16 a[150:151], v7 offset:8712
    v_mfma_f32_16x16x32_bf16 v[68:71], a[132:135], v[32:35], v[68:71]
    ds_read_b64_tr_b16 a[152:153], v7 offset:768
    ds_read_b64_tr_b16 a[154:155], v7 offset:8960
    v_mfma_f32_16x16x32_bf16 v[72:75], a[136:139], v[32:35], v[72:75]
    s_waitcnt lgkmcnt(6)
    ds_read_b64_tr_b16 a[156:157], v7 offset:776
    ds_read_b64_tr_b16 a[158:159], v7 offset:8968
    v_mfma_f32_16x16x32_bf16 v[76:79], a[140:143], v[32:35], v[76:79]
    s_waitcnt lgkmcnt(6)
    ds_read_b64_tr_b16 a[128:129], v46 offset:0
    ds_read_b64_tr_b16 a[130:131], v46 offset:8192
    v_mfma_f32_16x16x32_bf16 v[80:83], a[144:147], v[32:35], v[80:83]
    s_waitcnt lgkmcnt(6)
    ds_read_b64_tr_b16 a[132:133], v46 offset:8
    ds_read_b64_tr_b16 a[134:135], v46 offset:8200
    v_mfma_f32_16x16x32_bf16 v[84:87], a[148:151], v[32:35], v[84:87]
    s_waitcnt lgkmcnt(6)
    ds_read_b64_tr_b16 a[136:137], v46 offset:256
    ds_read_b64_tr_b16 a[138:139], v46 offset:8448
    v_mfma_f32_16x16x32_bf16 v[88:91], a[152:155], v[32:35], v[88:91]
    s_waitcnt lgkmcnt(6)
    ds_read_b64_tr_b16 a[140:141], v46 offset:264
    ds_read_b64_tr_b16 a[142:143], v46 offset:8456
    v_mfma_f32_16x16x32_bf16 v[92:95], a[156:159], v[32:35], v[92:95]
    ds_read_b64_tr_b16 a[144:145], v46 offset:512
    ds_read_b64_tr_b16 a[146:147], v46 offset:8704
    v_mfma_f32_16x16x32_bf16 a[232:235], a[248:251], v[32:35], a[232:235]
    ds_read_b64_tr_b16 a[148:149], v46 offset:520
    ds_read_b64_tr_b16 a[150:151], v46 offset:8712
    v_exp_f32 v24, v24
    v_exp_f32 v25, v25
    v_exp_f32 v26, v26
    v_exp_f32 v27, v27
    v_exp_f32 v28, v28
    v_exp_f32 v29, v29
    v_exp_f32 v30, v30
    v_exp_f32 v31, v31
    s_nop 0
    v_cvt_pk_bf16_f32 v36, v24, v25
    v_cvt_pk_bf16_f32 v37, v26, v27
    v_cvt_pk_bf16_f32 v38, v28, v29
    v_cvt_pk_bf16_f32 v39, v30, v31
    s_nop 1
    v_mfma_f32_16x16x32_bf16 a[232:235], a[248:251], v[36:39], a[232:235]
    s_waitcnt lgkmcnt(10)
    ds_read_b64_tr_b16 a[152:153], v46 offset:768
    ds_read_b64_tr_b16 a[154:155], v46 offset:8960
    v_mfma_f32_16x16x32_bf16 v[64:67], a[128:131], v[36:39], v[64:67]
    s_waitcnt lgkmcnt(10)
    ds_read_b64_tr_b16 a[156:157], v46 offset:776
    ds_read_b64_tr_b16 a[158:159], v46 offset:8968
    v_mfma_f32_16x16x32_bf16 v[68:71], a[132:135], v[36:39], v[68:71]
    s_waitcnt lgkmcnt(10)
    v_mfma_f32_16x16x32_bf16 v[72:75], a[136:139], v[36:39], v[72:75]
    s_waitcnt lgkmcnt(8)
    v_mfma_f32_16x16x32_bf16 v[76:79], a[140:143], v[36:39], v[76:79]
    s_waitcnt lgkmcnt(6)
    v_mfma_f32_16x16x32_bf16 v[80:83], a[144:147], v[36:39], v[80:83]
    s_waitcnt lgkmcnt(4)
    v_accvgpr_read_b32 v12, a232
    v_subrev_u32 v42, s38, v12
    v_mfma_f32_16x16x32_bf16 v[84:87], a[148:151], v[36:39], v[84:87]
    s_waitcnt lgkmcnt(2)
    v_cmp_lt_u32 vcc, s39, v42
    v_mfma_f32_16x16x32_bf16 v[88:91], a[152:155], v[36:39], v[88:91]
    s_waitcnt lgkmcnt(0)
    v_rcp_f32 v12, v12
    v_mfma_f32_16x16x32_bf16 v[92:95], a[156:159], v[36:39], v[92:95]
    s_or_b64 s[40:41], s[40:41], vcc
    s_nop 1
    v_pk_mul_f32 v[64:65], v[64:65], v[12:13] op_sel:[0,0] op_sel_hi:[1,0]
    v_pk_mul_f32 v[66:67], v[66:67], v[12:13] op_sel:[0,0] op_sel_hi:[1,0]
    v_pk_mul_f32 v[68:69], v[68:69], v[12:13] op_sel:[0,0] op_sel_hi:[1,0]
    v_pk_mul_f32 v[70:71], v[70:71], v[12:13] op_sel:[0,0] op_sel_hi:[1,0]
    v_cvt_pk_bf16_f32 v64, v64, v65
    v_cvt_pk_bf16_f32 v65, v66, v67
    v_cvt_pk_bf16_f32 v66, v68, v69
    v_cvt_pk_bf16_f32 v67, v70, v71
    buffer_store_dwordx4 v[64:67], v1, s[28:31], s52 offen offset:0 sc1
    v_pk_mul_f32 v[72:73], v[72:73], v[12:13] op_sel:[0,0] op_sel_hi:[1,0]
    v_pk_mul_f32 v[74:75], v[74:75], v[12:13] op_sel:[0,0] op_sel_hi:[1,0]
    v_pk_mul_f32 v[76:77], v[76:77], v[12:13] op_sel:[0,0] op_sel_hi:[1,0]
    v_pk_mul_f32 v[78:79], v[78:79], v[12:13] op_sel:[0,0] op_sel_hi:[1,0]
    v_cvt_pk_bf16_f32 v72, v72, v73
    v_cvt_pk_bf16_f32 v73, v74, v75
    v_cvt_pk_bf16_f32 v74, v76, v77
    v_cvt_pk_bf16_f32 v75, v78, v79
    buffer_store_dwordx4 v[72:75], v1, s[28:31], s52 offen offset:64 sc1
    v_pk_mul_f32 v[80:81], v[80:81], v[12:13] op_sel:[0,0] op_sel_hi:[1,0]
    v_pk_mul_f32 v[82:83], v[82:83], v[12:13] op_sel:[0,0] op_sel_hi:[1,0]
    v_pk_mul_f32 v[84:85], v[84:85], v[12:13] op_sel:[0,0] op_sel_hi:[1,0]
    v_pk_mul_f32 v[86:87], v[86:87], v[12:13] op_sel:[0,0] op_sel_hi:[1,0]
    v_cvt_pk_bf16_f32 v80, v80, v81
    v_cvt_pk_bf16_f32 v81, v82, v83
    v_cvt_pk_bf16_f32 v82, v84, v85
    v_cvt_pk_bf16_f32 v83, v86, v87
    buffer_store_dwordx4 v[80:83], v1, s[28:31], s52 offen offset:128 sc1
    v_pk_mul_f32 v[88:89], v[88:89], v[12:13] op_sel:[0,0] op_sel_hi:[1,0]
    v_pk_mul_f32 v[90:91], v[90:91], v[12:13] op_sel:[0,0] op_sel_hi:[1,0]
    v_pk_mul_f32 v[92:93], v[92:93], v[12:13] op_sel:[0,0] op_sel_hi:[1,0]
    v_pk_mul_f32 v[94:95], v[94:95], v[12:13] op_sel:[0,0] op_sel_hi:[1,0]
    v_cvt_pk_bf16_f32 v88, v88, v89
    v_cvt_pk_bf16_f32 v89, v90, v91
    v_cvt_pk_bf16_f32 v90, v92, v93
    v_cvt_pk_bf16_f32 v91, v94, v95
    buffer_store_dwordx4 v[88:91], v1, s[28:31], s52 offen offset:192 sc1
    s_cmp_lg_u64 s[40:41], 0
    s_cbranch_scc1 L_slow
L_done:
L_exit:
    s_endpgm
L_codeend:
L_slow:
    s_waitcnt vmcnt(0)
    v_mbcnt_lo_u32_b32 v11, -1, 0
    v_mbcnt_hi_u32_b32 v11, -1, v11
    v_and_b32 v12, 15, v11
    v_lshrrev_b32 v13, 4, v11
    v_lshlrev_b32 v2, 8, v12
    v_lshl_add_u32 v2, v13, 4, v2
    v_lshlrev_b32 v3, 1, v12
    v_lshl_add_u32 v3, v13, 10, v3
    v_add_u32 v3, 2048, v3
    v_lshlrev_b32 v4, 8, v12
    v_lshl_add_u32 v4, v13, 3, v4
    v_add_u32 v4, s32, v4
    s_mov_b32 s76, 0
L_slow_sub:
    buffer_load_dwordx4 v[64:67], v1, s[16:19], s76 offen offset:0
    buffer_load_dwordx4 v[68:71], v1, s[16:19], s76 offen offset:64
    buffer_load_dwordx4 v[72:75], v1, s[16:19], s76 offen offset:128
    buffer_load_dwordx4 v[76:79], v1, s[16:19], s76 offen offset:192
    v_mov_b32 v5, 0xff800000
    s_mov_b32 s77, 0
L_slow_max:
    s_add_u32 s78, s77, 4096
    buffer_load_dwordx4 v[128:131], v2, s[20:23], s77 offen offset:0
    buffer_load_dwordx4 v[132:135], v2, s[20:23], s77 offen offset:64
    buffer_load_dwordx4 v[136:139], v2, s[20:23], s77 offen offset:128
    buffer_load_dwordx4 v[140:143], v2, s[20:23], s77 offen offset:192
    buffer_load_dwordx4 v[144:147], v2, s[20:23], s78 offen offset:0
    buffer_load_dwordx4 v[148:151], v2, s[20:23], s78 offen offset:64
    buffer_load_dwordx4 v[152:155], v2, s[20:23], s78 offen offset:128
    buffer_load_dwordx4 v[156:159], v2, s[20:23], s78 offen offset:192
    s_waitcnt vmcnt(0)
    v_mfma_f32_16x16x32_bf16 v[16:19], v[128:131], v[64:67], 0
    v_mfma_f32_16x16x32_bf16 v[16:19], v[132:135], v[68:71], v[16:19]
    v_mfma_f32_16x16x32_bf16 v[16:19], v[136:139], v[72:75], v[16:19]
    v_mfma_f32_16x16x32_bf16 v[16:19], v[140:143], v[76:79], v[16:19]
    v_mfma_f32_16x16x32_bf16 v[20:23], v[144:147], v[64:67], 0
    v_mfma_f32_16x16x32_bf16 v[20:23], v[148:151], v[68:71], v[20:23]
    v_mfma_f32_16x16x32_bf16 v[20:23], v[152:155], v[72:75], v[20:23]
    v_mfma_f32_16x16x32_bf16 v[20:23], v[156:159], v[76:79], v[20:23]
    s_nop 7
    s_nop 1
    v_max3_f32 v5, v5, v16, v17
    v_max3_f32 v5, v5, v18, v19
    v_max3_f32 v5, v5, v20, v21
    v_max3_f32 v5, v5, v22, v23
    s_add_u32 s77, s77, 8192
    s_cmp_lt_u32 s77, 131072
    s_cbranch_scc1 L_slow_max
    v_mov_b32 v6, v5
    s_nop 1
    v_permlane32_swap_b32 v5, v6
    s_nop 1
    v_max_f32 v5, v5, v6
    v_mov_b32 v6, v5
    s_nop 1
    v_permlane16_swap_b32 v5, v6
    s_nop 1
    v_max_f32 v5, v5, v6
    v_mul_f32 v5, s34, v5
    v_mov_b32 v7, 0
    v_mov_b32 v96, 0
    v_mov_b32 v97, 0
    v_mov_b32 v98, 0
    v_mov_b32 v99, 0
    v_mov_b32 v100, 0
    v_mov_b32 v101, 0
    v_mov_b32 v102, 0
    v_mov_b32 v103, 0
    v_mov_b32 v104, 0
    v_mov_b32 v105, 0
    v_mov_b32 v106, 0
    v_mov_b32 v107, 0
    v_mov_b32 v108, 0
    v_mov_b32 v109, 0
    v_mov_b32 v110, 0
    v_mov_b32 v111, 0
    v_mov_b32 v112, 0
    v_mov_b32 v113, 0
    v_mov_b32 v114, 0
    v_mov_b32 v115, 0
    v_mov_b32 v116, 0
    v_mov_b32 v117, 0
    v_mov_b32 v118, 0
    v_mov_b32 v119, 0
    v_mov_b32 v120, 0
    v_mov_b32 v121, 0
    v_mov_b32 v122, 0
    v_mov_b32 v123, 0
    v_mov_b32 v124, 0
    v_mov_b32 v125, 0
    v_mov_b32 v126, 0
    v_mov_b32 v127, 0
    s_mov_b32 s77, 0
L_slow_pv:
    s_add_u32 s78, s77, 4096
    buffer_load_dwordx4 v[128:131], v2, s[20:23], s77 offen offset:0
    buffer_load_dwordx4 v[132:135], v2, s[20:23], s77 offen offset:64
    buffer_load_dwordx4 v[136:139], v2, s[20:23], s77 offen offset:128
    buffer_load_dwordx4 v[140:143], v2, s[20:23], s77 offen offset:192
    buffer_load_dwordx4 v[144:147], v2, s[20:23], s78 offen offset:0
    buffer_load_dwordx4 v[148:151], v2, s[20:23], s78 offen offset:64
    buffer_load_dwordx4 v[152:155], v2, s[20:23], s78 offen offset:128
    buffer_load_dwordx4 v[156:159], v2, s[20:23], s78 offen offset:192
    buffer_load_ushort v160, v3, s[24:27], s77 offen offset:0
    buffer_load_ushort v161, v3, s[24:27], s77 offen offset:256
    buffer_load_ushort v162, v3, s[24:27], s77 offen offset:512
    buffer_load_ushort v163, v3, s[24:27], s77 offen offset:768
    buffer_load_ushort v164, v3, s[24:27], s78 offen offset:0
    buffer_load_ushort v165, v3, s[24:27], s78 offen offset:256
    buffer_load_ushort v166, v3, s[24:27], s78 offen offset:512
    buffer_load_ushort v167, v3, s[24:27], s78 offen offset:768
    buffer_load_ushort v168, v3, s[24:27], s77 offen offset:32
    buffer_load_ushort v169, v3, s[24:27], s77 offen offset:288
    buffer_load_ushort v170, v3, s[24:27], s77 offen offset:544
    buffer_load_ushort v171, v3, s[24:27], s77 offen offset:800
    buffer_load_ushort v172, v3, s[24:27], s78 offen offset:32
    buffer_load_ushort v173, v3, s[24:27], s78 offen offset:288
    buffer_load_ushort v174, v3, s[24:27], s78 offen offset:544
    buffer_load_ushort v175, v3, s[24:27], s78 offen offset:800
    buffer_load_ushort v176, v3, s[24:27], s77 offen offset:64
    buffer_load_ushort v177, v3, s[24:27], s77 offen offset:320
    buffer_load_ushort v178, v3, s[24:27], s77 offen offset:576
    buffer_load_ushort v179, v3, s[24:27], s77 offen offset:832
    buffer_load_ushort v180, v3, s[24:27], s78 offen offset:64
    buffer_load_ushort v181, v3, s[24:27], s78 offen offset:320
    buffer_load_ushort v182, v3, s[24:27], s78 offen offset:576
    buffer_load_ushort v183, v3, s[24:27], s78 offen offset:832
    buffer_load_ushort v184, v3, s[24:27], s77 offen offset:96
    buffer_load_ushort v185, v3, s[24:27], s77 offen offset:352
    buffer_load_ushort v186, v3, s[24:27], s77 offen offset:608
    buffer_load_ushort v187, v3, s[24:27], s77 offen offset:864
    buffer_load_ushort v188, v3, s[24:27], s78 offen offset:96
    buffer_load_ushort v189, v3, s[24:27], s78 offen offset:352
    buffer_load_ushort v190, v3, s[24:27], s78 offen offset:608
    buffer_load_ushort v191, v3, s[24:27], s78 offen offset:864
    s_waitcnt vmcnt(16)
    buffer_load_ushort v192, v3, s[24:27], s77 offen offset:128
    buffer_load_ushort v193, v3, s[24:27], s77 offen offset:384
    buffer_load_ushort v194, v3, s[24:27], s77 offen offset:640
    buffer_load_ushort v195, v3, s[24:27], s77 offen offset:896
    buffer_load_ushort v196, v3, s[24:27], s78 offen offset:128
    buffer_load_ushort v197, v3, s[24:27], s78 offen offset:384
    buffer_load_ushort v198, v3, s[24:27], s78 offen offset:640
    buffer_load_ushort v199, v3, s[24:27], s78 offen offset:896
    buffer_load_ushort v200, v3, s[24:27], s77 offen offset:160
    buffer_load_ushort v201, v3, s[24:27], s77 offen offset:416
    buffer_load_ushort v202, v3, s[24:27], s77 offen offset:672
    buffer_load_ushort v203, v3, s[24:27], s77 offen offset:928
    buffer_load_ushort v204, v3, s[24:27], s78 offen offset:160
    buffer_load_ushort v205, v3, s[24:27], s78 offen offset:416
    buffer_load_ushort v206, v3, s[24:27], s78 offen offset:672
    buffer_load_ushort v207, v3, s[24:27], s78 offen offset:928
    buffer_load_ushort v208, v3, s[24:27], s77 offen offset:192
    buffer_load_ushort v209, v3, s[24:27], s77 offen offset:448
    buffer_load_ushort v210, v3, s[24:27], s77 offen offset:704
    buffer_load_ushort v211, v3, s[24:27], s77 offen offset:960
    buffer_load_ushort v212, v3, s[24:27], s78 offen offset:192
    buffer_load_ushort v213, v3, s[24:27], s78 offen offset:448
    buffer_load_ushort v214, v3, s[24:27], s78 offen offset:704
    buffer_load_ushort v215, v3, s[24:27], s78 offen offset:960
    buffer_load_ushort v216, v3, s[24:27], s77 offen offset:224
    buffer_load_ushort v217, v3, s[24:27], s77 offen offset:480
    buffer_load_ushort v218, v3, s[24:27], s77 offen offset:736
    buffer_load_ushort v219, v3, s[24:27], s77 offen offset:992
    buffer_load_ushort v220, v3, s[24:27], s78 offen offset:224
    buffer_load_ushort v221, v3, s[24:27], s78 offen offset:480
    buffer_load_ushort v222, v3, s[24:27], s78 offen offset:736
    buffer_load_ushort v223, v3, s[24:27], s78 offen offset:992
    s_waitcnt vmcnt(0)
    v_mfma_f32_16x16x32_bf16 v[16:19], v[128:131], v[64:67], 0
    v_mfma_f32_16x16x32_bf16 v[16:19], v[132:135], v[68:71], v[16:19]
    v_mfma_f32_16x16x32_bf16 v[16:19], v[136:139], v[72:75], v[16:19]
    v_mfma_f32_16x16x32_bf16 v[16:19], v[140:143], v[76:79], v[16:19]
    v_mfma_f32_16x16x32_bf16 v[20:23], v[144:147], v[64:67], 0
    v_mfma_f32_16x16x32_bf16 v[20:23], v[148:151], v[68:71], v[20:23]
    v_mfma_f32_16x16x32_bf16 v[20:23], v[152:155], v[72:75], v[20:23]
    v_mfma_f32_16x16x32_bf16 v[20:23], v[156:159], v[76:79], v[20:23]
    s_nop 7
    s_nop 1
    v_fma_f32 v16, v16, s34, -v5
    v_fma_f32 v17, v17, s34, -v5
    v_fma_f32 v18, v18, s34, -v5
    v_fma_f32 v19, v19, s34, -v5
    v_fma_f32 v20, v20, s34, -v5
    v_fma_f32 v21, v21, s34, -v5
    v_fma_f32 v22, v22, s34, -v5
    v_fma_f32 v23, v23, s34, -v5
    v_exp_f32 v16, v16
    v_exp_f32 v17, v17
    v_exp_f32 v18, v18
    v_exp_f32 v19, v19
    v_exp_f32 v20, v20
    v_exp_f32 v21, v21
    v_exp_f32 v22, v22
    v_exp_f32 v23, v23
    s_nop 0
    v_add_f32 v7, v7, v16
    v_add_f32 v7, v7, v17
    v_add_f32 v7, v7, v18
    v_add_f32 v7, v7, v19
    v_add_f32 v7, v7, v20
    v_add_f32 v7, v7, v21
    v_add_f32 v7, v7, v22
    v_add_f32 v7, v7, v23
    v_cvt_pk_bf16_f32 v32, v16, v17
    v_cvt_pk_bf16_f32 v33, v18, v19
    v_cvt_pk_bf16_f32 v34, v20, v21
    v_cvt_pk_bf16_f32 v35, v22, v23
    v_lshl_or_b32 v224, v161, 16, v160
    v_lshl_or_b32 v225, v163, 16, v162
    v_lshl_or_b32 v226, v165, 16, v164
    v_lshl_or_b32 v227, v167, 16, v166
    v_lshl_or_b32 v228, v169, 16, v168
    v_lshl_or_b32 v229, v171, 16, v170
    v_lshl_or_b32 v230, v173, 16, v172
    v_lshl_or_b32 v231, v175, 16, v174
    v_lshl_or_b32 v232, v177, 16, v176
    v_lshl_or_b32 v233, v179, 16, v178
    v_lshl_or_b32 v234, v181, 16, v180
    v_lshl_or_b32 v235, v183, 16, v182
    v_lshl_or_b32 v236, v185, 16, v184
    v_lshl_or_b32 v237, v187, 16, v186
    v_lshl_or_b32 v238, v189, 16, v188
    v_lshl_or_b32 v239, v191, 16, v190
    v_lshl_or_b32 v240, v193, 16, v192
    v_lshl_or_b32 v241, v195, 16, v194
    v_lshl_or_b32 v242, v197, 16, v196
    v_lshl_or_b32 v243, v199, 16, v198
    v_lshl_or_b32 v244, v201, 16, v200
    v_lshl_or_b32 v245, v203, 16, v202
    v_lshl_or_b32 v246, v205, 16, v204
    v_lshl_or_b32 v247, v207, 16, v206
    v_lshl_or_b32 v248, v209, 16, v208
    v_lshl_or_b32 v249, v211, 16, v210
    v_lshl_or_b32 v250, v213, 16, v212
    v_lshl_or_b32 v251, v215, 16, v214
    v_lshl_or_b32 v252, v217, 16, v216
    v_lshl_or_b32 v253, v219, 16, v218
    v_lshl_or_b32 v254, v221, 16, v220
    v_lshl_or_b32 v255, v223, 16, v222
    s_nop 1
    v_mfma_f32_16x16x32_bf16 v[96:99], v[224:227], v[32:35], v[96:99]
    v_mfma_f32_16x16x32_bf16 v[100:103], v[228:231], v[32:35], v[100:103]
    v_mfma_f32_16x16x32_bf16 v[104:107], v[232:235], v[32:35], v[104:107]
    v_mfma_f32_16x16x32_bf16 v[108:111], v[236:239], v[32:35], v[108:111]
    v_mfma_f32_16x16x32_bf16 v[112:115], v[240:243], v[32:35], v[112:115]
    v_mfma_f32_16x16x32_bf16 v[116:119], v[244:247], v[32:35], v[116:119]
    v_mfma_f32_16x16x32_bf16 v[120:123], v[248:251], v[32:35], v[120:123]
    v_mfma_f32_16x16x32_bf16 v[124:127], v[252:255], v[32:35], v[124:127]
    s_add_u32 s77, s77, 8192
    s_cmp_lt_u32 s77, 131072
    s_cbranch_scc1 L_slow_pv
    v_mov_b32 v6, v7
    s_nop 1
    v_permlane32_swap_b32 v7, v6
    s_nop 1
    v_add_f32 v7, v7, v6
    v_mov_b32 v6, v7
    s_nop 1
    v_permlane16_swap_b32 v7, v6
    s_nop 1
    v_add_f32 v7, v7, v6
    v_rcp_f32 v7, v7
    s_nop 7
    v_mul_f32 v96, v7, v96
    v_mul_f32 v97, v7, v97
    v_mul_f32 v98, v7, v98
    v_mul_f32 v99, v7, v99
    v_mul_f32 v100, v7, v100
    v_mul_f32 v101, v7, v101
    v_mul_f32 v102, v7, v102
    v_mul_f32 v103, v7, v103
    v_mul_f32 v104, v7, v104
    v_mul_f32 v105, v7, v105
    v_mul_f32 v106, v7, v106
    v_mul_f32 v107, v7, v107
    v_mul_f32 v108, v7, v108
    v_mul_f32 v109, v7, v109
    v_mul_f32 v110, v7, v110
    v_mul_f32 v111, v7, v111
    v_mul_f32 v112, v7, v112
    v_mul_f32 v113, v7, v113
    v_mul_f32 v114, v7, v114
    v_mul_f32 v115, v7, v115
    v_mul_f32 v116, v7, v116
    v_mul_f32 v117, v7, v117
    v_mul_f32 v118, v7, v118
    v_mul_f32 v119, v7, v119
    v_mul_f32 v120, v7, v120
    v_mul_f32 v121, v7, v121
    v_mul_f32 v122, v7, v122
    v_mul_f32 v123, v7, v123
    v_mul_f32 v124, v7, v124
    v_mul_f32 v125, v7, v125
    v_mul_f32 v126, v7, v126
    v_mul_f32 v127, v7, v127
    v_cvt_pk_bf16_f32 v128, v96, v97
    v_cvt_pk_bf16_f32 v129, v98, v99
    v_cvt_pk_bf16_f32 v130, v100, v101
    v_cvt_pk_bf16_f32 v131, v102, v103
    v_cvt_pk_bf16_f32 v132, v104, v105
    v_cvt_pk_bf16_f32 v133, v106, v107
    v_cvt_pk_bf16_f32 v134, v108, v109
    v_cvt_pk_bf16_f32 v135, v110, v111
    v_cvt_pk_bf16_f32 v136, v112, v113
    v_cvt_pk_bf16_f32 v137, v114, v115
    v_cvt_pk_bf16_f32 v138, v116, v117
    v_cvt_pk_bf16_f32 v139, v118, v119
    v_cvt_pk_bf16_f32 v140, v120, v121
    v_cvt_pk_bf16_f32 v141, v122, v123
    v_cvt_pk_bf16_f32 v142, v124, v125
    v_cvt_pk_bf16_f32 v143, v126, v127
    buffer_store_dwordx2 v[128:129], v4, s[28:31], s76 offen offset:0
    buffer_store_dwordx2 v[130:131], v4, s[28:31], s76 offen offset:32
    buffer_store_dwordx2 v[132:133], v4, s[28:31], s76 offen offset:64
    buffer_store_dwordx2 v[134:135], v4, s[28:31], s76 offen offset:96
    buffer_store_dwordx2 v[136:137], v4, s[28:31], s76 offen offset:128
    buffer_store_dwordx2 v[138:139], v4, s[28:31], s76 offen offset:160
    buffer_store_dwordx2 v[140:141], v4, s[28:31], s76 offen offset:192
    buffer_store_dwordx2 v[142:143], v4, s[28:31], s76 offen offset:224
    s_waitcnt vmcnt(0)
    s_add_u32 s76, s76, 16384
    s_cmp_lt_u32 s76, 163840
    s_cbranch_scc1 L_slow_sub
    s_branch L_done
.section .rodata,"a"
.p2align 6
.amdhsa_kernel standalone__mha_softmax__near_ridge_kernel
  .amdhsa_next_free_vgpr 512
  .amdhsa_next_free_sgpr 102
  .amdhsa_accum_offset 256
  .amdhsa_group_segment_fixed_size 0
  .amdhsa_kernarg_size 48
  .amdhsa_user_sgpr_count 2
  .amdhsa_user_sgpr_kernarg_segment_ptr 1
  .amdhsa_system_sgpr_workgroup_id_x 1
.end_amdhsa_kernel
```
